```python
import torch

def _softmax(x, axis=-1):
    return torch.softmax(x, dim=axis)
def _gelu(x):
    return torch.nn.functional.gelu(x, approximate="tanh")
def _silu(x):
    return torch.nn.functional.silu(x)
def _sigmoid(x):
    return torch.sigmoid(x)
def _layernorm(x, axis=-1, eps=1e-5):
    m = x.mean(dim=axis, keepdim=True)
    v = x.var(dim=axis, keepdim=True, unbiased=False)
    return (x - m) / torch.sqrt(v + eps)
def _scatter_add(tgt, idx, src, axis=0):
    return tgt.clone().index_add_(axis, idx, src)
def _segment_sum(src, seg, n):
    out = torch.zeros((n,) + src.shape[1:], dtype=src.dtype)
    return out.index_add_(0, seg, src)
def _pad(x, pw):
    flat = tuple(v for pair in reversed(pw) for v in pair)
    return torch.nn.functional.pad(x, flat)

kernel_name = 'interleave_layers__sliding_local_dilated__dense_activation_mish__prompt'

def setup_inputs():

    _w = (lambda a: (lambda t: t.to(torch.bfloat16) if t.is_floating_point() else t)(torch.as_tensor(a)))
    def _A_setup():
        B, S, D = 1, 2048, 512
        return {
            "x": _w((lambda *s: torch.randn(*s, dtype=torch.bfloat16) * 0.05)(B, S, D)),
            "wqkv": _w((lambda *s: torch.randn(*s, dtype=torch.bfloat16) * 0.05)(D, 3 * D)),
            "wo": _w((lambda *s: torch.randn(*s, dtype=torch.bfloat16) * 0.05)(D, D)),
        }
    _A_in = _A_setup()

    def _B_setup():
        B, S, D, F = 1, 2048, 512, 1792
        return {
            "x": _w((lambda *s: torch.randn(*s, dtype=torch.bfloat16) * 0.05)(B, S, D)),
            "w1": _w((lambda *s: torch.randn(*s, dtype=torch.bfloat16) * 0.8)(D, F) * (D ** -0.5)),
            "b1": _w((lambda *s: torch.randn(*s, dtype=torch.bfloat16) * 0.8)(F)),
            "w2": _w((lambda *s: torch.randn(*s, dtype=torch.bfloat16) * 0.8)(F, D) * (F ** -0.5)),
        }
    _B_in = _B_setup()

    return {
        "A_x": _A_in["x"],
        "A_wqkv": _A_in["wqkv"],
        "A_wo": _A_in["wo"],
        "B_x": _B_in["x"],
        "B_w1": _B_in["w1"],
        "B_b1": _B_in["b1"],
        "B_w2": _B_in["w2"],
    }

def reference(A_x, A_wqkv, A_wo, B_x, B_w1, B_b1, B_w2):
    def _A_ref(x, wqkv, wo):
        B, S, D = x.shape
        H = 32; Dh = D // H
        W, dil = 8, 2
        qkv = (lambda x, *d: x.permute(*d))((x @ wqkv).reshape(B, S, 3, H, Dh), 2, 0, 3, 1, 4)
        q, k, v = qkv[0], qkv[1], qkv[2]
        scale = Dh ** -0.5
        pos = torch.arange(S)
        off = torch.arange(W) * dil
        idx = pos[:, None] - off[None, :]
        mask = idx >= 0
        idx_c = torch.where(mask, idx, 0).reshape(-1)
        kg = k[:, :, idx_c, :].reshape(B, H, S, W, Dh)
        vg = v[:, :, idx_c, :].reshape(B, H, S, W, Dh)
        logits = torch.einsum("bhsd,bhswd->bhsw", q, kg) * scale
        logits = torch.where(mask[None, None, :, :], logits, -1e9)
        attn = _softmax(logits, axis=-1)
        o = torch.einsum("bhsw,bhswd->bhsd", attn, vg)
        return (lambda x, *d: x.permute(*d))(o, 0, 2, 1, 3).reshape(B, S, D) @ wo

    def _B_ref(x, w1, b1, w2):
        h = torch.einsum("bsd,df->bsf", x, w1) + b1
        sp = torch.log1p(torch.exp(-torch.abs(h))) + torch.where(h > 0, h, torch.zeros_like(h))
        act = h * torch.tanh(sp)
        return torch.einsum("bsf,fd->bsd", act, w2)

    x = A_x
    x = x + _A_ref(_layernorm(x, axis=-1), A_wqkv, A_wo)
    x = x + _B_ref(_layernorm(x, axis=-1), B_w1, B_b1, B_w2)
    x = x + _A_ref(_layernorm(x, axis=-1), A_wqkv, A_wo)
    x = x + _B_ref(_layernorm(x, axis=-1), B_w1, B_b1, B_w2)
    return x
```

```asm
; @launch grid=(256,1,1) block=(512,1,1) lds=163840
.amdgcn_target "amdgcn-amd-amdhsa--gfx950"
.text
.globl interleave_layers__sliding_local_dilated__dense_activation_mish__prompt_kernel
.p2align 8
.type interleave_layers__sliding_local_dilated__dense_activation_mish__prompt_kernel,@function
interleave_layers__sliding_local_dilated__dense_activation_mish__prompt_kernel:
s_cmp_ge_u32 s2, 256
s_cbranch_scc1 L_end
s_load_dwordx16 s[64:79], s[0:1], 0
s_load_dwordx4 s[80:83], s[0:1], 64
s_getpc_b64 s[4:5]
L_pc:
s_lshr_b32 s6, s2, 3
s_and_b32 s6, s6, 31
s_lshl_b32 s6, s6, 11
v_lshrrev_b32 v1, 6, v0
v_lshlrev_b32 v1, 8, v1
v_and_b32 v2, 1, v0
v_lshlrev_b32 v2, 7, v2
v_add_u32 v1, v1, v2
v_add_u32 v1, s6, v1
v_min_u32 v1, L_end-L_pc, v1
s_mov_b64 exec, 3
global_load_dword v255, v1, s[4:5]
s_mov_b64 exec, -1
s_getreg_b32 s40, hwreg(HW_REG_XCC_ID, 0, 4)
v_lshrrev_b32 v1, 6, v0
v_and_b32 v0, 63, v0
v_readfirstlane_b32 s42, v1
s_and_b32 s40, s40, 7
v_lshlrev_b32 v1, 4, v0
v_mov_b32 v2, 0
s_nop 0
s_lshr_b32 s101, s42, 2
s_and_b32 s42, s42, 3
v_mov_b32 v4, 161792
ds_write_b32 v4, v2
s_waitcnt lgkmcnt(0)
s_barrier
s_mov_b32 s36, s80
s_and_b32 s37, s81, 0xffff
s_mov_b32 s38, 0x100
s_mov_b32 s39, 0x20000
s_or_b32 s48, s101, s42
s_cmp_lg_u32 s48, 0
s_cbranch_scc1 L_noatom_1
s_and_b32 s48, s40, 3
s_lshl_b32 s48, s48, 6
s_lshr_b32 s49, s40, 2
s_lshl_b32 s49, s49, 2
s_add_u32 s48, s48, s49
s_add_u32 s50, s80, s48
s_addc_u32 s51, s81, 0
s_mov_b32 s52, 1
s_atomic_add s52, s[50:51], 0 glc
s_waitcnt lgkmcnt(0)
s_add_u32 s52, s52, 1
v_mov_b32 v232, s52
v_mov_b32 v233, 161792
ds_write_b32 v233, v232
s_waitcnt lgkmcnt(0)
L_noatom_1:
s_cmp_eq_u32 s101, 0
s_cbranch_scc1 L_cpro
s_mov_b32 s28, s64
s_and_b32 s29, s65, 0xffff
s_mov_b32 s30, 0x200000
s_mov_b32 s31, 0x20000
s_mov_b32 s12, s66
s_and_b32 s13, s67, 0xffff
s_mov_b32 s14, 0x180000
s_mov_b32 s15, 0x20000
s_lshr_b32 s100, s2, 3
s_and_b32 s100, s100, 31
s_lshl_b32 s100, s100, 2
s_add_u32 s100, s100, s42
s_lshl_b32 s50, s40, 18
s_sub_u32 s50, s50, 16384
s_cmp_eq_u32 s40, 0
s_cselect_b32 s50, 0, s50
s_mul_i32 s87, s100, 2176
s_add_u32 s87, s87, s50
v_min_u32 v3, 16, v0
v_lshlrev_b32 v3, 7, v3
buffer_load_dword v17, v3, s[28:31], s87 offen
s_mul_i32 s88, s100, 6144
v_min_u32 v19, 47, v0
v_lshlrev_b32 v19, 7, v19
buffer_load_dword v17, v19, s[12:15], s88 offen
s_mul_i32 s88, s100, 6144
s_add_u32 s88, s88, 786432
v_min_u32 v19, 47, v0
v_lshlrev_b32 v19, 7, v19
buffer_load_dword v17, v19, s[12:15], s88 offen
s_mov_b32 s16, s68
s_and_b32 s17, s69, 0xffff
s_mov_b32 s18, 0x80000
s_mov_b32 s19, 0x20000
s_mov_b32 s20, s72
s_and_b32 s21, s73, 0xffff
s_mov_b32 s22, 0x1c0000
s_mov_b32 s23, 0x20000
s_mov_b32 s24, s76
s_and_b32 s25, s77, 0xffff
s_mov_b32 s26, 0x1c0000
s_mov_b32 s27, 0x20000
s_mul_i32 s48, s40, 0x400000
s_add_u32 s8, s82, s48
s_addc_u32 s9, s83, 0
s_and_b32 s9, s9, 0xffff
s_mov_b32 s10, 0x400000
s_mov_b32 s11, 0x20000
s_add_u32 s48, s48, 0x400000
s_add_u32 s32, s82, s48
s_addc_u32 s33, s83, 0
s_and_b32 s33, s33, 0xffff
s_mov_b32 s34, 0x400000
s_mov_b32 s35, 0x20000
s_branch L_helper
L_cpro:
s_mov_b32 s28, s64
s_and_b32 s29, s65, 0xffff
s_mov_b32 s30, 0x200000
s_mov_b32 s31, 0x20000
s_mov_b32 s15, 0x20000
s_mul_i32 s48, s40, 0x400000
s_add_u32 s8, s82, s48
s_addc_u32 s9, s83, 0
s_and_b32 s9, s9, 0xffff
s_mov_b32 s10, 0x400000
s_mov_b32 s11, 0x20000
s_add_u32 s48, s48, 0x400000
s_add_u32 s32, s82, s48
s_addc_u32 s33, s83, 0
s_and_b32 s33, s33, 0xffff
s_mov_b32 s34, 0x400000
s_mov_b32 s35, 0x20000
s_cmp_ge_u32 s2, 8
s_cbranch_scc1 L_nozero_2
s_cmp_lg_u32 s42, 1
s_cbranch_scc1 L_nozero_2
s_mul_i32 s48, s2, 0x400000
s_add_u32 s16, s82, s48
s_addc_u32 s17, s83, 0
s_and_b32 s17, s17, 0xffff
s_mov_b32 s18, 0x400000
s_mov_b32 s19, 0x20000
v_lshlrev_b32 v236, 2, v0
buffer_store_dword v2, v236, s[16:19], 0 offen sc1
buffer_store_dword v2, v236, s[16:19], 0 offen offset:256 sc1
buffer_store_dword v2, v236, s[16:19], 0 offen offset:512 sc1
buffer_store_dword v2, v236, s[16:19], 0 offen offset:768 sc1
buffer_store_dword v2, v236, s[16:19], 0 offen offset:1024 sc1
s_waitcnt vmcnt(0)
v_mov_b32 v237, 1
s_lshl_b32 s48, s2, 2
s_mov_b64 exec, 1
buffer_store_dword v237, v2, s[36:39], s48 offen offset:32 sc1
s_mov_b64 exec, -1
s_waitcnt vmcnt(0)
L_nozero_2:
s_setprio 2
s_mov_b32 s12, s64
s_and_b32 s13, s65, 0xffff
s_mov_b32 s14, 0x200000
v_mov_b32 v233, 161792
s_mov_b32 s86, 0
L_role_3:
ds_read_b32 v232, v233
s_waitcnt lgkmcnt(0)
v_readfirstlane_b32 s41, v232
s_nop 3
s_cmp_lg_u32 s41, 0
s_cbranch_scc1 L_roleok_4
s_add_u32 s86, s86, 1
s_cmp_lt_u32 s86, 0x100000
s_cbranch_scc1 L_role_3
L_roleok_4:
s_sub_u32 s41, s41, 1
s_and_b32 s41, s41, 31
s_lshr_b32 s43, s41, 4
s_and_b32 s44, s41, 15
s_lshr_b32 s48, s44, 3
s_lshl_b32 s45, s43, 1
s_add_u32 s45, s45, s48
s_and_b32 s46, s44, 7
s_mov_b32 s47, 0
s_mov_b32 s54, 0
s_lshl_b32 s85, s41, 4
s_lshl_b32 s48, s42, 2
s_add_u32 s85, s85, s48
s_mov_b32 s89, 0x3f803f80
s_mov_b32 s94, 0x3727c5ac
v_and_b32 v153, 15, v0
v_lshrrev_b32 v154, 4, v0
v_lshrrev_b32 v155, 2, v153
v_and_b32 v156, 3, v153
v_lshlrev_b32 v157, 2, v154
v_add_u32 v157, v157, v155
v_lshlrev_b32 v158, 3, v156
v_and_b32 v160, 1, v154
v_lshlrev_b32 v160, 5, v160
v_lshlrev_b32 v159, 6, v157
v_add_u32 v159, v159, v158
v_add_u32 v6, v159, v160
v_xor_b32 v7, 32, v6
v_lshrrev_b32 v160, 3, v153
v_lshlrev_b32 v161, 1, v154
v_add_u32 v160, v160, v161
v_and_b32 v160, 3, v160
v_lshlrev_b32 v160, 5, v160
v_lshlrev_b32 v159, 7, v157
v_add_u32 v159, v159, v158
v_xor_b32 v161, 0, v160
v_add_u32 v52, v161, v159
v_add_u32 v8, 98304, v52
v_xor_b32 v161, 32, v160
v_add_u32 v53, v161, v159
v_add_u32 v9, 98304, v53
v_xor_b32 v161, 64, v160
v_add_u32 v54, v161, v159
v_add_u32 v10, 98304, v54
v_xor_b32 v161, 96, v160
v_add_u32 v55, v161, v159
v_add_u32 v11, 98304, v55
v_mul_u32_u24 v159, 224, v157
v_add_u32 v12, v159, v158
s_mul_i32 s63, s42, 28672
s_mul_i32 s62, s42, 8192
s_add_u32 s62, s62, 114688
s_lshr_b32 s48, s46, 1
s_lshl_b32 s48, s48, 8
s_and_b32 s49, s46, 1
s_lshl_b32 s49, s49, 3
s_add_u32 s48, s48, s49
v_lshlrev_b32 v159, 4, v153
v_lshrrev_b32 v160, 5, v0
v_lshlrev_b32 v160, 2, v160
v_add_u32 v159, v159, v160
v_add_u32 v4, s48, v159
v_and_b32 v160, 1, v154
v_mul_u32_u24 v160, 24, v160
v_lshlrev_b32 v159, 3, v154
v_add_u32 v159, v159, v160
v_lshlrev_b32 v160, 10, v153
v_add_u32 v159, v159, v160
s_lshl_b32 s48, s46, 7
v_add_u32 v5, s48, v159
s_mov_b32 s50, 0xf149f2ca
v_mov_b32 v162, s50
s_or_b32 s48, s40, s43
s_or_b32 s93, s48, s42
v_lshlrev_b32 v159, 2, v154
v_add_u32 v159, 0, v159
v_sub_u32 v160, v153, v159
v_and_b32 v161, 1, v160
v_cmp_eq_u32 s[52:53], 0, v161
v_cmp_le_i32 vcc, 0, v160
s_nop 3
s_and_b64 vcc, vcc, s[52:53]
v_cndmask_b32 v32, v162, v2, vcc
v_cmp_ge_i32 vcc, -2, v160
s_nop 3
s_and_b64 vcc, vcc, s[52:53]
v_cndmask_b32 v36, v162, v2, vcc
s_cmp_eq_u32 s93, 0
s_cselect_b64 vcc, 0, vcc
v_cndmask_b32 v40, v162, v2, vcc
v_lshlrev_b32 v159, 2, v154
v_add_u32 v159, 1, v159
v_sub_u32 v160, v153, v159
v_and_b32 v161, 1, v160
v_cmp_eq_u32 s[52:53], 0, v161
v_cmp_le_i32 vcc, 0, v160
s_nop 3
s_and_b64 vcc, vcc, s[52:53]
v_cndmask_b32 v33, v162, v2, vcc
v_cmp_ge_i32 vcc, -2, v160
s_nop 3
s_and_b64 vcc, vcc, s[52:53]
v_cndmask_b32 v37, v162, v2, vcc
s_cmp_eq_u32 s93, 0
s_cselect_b64 vcc, 0, vcc
v_cndmask_b32 v41, v162, v2, vcc
v_lshlrev_b32 v159, 2, v154
v_add_u32 v159, 2, v159
v_sub_u32 v160, v153, v159
v_and_b32 v161, 1, v160
v_cmp_eq_u32 s[52:53], 0, v161
v_cmp_le_i32 vcc, 0, v160
s_nop 3
s_and_b64 vcc, vcc, s[52:53]
v_cndmask_b32 v34, v162, v2, vcc
v_cmp_ge_i32 vcc, -2, v160
s_nop 3
s_and_b64 vcc, vcc, s[52:53]
v_cndmask_b32 v38, v162, v2, vcc
s_cmp_eq_u32 s93, 0
s_cselect_b64 vcc, 0, vcc
v_cndmask_b32 v42, v162, v2, vcc
v_lshlrev_b32 v159, 2, v154
v_add_u32 v159, 3, v159
v_sub_u32 v160, v153, v159
v_and_b32 v161, 1, v160
v_cmp_eq_u32 s[52:53], 0, v161
v_cmp_le_i32 vcc, 0, v160
s_nop 3
s_and_b64 vcc, vcc, s[52:53]
v_cndmask_b32 v35, v162, v2, vcc
v_cmp_ge_i32 vcc, -2, v160
s_nop 3
s_and_b64 vcc, vcc, s[52:53]
v_cndmask_b32 v39, v162, v2, vcc
s_cmp_eq_u32 s93, 0
s_cselect_b64 vcc, 0, vcc
v_cndmask_b32 v43, v162, v2, vcc
s_lshl_b32 s48, s43, 3
s_lshl_b32 s49, s42, 1
s_add_u32 s48, s48, s49
s_lshl_b32 s48, s48, 3
s_cmp_eq_u32 s43, 0
s_cselect_b32 s49, 0, 56
s_cselect_b32 s50, 15, 7
v_and_b32 v233, 15, v0
v_add_u32 v233, s48, v233
v_and_b32 v234, s50, v0
v_add_u32 v234, s49, v234
v_cmp_gt_u32 vcc, 32, v0
s_nop 1
v_cndmask_b32 v233, v234, v233, vcc
v_lshlrev_b32 v3, 2, v233
v_add_u32 v3, 512, v3
s_lshl_b32 s52, s43, 3
s_lshl_b32 s53, s42, 1
s_add_u32 s52, s52, s53
s_lshl_b32 s84, s52, 10
s_add_u32 s84, s84, 0x50000
s_mul_i32 s91, s43, 0x8000
s_add_u32 s91, s91, 0x60000
s_add_u32 s91, s91, 0x4000
s_or_b32 s53, s40, s43
s_cmp_eq_u32 s53, 0
s_lshl_b32 s48, s40, 4
s_add_u32 s48, s48, s52
s_lshl_b32 s48, s48, 14
s_add_u32 s49, s48, 16384
s_lshl_b32 s50, s40, 1
s_add_u32 s50, s50, s43
s_lshl_b32 s50, s50, 17
s_sub_u32 s50, s50, 16384
s_lshl_b32 s52, s42, 8
s_add_u32 s50, s50, s52
s_cmp_eq_u32 s53, 0
s_cselect_b32 s50, 0x7ff00000, s50
v_add_u32 v248, 49152, v6
v_add_u32 v249, 49152, v7
s_mul_i32 s51, s42, 15360
s_add_u32 s60, s51, 98304
v_lshrrev_b32 v174, 3, v0
v_add_u32 v174, 0, v174
v_lshrrev_b32 v175, 1, v174
v_lshlrev_b32 v174, 10, v174
v_xor_b32 v175, v175, v0
v_and_b32 v175, 7, v175
v_lshlrev_b32 v175, 4, v175
v_add_u32 v168, v174, v175
v_lshrrev_b32 v174, 3, v0
v_add_u32 v174, 8, v174
v_lshrrev_b32 v175, 1, v174
v_lshlrev_b32 v174, 10, v174
v_xor_b32 v175, v175, v0
v_and_b32 v175, 7, v175
v_lshlrev_b32 v175, 4, v175
v_add_u32 v169, v174, v175
v_and_b32 v174, 15, v0
v_lshrrev_b32 v175, 1, v174
v_lshrrev_b32 v170, 5, v0
v_xor_b32 v175, v175, v170
v_and_b32 v175, 7, v175
v_lshlrev_b32 v175, 4, v175
v_and_b32 v170, 7, v174
v_lshlrev_b32 v170, 7, v170
v_add_u32 v175, v175, v170
v_lshrrev_b32 v174, 3, v174
v_lshlrev_b32 v174, 10, v174
v_add_u32 v175, v175, v174
v_bfe_u32 v174, v0, 4, 1
v_lshlrev_b32 v174, 3, v174
v_add_u32 v175, v175, v174
v_add_u32 v170, s60, v175
v_xor_b32 v171, 32, v170
v_xor_b32 v172, 64, v170
v_xor_b32 v173, 96, v170
s_add_u32 m0, s60, 0
s_nop 0
buffer_load_dwordx4 v168, s[28:31], s48 offen offset:0 lds
s_add_u32 m0, s60, 1024
s_nop 0
buffer_load_dwordx4 v169, s[28:31], s48 offen offset:0 lds
s_add_u32 m0, s60, 2048
s_nop 0
buffer_load_dwordx4 v168, s[28:31], s49 offen offset:0 lds
s_add_u32 m0, s60, 3072
s_nop 0
buffer_load_dwordx4 v169, s[28:31], s49 offen offset:0 lds
s_add_u32 m0, s60, 3968
s_nop 0
buffer_load_dwordx4 v168, s[28:31], s48 offen offset:128 lds
s_add_u32 m0, s60, 4992
s_nop 0
buffer_load_dwordx4 v169, s[28:31], s48 offen offset:128 lds
s_add_u32 m0, s60, 6016
s_nop 0
buffer_load_dwordx4 v168, s[28:31], s49 offen offset:128 lds
s_add_u32 m0, s60, 7040
s_nop 0
buffer_load_dwordx4 v169, s[28:31], s49 offen offset:128 lds
s_add_u32 m0, s60, 7936
s_nop 0
buffer_load_dwordx4 v168, s[28:31], s48 offen offset:256 lds
s_add_u32 m0, s60, 8960
s_nop 0
buffer_load_dwordx4 v169, s[28:31], s48 offen offset:256 lds
s_add_u32 m0, s60, 9984
s_nop 0
buffer_load_dwordx4 v168, s[28:31], s49 offen offset:256 lds
s_add_u32 m0, s60, 11008
s_nop 0
buffer_load_dwordx4 v169, s[28:31], s49 offen offset:256 lds
s_waitcnt vmcnt(8)
ds_read_b64 v[152:153], v170 offset:0
ds_read_b64 v[154:155], v171 offset:0
ds_read_b64 v[156:157], v170 offset:2048
ds_read_b64 v[158:159], v171 offset:2048
s_barrier
ds_read_b64_tr_b16 v[120:121], v6 offset:0
ds_read_b64_tr_b16 v[122:123], v6 offset:1024
ds_read_b64_tr_b16 v[124:125], v7 offset:0
ds_read_b64_tr_b16 v[126:127], v7 offset:1024
ds_read_b64_tr_b16 v[128:129], v6 offset:2048
ds_read_b64_tr_b16 v[130:131], v6 offset:3072
ds_read_b64_tr_b16 v[132:133], v7 offset:2048
ds_read_b64_tr_b16 v[134:135], v7 offset:3072
ds_read_b64_tr_b16 v[136:137], v6 offset:4096
ds_read_b64_tr_b16 v[138:139], v6 offset:5120
ds_read_b64_tr_b16 v[140:141], v7 offset:4096
ds_read_b64_tr_b16 v[142:143], v7 offset:5120
s_waitcnt lgkmcnt(10)
v_mfma_f32_16x16x32_bf16 v[56:59], v[120:123], v[152:155], 0
v_mfma_f32_16x16x32_bf16 v[60:63], v[120:123], v[156:159], 0
ds_read_b64_tr_b16 v[120:121], v6 offset:6144
s_waitcnt lgkmcnt(9)
v_mfma_f32_16x16x32_bf16 v[64:67], v[124:127], v[152:155], 0
ds_read_b64_tr_b16 v[122:123], v6 offset:7168
ds_read_b64 v[160:161], v172 offset:0
v_mfma_f32_16x16x32_bf16 v[68:71], v[124:127], v[156:159], 0
ds_read_b64_tr_b16 v[124:125], v7 offset:6144
ds_read_b64 v[162:163], v173 offset:0
s_waitcnt lgkmcnt(11)
v_mfma_f32_16x16x32_bf16 v[72:75], v[128:131], v[152:155], 0
ds_read_b64_tr_b16 v[126:127], v7 offset:7168
ds_read_b64 v[164:165], v172 offset:2048
v_mfma_f32_16x16x32_bf16 v[76:79], v[128:131], v[156:159], 0
ds_read_b64_tr_b16 v[128:129], v6 offset:8192
ds_read_b64 v[166:167], v173 offset:2048
s_waitcnt lgkmcnt(13)
v_mfma_f32_16x16x32_bf16 v[80:83], v[132:135], v[152:155], 0
ds_read_b64_tr_b16 v[130:131], v6 offset:9216
v_mfma_f32_16x16x32_bf16 v[84:87], v[132:135], v[156:159], 0
ds_read_b64_tr_b16 v[132:133], v7 offset:8192
s_waitcnt lgkmcnt(13)
v_mfma_f32_16x16x32_bf16 v[88:91], v[152:155], v[136:139], 0
ds_read_b64_tr_b16 v[134:135], v7 offset:9216
v_mfma_f32_16x16x32_bf16 v[92:95], v[156:159], v[136:139], 0
ds_read_b64_tr_b16 v[136:137], v6 offset:10240
s_waitcnt lgkmcnt(13)
v_mfma_f32_16x16x32_bf16 v[96:99], v[152:155], v[140:143], 0
ds_read_b64_tr_b16 v[138:139], v6 offset:11264
v_mfma_f32_16x16x32_bf16 v[100:103], v[156:159], v[140:143], 0
ds_read_b64_tr_b16 v[140:141], v7 offset:10240
s_waitcnt lgkmcnt(10)
v_mfma_f32_16x16x32_bf16 v[56:59], v[120:123], v[160:163], v[56:59]
ds_read_b64_tr_b16 v[142:143], v7 offset:11264
s_waitcnt lgkmcnt(7)
v_mfma_f32_16x16x32_bf16 v[60:63], v[120:123], v[164:167], v[60:63]
ds_read_b64_tr_b16 v[120:121], v6 offset:12288
s_waitcnt vmcnt(4)
v_mfma_f32_16x16x32_bf16 v[64:67], v[124:127], v[160:163], v[64:67]
ds_read_b64_tr_b16 v[122:123], v6 offset:13312
ds_read_b64 v[152:153], v170 offset:4096
v_mfma_f32_16x16x32_bf16 v[68:71], v[124:127], v[164:167], v[68:71]
ds_read_b64_tr_b16 v[124:125], v7 offset:12288
ds_read_b64 v[154:155], v171 offset:4096
s_add_u32 m0, s60, 4294966912
s_waitcnt lgkmcnt(11)
v_mfma_f32_16x16x32_bf16 v[72:75], v[128:131], v[160:163], v[72:75]
ds_read_b64_tr_b16 v[126:127], v7 offset:13312
ds_read_b64 v[156:157], v170 offset:6144
buffer_load_dwordx4 v168, s[28:31], s48 offen offset:384 lds
v_mfma_f32_16x16x32_bf16 v[76:79], v[128:131], v[164:167], v[76:79]
ds_read_b64_tr_b16 v[128:129], v6 offset:14336
ds_read_b64 v[158:159], v171 offset:6144
s_add_u32 m0, s60, 640
s_waitcnt lgkmcnt(13)
v_mfma_f32_16x16x32_bf16 v[80:83], v[132:135], v[160:163], v[80:83]
ds_read_b64_tr_b16 v[130:131], v6 offset:15360
buffer_load_dwordx4 v169, s[28:31], s48 offen offset:384 lds
v_mfma_f32_16x16x32_bf16 v[84:87], v[132:135], v[164:167], v[84:87]
ds_read_b64_tr_b16 v[132:133], v7 offset:14336
s_add_u32 m0, s60, 1664
s_waitcnt lgkmcnt(13)
v_mfma_f32_16x16x32_bf16 v[88:91], v[160:163], v[136:139], v[88:91]
ds_read_b64_tr_b16 v[134:135], v7 offset:15360
buffer_load_dwordx4 v168, s[28:31], s49 offen offset:384 lds
v_mfma_f32_16x16x32_bf16 v[92:95], v[164:167], v[136:139], v[92:95]
ds_read_b64_tr_b16 v[136:137], v6 offset:16384
s_add_u32 m0, s60, 2688
s_waitcnt lgkmcnt(13)
v_mfma_f32_16x16x32_bf16 v[96:99], v[160:163], v[140:143], v[96:99]
ds_read_b64_tr_b16 v[138:139], v6 offset:17408
buffer_load_dwordx4 v169, s[28:31], s49 offen offset:384 lds
v_mfma_f32_16x16x32_bf16 v[100:103], v[164:167], v[140:143], v[100:103]
ds_read_b64_tr_b16 v[140:141], v7 offset:16384
s_waitcnt lgkmcnt(10)
v_mfma_f32_16x16x32_bf16 v[56:59], v[120:123], v[152:155], v[56:59]
ds_read_b64_tr_b16 v[142:143], v7 offset:17408
s_waitcnt lgkmcnt(7)
v_mfma_f32_16x16x32_bf16 v[60:63], v[120:123], v[156:159], v[60:63]
ds_read_b64_tr_b16 v[120:121], v6 offset:18432
v_mfma_f32_16x16x32_bf16 v[64:67], v[124:127], v[152:155], v[64:67]
ds_read_b64_tr_b16 v[122:123], v6 offset:19456
ds_read_b64 v[160:161], v172 offset:4096
v_mfma_f32_16x16x32_bf16 v[68:71], v[124:127], v[156:159], v[68:71]
ds_read_b64_tr_b16 v[124:125], v7 offset:18432
ds_read_b64 v[162:163], v173 offset:4096
s_waitcnt lgkmcnt(11)
v_mfma_f32_16x16x32_bf16 v[72:75], v[128:131], v[152:155], v[72:75]
ds_read_b64_tr_b16 v[126:127], v7 offset:19456
ds_read_b64 v[164:165], v172 offset:6144
v_mfma_f32_16x16x32_bf16 v[76:79], v[128:131], v[156:159], v[76:79]
ds_read_b64_tr_b16 v[128:129], v6 offset:20480
ds_read_b64 v[166:167], v173 offset:6144
s_waitcnt lgkmcnt(13)
v_mfma_f32_16x16x32_bf16 v[80:83], v[132:135], v[152:155], v[80:83]
ds_read_b64_tr_b16 v[130:131], v6 offset:21504
v_mfma_f32_16x16x32_bf16 v[84:87], v[132:135], v[156:159], v[84:87]
ds_read_b64_tr_b16 v[132:133], v7 offset:20480
s_waitcnt lgkmcnt(13)
v_mfma_f32_16x16x32_bf16 v[88:91], v[152:155], v[136:139], v[88:91]
ds_read_b64_tr_b16 v[134:135], v7 offset:21504
v_mfma_f32_16x16x32_bf16 v[92:95], v[156:159], v[136:139], v[92:95]
ds_read_b64_tr_b16 v[136:137], v6 offset:22528
s_waitcnt lgkmcnt(13)
v_mfma_f32_16x16x32_bf16 v[96:99], v[152:155], v[140:143], v[96:99]
ds_read_b64_tr_b16 v[138:139], v6 offset:23552
v_mfma_f32_16x16x32_bf16 v[100:103], v[156:159], v[140:143], v[100:103]
ds_read_b64_tr_b16 v[140:141], v7 offset:22528
s_barrier
s_waitcnt lgkmcnt(10)
v_mfma_f32_16x16x32_bf16 v[56:59], v[120:123], v[160:163], v[56:59]
ds_read_b64_tr_b16 v[142:143], v7 offset:23552
s_waitcnt lgkmcnt(7)
v_mfma_f32_16x16x32_bf16 v[60:63], v[120:123], v[164:167], v[60:63]
ds_read_b64_tr_b16 v[120:121], v6 offset:24576
s_waitcnt vmcnt(4)
v_mfma_f32_16x16x32_bf16 v[64:67], v[124:127], v[160:163], v[64:67]
ds_read_b64_tr_b16 v[122:123], v6 offset:25600
ds_read_b64 v[152:153], v170 offset:8192
v_mfma_f32_16x16x32_bf16 v[68:71], v[124:127], v[164:167], v[68:71]
ds_read_b64_tr_b16 v[124:125], v7 offset:24576
ds_read_b64 v[154:155], v171 offset:8192
s_add_u32 m0, s60, 3584
s_waitcnt lgkmcnt(11)
v_mfma_f32_16x16x32_bf16 v[72:75], v[128:131], v[160:163], v[72:75]
ds_read_b64_tr_b16 v[126:127], v7 offset:25600
ds_read_b64 v[156:157], v170 offset:10240
buffer_load_dwordx4 v168, s[28:31], s48 offen offset:512 lds
v_mfma_f32_16x16x32_bf16 v[76:79], v[128:131], v[164:167], v[76:79]
ds_read_b64_tr_b16 v[128:129], v6 offset:26624
ds_read_b64 v[158:159], v171 offset:10240
s_add_u32 m0, s60, 4608
s_waitcnt lgkmcnt(13)
v_mfma_f32_16x16x32_bf16 v[80:83], v[132:135], v[160:163], v[80:83]
ds_read_b64_tr_b16 v[130:131], v6 offset:27648
buffer_load_dwordx4 v169, s[28:31], s48 offen offset:512 lds
v_mfma_f32_16x16x32_bf16 v[84:87], v[132:135], v[164:167], v[84:87]
ds_read_b64_tr_b16 v[132:133], v7 offset:26624
s_add_u32 m0, s60, 5632
s_waitcnt lgkmcnt(13)
v_mfma_f32_16x16x32_bf16 v[88:91], v[160:163], v[136:139], v[88:91]
ds_read_b64_tr_b16 v[134:135], v7 offset:27648
buffer_load_dwordx4 v168, s[28:31], s49 offen offset:512 lds
v_mfma_f32_16x16x32_bf16 v[92:95], v[164:167], v[136:139], v[92:95]
ds_read_b64_tr_b16 v[136:137], v6 offset:28672
s_add_u32 m0, s60, 6656
s_waitcnt lgkmcnt(13)
v_mfma_f32_16x16x32_bf16 v[96:99], v[160:163], v[140:143], v[96:99]
ds_read_b64_tr_b16 v[138:139], v6 offset:29696
buffer_load_dwordx4 v169, s[28:31], s49 offen offset:512 lds
v_mfma_f32_16x16x32_bf16 v[100:103], v[164:167], v[140:143], v[100:103]
ds_read_b64_tr_b16 v[140:141], v7 offset:28672
s_waitcnt lgkmcnt(10)
v_mfma_f32_16x16x32_bf16 v[56:59], v[120:123], v[152:155], v[56:59]
ds_read_b64_tr_b16 v[142:143], v7 offset:29696
s_waitcnt lgkmcnt(7)
v_mfma_f32_16x16x32_bf16 v[60:63], v[120:123], v[156:159], v[60:63]
ds_read_b64_tr_b16 v[120:121], v6 offset:30720
v_mfma_f32_16x16x32_bf16 v[64:67], v[124:127], v[152:155], v[64:67]
ds_read_b64_tr_b16 v[122:123], v6 offset:31744
ds_read_b64 v[160:161], v172 offset:8192
v_mfma_f32_16x16x32_bf16 v[68:71], v[124:127], v[156:159], v[68:71]
ds_read_b64_tr_b16 v[124:125], v7 offset:30720
ds_read_b64 v[162:163], v173 offset:8192
s_waitcnt lgkmcnt(11)
v_mfma_f32_16x16x32_bf16 v[72:75], v[128:131], v[152:155], v[72:75]
ds_read_b64_tr_b16 v[126:127], v7 offset:31744
ds_read_b64 v[164:165], v172 offset:10240
v_mfma_f32_16x16x32_bf16 v[76:79], v[128:131], v[156:159], v[76:79]
ds_read_b64_tr_b16 v[128:129], v6 offset:32768
ds_read_b64 v[166:167], v173 offset:10240
s_waitcnt lgkmcnt(13)
v_mfma_f32_16x16x32_bf16 v[80:83], v[132:135], v[152:155], v[80:83]
ds_read_b64_tr_b16 v[130:131], v6 offset:33792
v_mfma_f32_16x16x32_bf16 v[84:87], v[132:135], v[156:159], v[84:87]
ds_read_b64_tr_b16 v[132:133], v7 offset:32768
s_waitcnt lgkmcnt(13)
v_mfma_f32_16x16x32_bf16 v[88:91], v[152:155], v[136:139], v[88:91]
ds_read_b64_tr_b16 v[134:135], v7 offset:33792
v_mfma_f32_16x16x32_bf16 v[92:95], v[156:159], v[136:139], v[92:95]
ds_read_b64_tr_b16 v[136:137], v6 offset:34816
s_waitcnt lgkmcnt(13)
v_mfma_f32_16x16x32_bf16 v[96:99], v[152:155], v[140:143], v[96:99]
ds_read_b64_tr_b16 v[138:139], v6 offset:35840
v_mfma_f32_16x16x32_bf16 v[100:103], v[156:159], v[140:143], v[100:103]
ds_read_b64_tr_b16 v[140:141], v7 offset:34816
s_waitcnt lgkmcnt(10)
v_mfma_f32_16x16x32_bf16 v[56:59], v[120:123], v[160:163], v[56:59]
ds_read_b64_tr_b16 v[142:143], v7 offset:35840
s_waitcnt lgkmcnt(7)
v_mfma_f32_16x16x32_bf16 v[60:63], v[120:123], v[164:167], v[60:63]
ds_read_b64_tr_b16 v[120:121], v6 offset:36864
s_waitcnt vmcnt(4)
v_mfma_f32_16x16x32_bf16 v[64:67], v[124:127], v[160:163], v[64:67]
ds_read_b64_tr_b16 v[122:123], v6 offset:37888
ds_read_b64 v[152:153], v170 offset:0
v_mfma_f32_16x16x32_bf16 v[68:71], v[124:127], v[164:167], v[68:71]
ds_read_b64_tr_b16 v[124:125], v7 offset:36864
ds_read_b64 v[154:155], v171 offset:0
s_add_u32 m0, s60, 7552
s_waitcnt lgkmcnt(11)
v_mfma_f32_16x16x32_bf16 v[72:75], v[128:131], v[160:163], v[72:75]
ds_read_b64_tr_b16 v[126:127], v7 offset:37888
ds_read_b64 v[156:157], v170 offset:2048
buffer_load_dwordx4 v168, s[28:31], s48 offen offset:640 lds
v_mfma_f32_16x16x32_bf16 v[76:79], v[128:131], v[164:167], v[76:79]
ds_read_b64_tr_b16 v[128:129], v6 offset:38912
ds_read_b64 v[158:159], v171 offset:2048
s_add_u32 m0, s60, 8576
s_waitcnt lgkmcnt(13)
v_mfma_f32_16x16x32_bf16 v[80:83], v[132:135], v[160:163], v[80:83]
ds_read_b64_tr_b16 v[130:131], v6 offset:39936
buffer_load_dwordx4 v169, s[28:31], s48 offen offset:640 lds
v_mfma_f32_16x16x32_bf16 v[84:87], v[132:135], v[164:167], v[84:87]
ds_read_b64_tr_b16 v[132:133], v7 offset:38912
s_add_u32 m0, s60, 9600
s_waitcnt lgkmcnt(13)
v_mfma_f32_16x16x32_bf16 v[88:91], v[160:163], v[136:139], v[88:91]
ds_read_b64_tr_b16 v[134:135], v7 offset:39936
buffer_load_dwordx4 v168, s[28:31], s49 offen offset:640 lds
v_mfma_f32_16x16x32_bf16 v[92:95], v[164:167], v[136:139], v[92:95]
ds_read_b64_tr_b16 v[136:137], v6 offset:40960
s_add_u32 m0, s60, 10624
s_waitcnt lgkmcnt(13)
v_mfma_f32_16x16x32_bf16 v[96:99], v[160:163], v[140:143], v[96:99]
ds_read_b64_tr_b16 v[138:139], v6 offset:41984
buffer_load_dwordx4 v169, s[28:31], s49 offen offset:640 lds
v_mfma_f32_16x16x32_bf16 v[100:103], v[164:167], v[140:143], v[100:103]
ds_read_b64_tr_b16 v[140:141], v7 offset:40960
s_waitcnt lgkmcnt(10)
v_mfma_f32_16x16x32_bf16 v[56:59], v[120:123], v[152:155], v[56:59]
ds_read_b64_tr_b16 v[142:143], v7 offset:41984
s_waitcnt lgkmcnt(7)
v_mfma_f32_16x16x32_bf16 v[60:63], v[120:123], v[156:159], v[60:63]
ds_read_b64_tr_b16 v[120:121], v6 offset:43008
v_mfma_f32_16x16x32_bf16 v[64:67], v[124:127], v[152:155], v[64:67]
ds_read_b64_tr_b16 v[122:123], v6 offset:44032
ds_read_b64 v[160:161], v172 offset:0
v_mfma_f32_16x16x32_bf16 v[68:71], v[124:127], v[156:159], v[68:71]
ds_read_b64_tr_b16 v[124:125], v7 offset:43008
ds_read_b64 v[162:163], v173 offset:0
s_waitcnt lgkmcnt(11)
v_mfma_f32_16x16x32_bf16 v[72:75], v[128:131], v[152:155], v[72:75]
ds_read_b64_tr_b16 v[126:127], v7 offset:44032
ds_read_b64 v[164:165], v172 offset:2048
v_mfma_f32_16x16x32_bf16 v[76:79], v[128:131], v[156:159], v[76:79]
ds_read_b64_tr_b16 v[128:129], v6 offset:45056
ds_read_b64 v[166:167], v173 offset:2048
s_waitcnt lgkmcnt(13)
v_mfma_f32_16x16x32_bf16 v[80:83], v[132:135], v[152:155], v[80:83]
ds_read_b64_tr_b16 v[130:131], v6 offset:46080
v_mfma_f32_16x16x32_bf16 v[84:87], v[132:135], v[156:159], v[84:87]
ds_read_b64_tr_b16 v[132:133], v7 offset:45056
s_waitcnt lgkmcnt(13)
v_mfma_f32_16x16x32_bf16 v[88:91], v[152:155], v[136:139], v[88:91]
ds_read_b64_tr_b16 v[134:135], v7 offset:46080
v_mfma_f32_16x16x32_bf16 v[92:95], v[156:159], v[136:139], v[92:95]
ds_read_b64_tr_b16 v[136:137], v6 offset:47104
s_waitcnt lgkmcnt(13)
v_mfma_f32_16x16x32_bf16 v[96:99], v[152:155], v[140:143], v[96:99]
ds_read_b64_tr_b16 v[138:139], v6 offset:48128
v_mfma_f32_16x16x32_bf16 v[100:103], v[156:159], v[140:143], v[100:103]
ds_read_b64_tr_b16 v[140:141], v7 offset:47104
s_barrier
s_waitcnt lgkmcnt(10)
v_mfma_f32_16x16x32_bf16 v[56:59], v[120:123], v[160:163], v[56:59]
ds_read_b64_tr_b16 v[142:143], v7 offset:48128
s_waitcnt lgkmcnt(7)
v_mfma_f32_16x16x32_bf16 v[60:63], v[120:123], v[164:167], v[60:63]
ds_read_b64_tr_b16 v[120:121], v248 offset:0
s_waitcnt vmcnt(4)
v_mfma_f32_16x16x32_bf16 v[64:67], v[124:127], v[160:163], v[64:67]
ds_read_b64_tr_b16 v[122:123], v248 offset:1024
ds_read_b64 v[152:153], v170 offset:4096
v_mfma_f32_16x16x32_bf16 v[68:71], v[124:127], v[164:167], v[68:71]
ds_read_b64_tr_b16 v[124:125], v249 offset:0
ds_read_b64 v[154:155], v171 offset:4096
s_add_u32 m0, s60, 4294966528
s_waitcnt lgkmcnt(11)
v_mfma_f32_16x16x32_bf16 v[72:75], v[128:131], v[160:163], v[72:75]
ds_read_b64_tr_b16 v[126:127], v249 offset:1024
ds_read_b64 v[156:157], v170 offset:6144
buffer_load_dwordx4 v168, s[28:31], s48 offen offset:768 lds
v_mfma_f32_16x16x32_bf16 v[76:79], v[128:131], v[164:167], v[76:79]
ds_read_b64_tr_b16 v[128:129], v248 offset:2048
ds_read_b64 v[158:159], v171 offset:6144
s_add_u32 m0, s60, 256
s_waitcnt lgkmcnt(13)
v_mfma_f32_16x16x32_bf16 v[80:83], v[132:135], v[160:163], v[80:83]
ds_read_b64_tr_b16 v[130:131], v248 offset:3072
buffer_load_dwordx4 v169, s[28:31], s48 offen offset:768 lds
v_mfma_f32_16x16x32_bf16 v[84:87], v[132:135], v[164:167], v[84:87]
ds_read_b64_tr_b16 v[132:133], v249 offset:2048
s_add_u32 m0, s60, 1280
s_waitcnt lgkmcnt(13)
v_mfma_f32_16x16x32_bf16 v[88:91], v[160:163], v[136:139], v[88:91]
ds_read_b64_tr_b16 v[134:135], v249 offset:3072
buffer_load_dwordx4 v168, s[28:31], s49 offen offset:768 lds
v_mfma_f32_16x16x32_bf16 v[92:95], v[164:167], v[136:139], v[92:95]
ds_read_b64_tr_b16 v[136:137], v248 offset:4096
s_add_u32 m0, s60, 2304
s_waitcnt lgkmcnt(13)
v_mfma_f32_16x16x32_bf16 v[96:99], v[160:163], v[140:143], v[96:99]
ds_read_b64_tr_b16 v[138:139], v248 offset:5120
buffer_load_dwordx4 v169, s[28:31], s49 offen offset:768 lds
v_mfma_f32_16x16x32_bf16 v[100:103], v[164:167], v[140:143], v[100:103]
ds_read_b64_tr_b16 v[140:141], v249 offset:4096
s_waitcnt lgkmcnt(10)
v_mfma_f32_16x16x32_bf16 v[56:59], v[120:123], v[152:155], v[56:59]
ds_read_b64_tr_b16 v[142:143], v249 offset:5120
s_waitcnt lgkmcnt(7)
v_mfma_f32_16x16x32_bf16 v[60:63], v[120:123], v[156:159], v[60:63]
ds_read_b64_tr_b16 v[120:121], v248 offset:6144
v_mfma_f32_16x16x32_bf16 v[64:67], v[124:127], v[152:155], v[64:67]
ds_read_b64_tr_b16 v[122:123], v248 offset:7168
ds_read_b64 v[160:161], v172 offset:4096
v_mfma_f32_16x16x32_bf16 v[68:71], v[124:127], v[156:159], v[68:71]
ds_read_b64_tr_b16 v[124:125], v249 offset:6144
ds_read_b64 v[162:163], v173 offset:4096
s_waitcnt lgkmcnt(11)
v_mfma_f32_16x16x32_bf16 v[72:75], v[128:131], v[152:155], v[72:75]
ds_read_b64_tr_b16 v[126:127], v249 offset:7168
ds_read_b64 v[164:165], v172 offset:6144
v_mfma_f32_16x16x32_bf16 v[76:79], v[128:131], v[156:159], v[76:79]
ds_read_b64_tr_b16 v[128:129], v248 offset:8192
ds_read_b64 v[166:167], v173 offset:6144
s_waitcnt lgkmcnt(13)
v_mfma_f32_16x16x32_bf16 v[80:83], v[132:135], v[152:155], v[80:83]
ds_read_b64_tr_b16 v[130:131], v248 offset:9216
v_mfma_f32_16x16x32_bf16 v[84:87], v[132:135], v[156:159], v[84:87]
ds_read_b64_tr_b16 v[132:133], v249 offset:8192
s_waitcnt lgkmcnt(13)
v_mfma_f32_16x16x32_bf16 v[88:91], v[152:155], v[136:139], v[88:91]
ds_read_b64_tr_b16 v[134:135], v249 offset:9216
v_mfma_f32_16x16x32_bf16 v[92:95], v[156:159], v[136:139], v[92:95]
ds_read_b64_tr_b16 v[136:137], v248 offset:10240
s_waitcnt lgkmcnt(13)
v_mfma_f32_16x16x32_bf16 v[96:99], v[152:155], v[140:143], v[96:99]
ds_read_b64_tr_b16 v[138:139], v248 offset:11264
v_mfma_f32_16x16x32_bf16 v[100:103], v[156:159], v[140:143], v[100:103]
ds_read_b64_tr_b16 v[140:141], v249 offset:10240
s_waitcnt lgkmcnt(10)
v_mfma_f32_16x16x32_bf16 v[56:59], v[120:123], v[160:163], v[56:59]
ds_read_b64_tr_b16 v[142:143], v249 offset:11264
s_waitcnt lgkmcnt(7)
v_mfma_f32_16x16x32_bf16 v[60:63], v[120:123], v[164:167], v[60:63]
ds_read_b64_tr_b16 v[120:121], v248 offset:12288
s_waitcnt vmcnt(4)
v_mfma_f32_16x16x32_bf16 v[64:67], v[124:127], v[160:163], v[64:67]
ds_read_b64_tr_b16 v[122:123], v248 offset:13312
ds_read_b64 v[152:153], v170 offset:8192
v_mfma_f32_16x16x32_bf16 v[68:71], v[124:127], v[164:167], v[68:71]
ds_read_b64_tr_b16 v[124:125], v249 offset:12288
ds_read_b64 v[154:155], v171 offset:8192
s_add_u32 m0, s60, 3200
s_waitcnt lgkmcnt(11)
v_mfma_f32_16x16x32_bf16 v[72:75], v[128:131], v[160:163], v[72:75]
ds_read_b64_tr_b16 v[126:127], v249 offset:13312
ds_read_b64 v[156:157], v170 offset:10240
buffer_load_dwordx4 v168, s[28:31], s48 offen offset:896 lds
v_mfma_f32_16x16x32_bf16 v[76:79], v[128:131], v[164:167], v[76:79]
ds_read_b64_tr_b16 v[128:129], v248 offset:14336
ds_read_b64 v[158:159], v171 offset:10240
s_add_u32 m0, s60, 4224
s_waitcnt lgkmcnt(13)
v_mfma_f32_16x16x32_bf16 v[80:83], v[132:135], v[160:163], v[80:83]
ds_read_b64_tr_b16 v[130:131], v248 offset:15360
buffer_load_dwordx4 v169, s[28:31], s48 offen offset:896 lds
v_mfma_f32_16x16x32_bf16 v[84:87], v[132:135], v[164:167], v[84:87]
ds_read_b64_tr_b16 v[132:133], v249 offset:14336
s_add_u32 m0, s60, 5248
s_waitcnt lgkmcnt(13)
v_mfma_f32_16x16x32_bf16 v[88:91], v[160:163], v[136:139], v[88:91]
ds_read_b64_tr_b16 v[134:135], v249 offset:15360
buffer_load_dwordx4 v168, s[28:31], s49 offen offset:896 lds
v_mfma_f32_16x16x32_bf16 v[92:95], v[164:167], v[136:139], v[92:95]
ds_read_b64_tr_b16 v[136:137], v248 offset:16384
s_add_u32 m0, s60, 6272
s_waitcnt lgkmcnt(13)
v_mfma_f32_16x16x32_bf16 v[96:99], v[160:163], v[140:143], v[96:99]
ds_read_b64_tr_b16 v[138:139], v248 offset:17408
buffer_load_dwordx4 v169, s[28:31], s49 offen offset:896 lds
v_mfma_f32_16x16x32_bf16 v[100:103], v[164:167], v[140:143], v[100:103]
ds_read_b64_tr_b16 v[140:141], v249 offset:16384
s_waitcnt lgkmcnt(10)
v_mfma_f32_16x16x32_bf16 v[56:59], v[120:123], v[152:155], v[56:59]
ds_read_b64_tr_b16 v[142:143], v249 offset:17408
s_waitcnt lgkmcnt(7)
v_mfma_f32_16x16x32_bf16 v[60:63], v[120:123], v[156:159], v[60:63]
ds_read_b64_tr_b16 v[120:121], v248 offset:18432
v_mfma_f32_16x16x32_bf16 v[64:67], v[124:127], v[152:155], v[64:67]
ds_read_b64_tr_b16 v[122:123], v248 offset:19456
ds_read_b64 v[160:161], v172 offset:8192
v_mfma_f32_16x16x32_bf16 v[68:71], v[124:127], v[156:159], v[68:71]
ds_read_b64_tr_b16 v[124:125], v249 offset:18432
ds_read_b64 v[162:163], v173 offset:8192
s_waitcnt lgkmcnt(11)
v_mfma_f32_16x16x32_bf16 v[72:75], v[128:131], v[152:155], v[72:75]
ds_read_b64_tr_b16 v[126:127], v249 offset:19456
ds_read_b64 v[164:165], v172 offset:10240
v_mfma_f32_16x16x32_bf16 v[76:79], v[128:131], v[156:159], v[76:79]
ds_read_b64_tr_b16 v[128:129], v248 offset:20480
ds_read_b64 v[166:167], v173 offset:10240
s_waitcnt lgkmcnt(13)
v_mfma_f32_16x16x32_bf16 v[80:83], v[132:135], v[152:155], v[80:83]
ds_read_b64_tr_b16 v[130:131], v248 offset:21504
v_mfma_f32_16x16x32_bf16 v[84:87], v[132:135], v[156:159], v[84:87]
ds_read_b64_tr_b16 v[132:133], v249 offset:20480
s_waitcnt lgkmcnt(13)
v_mfma_f32_16x16x32_bf16 v[88:91], v[152:155], v[136:139], v[88:91]
ds_read_b64_tr_b16 v[134:135], v249 offset:21504
v_mfma_f32_16x16x32_bf16 v[92:95], v[156:159], v[136:139], v[92:95]
ds_read_b64_tr_b16 v[136:137], v248 offset:22528
s_waitcnt lgkmcnt(13)
v_mfma_f32_16x16x32_bf16 v[96:99], v[152:155], v[140:143], v[96:99]
ds_read_b64_tr_b16 v[138:139], v248 offset:23552
v_mfma_f32_16x16x32_bf16 v[100:103], v[156:159], v[140:143], v[100:103]
ds_read_b64_tr_b16 v[140:141], v249 offset:22528
s_barrier
buffer_load_dword v233, v3, s[8:11], 0 offen sc1
s_waitcnt lgkmcnt(10)
v_mfma_f32_16x16x32_bf16 v[56:59], v[120:123], v[160:163], v[56:59]
ds_read_b64_tr_b16 v[142:143], v249 offset:23552
s_waitcnt lgkmcnt(7)
v_mfma_f32_16x16x32_bf16 v[60:63], v[120:123], v[164:167], v[60:63]
ds_read_b64_tr_b16 v[120:121], v248 offset:24576
s_waitcnt vmcnt(5)
v_mfma_f32_16x16x32_bf16 v[64:67], v[124:127], v[160:163], v[64:67]
ds_read_b64_tr_b16 v[122:123], v248 offset:25600
ds_read_b64 v[152:153], v170 offset:0
v_mfma_f32_16x16x32_bf16 v[68:71], v[124:127], v[164:167], v[68:71]
ds_read_b64_tr_b16 v[124:125], v249 offset:24576
s_add_u32 m0, s60, 8192
ds_read_b64 v[154:155], v171 offset:0
s_waitcnt lgkmcnt(11)
v_mfma_f32_16x16x32_bf16 v[72:75], v[128:131], v[160:163], v[72:75]
ds_read_b64_tr_b16 v[126:127], v249 offset:25600
buffer_load_dwordx4 v168, s[28:31], s50 offen offset:0 lds
ds_read_b64 v[156:157], v170 offset:2048
v_mfma_f32_16x16x32_bf16 v[76:79], v[128:131], v[164:167], v[76:79]
ds_read_b64_tr_b16 v[128:129], v248 offset:26624
s_add_u32 m0, s60, 9216
ds_read_b64 v[158:159], v171 offset:2048
s_waitcnt lgkmcnt(13)
v_mfma_f32_16x16x32_bf16 v[80:83], v[132:135], v[160:163], v[80:83]
ds_read_b64_tr_b16 v[130:131], v248 offset:27648
buffer_load_dwordx4 v169, s[28:31], s50 offen offset:0 lds
v_mfma_f32_16x16x32_bf16 v[84:87], v[132:135], v[164:167], v[84:87]
ds_read_b64_tr_b16 v[132:133], v249 offset:26624
s_add_u32 m0, s60, 10112
s_waitcnt lgkmcnt(13)
v_mfma_f32_16x16x32_bf16 v[88:91], v[160:163], v[136:139], v[88:91]
ds_read_b64_tr_b16 v[134:135], v249 offset:27648
buffer_load_dwordx4 v168, s[28:31], s50 offen offset:128 lds
v_mfma_f32_16x16x32_bf16 v[92:95], v[164:167], v[136:139], v[92:95]
ds_read_b64_tr_b16 v[136:137], v248 offset:28672
s_add_u32 m0, s60, 11136
s_waitcnt lgkmcnt(13)
v_mfma_f32_16x16x32_bf16 v[96:99], v[160:163], v[140:143], v[96:99]
ds_read_b64_tr_b16 v[138:139], v248 offset:29696
buffer_load_dwordx4 v169, s[28:31], s50 offen offset:128 lds
v_mfma_f32_16x16x32_bf16 v[100:103], v[164:167], v[140:143], v[100:103]
ds_read_b64_tr_b16 v[140:141], v249 offset:28672
s_waitcnt lgkmcnt(10)
v_mfma_f32_16x16x32_bf16 v[56:59], v[120:123], v[152:155], v[56:59]
ds_read_b64_tr_b16 v[142:143], v249 offset:29696
s_waitcnt lgkmcnt(7)
v_mfma_f32_16x16x32_bf16 v[60:63], v[120:123], v[156:159], v[60:63]
ds_read_b64_tr_b16 v[120:121], v248 offset:30720
v_mfma_f32_16x16x32_bf16 v[64:67], v[124:127], v[152:155], v[64:67]
ds_read_b64_tr_b16 v[122:123], v248 offset:31744
ds_read_b64 v[160:161], v172 offset:0
v_mfma_f32_16x16x32_bf16 v[68:71], v[124:127], v[156:159], v[68:71]
ds_read_b64_tr_b16 v[124:125], v249 offset:30720
ds_read_b64 v[162:163], v173 offset:0
s_waitcnt lgkmcnt(11)
v_mfma_f32_16x16x32_bf16 v[72:75], v[128:131], v[152:155], v[72:75]
ds_read_b64_tr_b16 v[126:127], v249 offset:31744
ds_read_b64 v[164:165], v172 offset:2048
v_mfma_f32_16x16x32_bf16 v[76:79], v[128:131], v[156:159], v[76:79]
ds_read_b64_tr_b16 v[128:129], v248 offset:32768
ds_read_b64 v[166:167], v173 offset:2048
s_waitcnt lgkmcnt(13)
v_mfma_f32_16x16x32_bf16 v[80:83], v[132:135], v[152:155], v[80:83]
ds_read_b64_tr_b16 v[130:131], v248 offset:33792
v_mfma_f32_16x16x32_bf16 v[84:87], v[132:135], v[156:159], v[84:87]
ds_read_b64_tr_b16 v[132:133], v249 offset:32768
s_waitcnt lgkmcnt(13)
v_mfma_f32_16x16x32_bf16 v[88:91], v[152:155], v[136:139], v[88:91]
ds_read_b64_tr_b16 v[134:135], v249 offset:33792
v_mfma_f32_16x16x32_bf16 v[92:95], v[156:159], v[136:139], v[92:95]
ds_read_b64_tr_b16 v[136:137], v248 offset:34816
s_waitcnt lgkmcnt(13)
v_mfma_f32_16x16x32_bf16 v[96:99], v[152:155], v[140:143], v[96:99]
ds_read_b64_tr_b16 v[138:139], v248 offset:35840
v_mfma_f32_16x16x32_bf16 v[100:103], v[156:159], v[140:143], v[100:103]
ds_read_b64_tr_b16 v[140:141], v249 offset:34816
s_waitcnt vmcnt(4)
v_cmp_gt_u32 vcc, 1, v233
s_nop 0
s_cbranch_vccz L_p0rdy_5
s_waitcnt vmcnt(0)
s_mov_b32 s86, 0
L_poll_6:
buffer_load_dword v232, v3, s[8:11], 0 offen sc1
s_waitcnt vmcnt(0)
v_cmp_gt_u32 vcc, 1, v232
s_nop 0
s_cbranch_vccz L_pollok_7
s_add_u32 s86, s86, 1
s_cmp_lt_u32 s86, 0x40000
s_cbranch_scc1 L_poll_6
v_mov_b32 v232, 0xdead
s_movk_i32 s86, 252
buffer_store_dword v232, v2, s[36:39], s86 offen sc1
s_waitcnt vmcnt(0)
L_pollok_7:
L_p0rdy_5:
buffer_load_dwordx4 v[236:239], v1, s[8:11], s84 offen sc1
buffer_load_dwordx4 v[240:243], v1, s[8:11], s84 offen offset:1024 sc1
buffer_load_dwordx4 v[244:247], v1, s[8:11], s91 offen sc1
s_barrier
s_waitcnt lgkmcnt(10)
v_mfma_f32_16x16x32_bf16 v[56:59], v[120:123], v[160:163], v[56:59]
ds_read_b64_tr_b16 v[142:143], v249 offset:35840
s_waitcnt lgkmcnt(7)
v_mfma_f32_16x16x32_bf16 v[60:63], v[120:123], v[164:167], v[60:63]
ds_read_b64_tr_b16 v[120:121], v248 offset:36864
v_mfma_f32_16x16x32_bf16 v[64:67], v[124:127], v[160:163], v[64:67]
ds_read_b64_tr_b16 v[122:123], v248 offset:37888
ds_read_b64 v[152:153], v170 offset:4096
v_mfma_f32_16x16x32_bf16 v[68:71], v[124:127], v[164:167], v[68:71]
ds_read_b64_tr_b16 v[124:125], v249 offset:36864
ds_read_b64 v[154:155], v171 offset:4096
s_waitcnt lgkmcnt(11)
v_mfma_f32_16x16x32_bf16 v[72:75], v[128:131], v[160:163], v[72:75]
ds_read_b64_tr_b16 v[126:127], v249 offset:37888
ds_read_b64 v[156:157], v170 offset:6144
v_mfma_f32_16x16x32_bf16 v[76:79], v[128:131], v[164:167], v[76:79]
ds_read_b64_tr_b16 v[128:129], v248 offset:38912
ds_read_b64 v[158:159], v171 offset:6144
s_waitcnt lgkmcnt(13)
v_mfma_f32_16x16x32_bf16 v[80:83], v[132:135], v[160:163], v[80:83]
ds_read_b64_tr_b16 v[130:131], v248 offset:39936
v_mfma_f32_16x16x32_bf16 v[84:87], v[132:135], v[164:167], v[84:87]
ds_read_b64_tr_b16 v[132:133], v249 offset:38912
s_waitcnt lgkmcnt(13)
v_mfma_f32_16x16x32_bf16 v[88:91], v[160:163], v[136:139], v[88:91]
ds_read_b64_tr_b16 v[134:135], v249 offset:39936
v_mfma_f32_16x16x32_bf16 v[92:95], v[164:167], v[136:139], v[92:95]
ds_read_b64_tr_b16 v[136:137], v248 offset:40960
s_waitcnt lgkmcnt(13)
v_mfma_f32_16x16x32_bf16 v[96:99], v[160:163], v[140:143], v[96:99]
ds_read_b64_tr_b16 v[138:139], v248 offset:41984
v_mfma_f32_16x16x32_bf16 v[100:103], v[164:167], v[140:143], v[100:103]
ds_read_b64_tr_b16 v[140:141], v249 offset:40960
s_waitcnt lgkmcnt(10)
v_mfma_f32_16x16x32_bf16 v[56:59], v[120:123], v[152:155], v[56:59]
ds_read_b64_tr_b16 v[142:143], v249 offset:41984
s_waitcnt lgkmcnt(7)
v_mfma_f32_16x16x32_bf16 v[60:63], v[120:123], v[156:159], v[60:63]
ds_read_b64_tr_b16 v[120:121], v248 offset:43008
v_mfma_f32_16x16x32_bf16 v[64:67], v[124:127], v[152:155], v[64:67]
ds_read_b64_tr_b16 v[122:123], v248 offset:44032
ds_read_b64 v[160:161], v172 offset:4096
v_mfma_f32_16x16x32_bf16 v[68:71], v[124:127], v[156:159], v[68:71]
ds_read_b64_tr_b16 v[124:125], v249 offset:43008
ds_read_b64 v[162:163], v173 offset:4096
s_waitcnt lgkmcnt(11)
v_mfma_f32_16x16x32_bf16 v[72:75], v[128:131], v[152:155], v[72:75]
ds_read_b64_tr_b16 v[126:127], v249 offset:44032
ds_read_b64 v[164:165], v172 offset:6144
v_mfma_f32_16x16x32_bf16 v[76:79], v[128:131], v[156:159], v[76:79]
ds_read_b64_tr_b16 v[128:129], v248 offset:45056
ds_read_b64 v[166:167], v173 offset:6144
s_waitcnt lgkmcnt(13)
v_mfma_f32_16x16x32_bf16 v[80:83], v[132:135], v[152:155], v[80:83]
ds_read_b64_tr_b16 v[130:131], v248 offset:46080
v_mfma_f32_16x16x32_bf16 v[84:87], v[132:135], v[156:159], v[84:87]
ds_read_b64_tr_b16 v[132:133], v249 offset:45056
s_waitcnt lgkmcnt(13)
v_mfma_f32_16x16x32_bf16 v[88:91], v[152:155], v[136:139], v[88:91]
ds_read_b64_tr_b16 v[134:135], v249 offset:46080
v_mfma_f32_16x16x32_bf16 v[92:95], v[156:159], v[136:139], v[92:95]
ds_read_b64_tr_b16 v[136:137], v248 offset:47104
s_waitcnt lgkmcnt(13)
v_mfma_f32_16x16x32_bf16 v[96:99], v[152:155], v[140:143], v[96:99]
ds_read_b64_tr_b16 v[138:139], v248 offset:48128
v_mfma_f32_16x16x32_bf16 v[100:103], v[156:159], v[140:143], v[100:103]
ds_read_b64_tr_b16 v[140:141], v249 offset:47104
s_waitcnt lgkmcnt(10)
v_mfma_f32_16x16x32_bf16 v[56:59], v[120:123], v[160:163], v[56:59]
ds_read_b64_tr_b16 v[142:143], v249 offset:48128
s_waitcnt vmcnt(2)
v_add_f32 v236, v236, v238
v_add_f32 v237, v237, v239
s_nop 1
v_permlane32_swap_b32 v236, v237
v_add_f32 v236, v236, v237
v_mov_b32 v238, v236
s_waitcnt lgkmcnt(7)
v_mfma_f32_16x16x32_bf16 v[60:63], v[120:123], v[164:167], v[60:63]
v_permlane16_swap_b32 v238, v236
v_add_f32 v236, v236, v238
v_mov_b32 v237, v236
s_nop 1
v_permlane32_swap_b32 v236, v237
v_mul_f32 v236, 0x3b000000, v236
v_mfma_f32_16x16x32_bf16 v[64:67], v[124:127], v[160:163], v[64:67]
v_mul_f32 v237, 0x3b000000, v237
v_fma_f32 v237, -v236, v236, v237
v_max_f32 v237, 0, v237
v_add_f32 v237, s94, v237
v_rsq_f32 v252, v237
v_mfma_f32_16x16x32_bf16 v[68:71], v[124:127], v[164:167], v[68:71]
v_mul_f32 v253, v236, v252
s_waitcnt vmcnt(1)
v_add_f32 v240, v240, v242
v_add_f32 v241, v241, v243
s_nop 1
v_permlane32_swap_b32 v240, v241
v_add_f32 v240, v240, v241
s_waitcnt lgkmcnt(6)
v_mfma_f32_16x16x32_bf16 v[72:75], v[128:131], v[160:163], v[72:75]
v_mov_b32 v242, v240
s_nop 1
v_permlane16_swap_b32 v242, v240
v_add_f32 v240, v240, v242
v_mov_b32 v241, v240
v_mfma_f32_16x16x32_bf16 v[76:79], v[128:131], v[164:167], v[76:79]
s_nop 0
v_permlane32_swap_b32 v240, v241
v_mul_f32 v240, 0x3b000000, v240
v_mul_f32 v241, 0x3b000000, v241
v_fma_f32 v241, -v240, v240, v241
v_max_f32 v241, 0, v241
s_waitcnt lgkmcnt(4)
v_mfma_f32_16x16x32_bf16 v[80:83], v[132:135], v[160:163], v[80:83]
v_add_f32 v241, s94, v241
v_rsq_f32 v254, v241
s_nop 0
v_mul_f32 v255, v240, v254
s_waitcnt vmcnt(0)
v_add_f32 v244, v244, v246
v_add_f32 v245, v245, v247
v_mfma_f32_16x16x32_bf16 v[84:87], v[132:135], v[164:167], v[84:87]
s_nop 0
v_permlane32_swap_b32 v244, v245
v_add_f32 v244, v244, v245
v_mov_b32 v246, v244
s_nop 1
v_permlane16_swap_b32 v246, v244
v_add_f32 v244, v244, v246
s_waitcnt lgkmcnt(2)
v_mfma_f32_16x16x32_bf16 v[88:91], v[160:163], v[136:139], v[88:91]
v_mov_b32 v245, v244
s_nop 1
v_permlane32_swap_b32 v244, v245
v_mul_f32 v244, 0x3b000000, v244
v_mul_f32 v245, 0x3b000000, v245
v_fma_f32 v245, -v244, v244, v245
v_mfma_f32_16x16x32_bf16 v[92:95], v[164:167], v[136:139], v[92:95]
v_max_f32 v245, 0, v245
v_add_f32 v245, s94, v245
v_rsq_f32 v234, v245
s_nop 0
v_mul_f32 v235, v244, v234
s_waitcnt lgkmcnt(0)
v_mfma_f32_16x16x32_bf16 v[96:99], v[160:163], v[140:143], v[96:99]
v_mfma_f32_16x16x32_bf16 v[100:103], v[164:167], v[140:143], v[100:103]
ds_read_b64 v[16:17], v170 offset:8192
ds_read_b64 v[18:19], v171 offset:8192
ds_read_b64 v[20:21], v172 offset:8192
ds_read_b64 v[22:23], v173 offset:8192
ds_read_b64 v[24:25], v170 offset:10240
ds_read_b64 v[26:27], v171 offset:10240
ds_read_b64 v[28:29], v172 offset:10240
ds_read_b64 v[30:31], v173 offset:10240
s_mul_i32 s52, s42, 24576
v_add_u32 v250, s52, v6
v_add_u32 v251, s52, v7
ds_read_b64_tr_b16 v[120:121], v250 offset:2048
ds_read_b64_tr_b16 v[122:123], v250 offset:3072
ds_read_b64_tr_b16 v[124:125], v251 offset:2048
ds_read_b64_tr_b16 v[126:127], v251 offset:3072
ds_read_b64_tr_b16 v[128:129], v250 offset:4096
ds_read_b64_tr_b16 v[130:131], v250 offset:5120
ds_read_b64_tr_b16 v[132:133], v251 offset:4096
ds_read_b64_tr_b16 v[134:135], v251 offset:5120
ds_read_b64_tr_b16 v[136:137], v250 offset:8192
ds_read_b64_tr_b16 v[138:139], v250 offset:9216
ds_read_b64_tr_b16 v[140:141], v251 offset:8192
ds_read_b64_tr_b16 v[142:143], v251 offset:9216
ds_read_b64_tr_b16 v[144:145], v250 offset:10240
ds_read_b64_tr_b16 v[146:147], v250 offset:11264
ds_read_b64_tr_b16 v[148:149], v251 offset:10240
ds_read_b64_tr_b16 v[150:151], v251 offset:11264
s_waitcnt lgkmcnt(14)
v_mfma_f32_16x16x32_bf16 v[104:107], v[120:123], v[16:19], 0
ds_read_b64_tr_b16 v[120:121], v250 offset:14336
ds_read_b64_tr_b16 v[122:123], v250 offset:15360
s_waitcnt lgkmcnt(14)
v_mfma_f32_16x16x32_bf16 v[108:111], v[124:127], v[16:19], 0
ds_read_b64_tr_b16 v[124:125], v251 offset:14336
ds_read_b64_tr_b16 v[126:127], v251 offset:15360
s_waitcnt lgkmcnt(14)
v_mfma_f32_16x16x32_bf16 v[112:115], v[16:19], v[128:131], 0
ds_read_b64_tr_b16 v[128:129], v250 offset:16384
ds_read_b64_tr_b16 v[130:131], v250 offset:17408
s_waitcnt lgkmcnt(14)
v_mfma_f32_16x16x32_bf16 v[116:119], v[16:19], v[132:135], 0
ds_read_b64_tr_b16 v[132:133], v251 offset:16384
ds_read_b64_tr_b16 v[134:135], v251 offset:17408
s_waitcnt lgkmcnt(14)
v_mfma_f32_16x16x32_bf16 v[104:107], v[136:139], v[20:23], v[104:107]
ds_read_b64_tr_b16 v[136:137], v250 offset:20480
ds_read_b64_tr_b16 v[138:139], v250 offset:21504
s_waitcnt lgkmcnt(14)
v_mfma_f32_16x16x32_bf16 v[108:111], v[140:143], v[20:23], v[108:111]
ds_read_b64_tr_b16 v[140:141], v251 offset:20480
ds_read_b64_tr_b16 v[142:143], v251 offset:21504
s_waitcnt lgkmcnt(14)
v_mfma_f32_16x16x32_bf16 v[112:115], v[20:23], v[144:147], v[112:115]
ds_read_b64_tr_b16 v[144:145], v250 offset:22528
ds_read_b64_tr_b16 v[146:147], v250 offset:23552
s_waitcnt lgkmcnt(14)
v_mfma_f32_16x16x32_bf16 v[116:119], v[20:23], v[148:151], v[116:119]
ds_read_b64_tr_b16 v[148:149], v251 offset:22528
ds_read_b64_tr_b16 v[150:151], v251 offset:23552
s_waitcnt lgkmcnt(14)
v_mfma_f32_16x16x32_bf16 v[104:107], v[120:123], v[24:27], v[104:107]
s_waitcnt lgkmcnt(12)
v_mfma_f32_16x16x32_bf16 v[108:111], v[124:127], v[24:27], v[108:111]
s_waitcnt lgkmcnt(10)
v_mfma_f32_16x16x32_bf16 v[112:115], v[24:27], v[128:131], v[112:115]
s_waitcnt lgkmcnt(8)
v_mfma_f32_16x16x32_bf16 v[116:119], v[24:27], v[132:135], v[116:119]
s_waitcnt lgkmcnt(6)
v_mfma_f32_16x16x32_bf16 v[104:107], v[136:139], v[28:31], v[104:107]
s_waitcnt lgkmcnt(4)
v_mfma_f32_16x16x32_bf16 v[108:111], v[140:143], v[28:31], v[108:111]
s_waitcnt lgkmcnt(2)
v_mfma_f32_16x16x32_bf16 v[112:115], v[28:31], v[144:147], v[112:115]
s_waitcnt lgkmcnt(0)
v_mfma_f32_16x16x32_bf16 v[116:119], v[28:31], v[148:151], v[116:119]
s_mov_b32 s28, s78
s_and_b32 s29, s79, 0xffff
s_mov_b32 s30, 2097152
s_mov_b32 s31, 0x20000
s_nop 7
L_p1epi:
v_and_b32 v160, 15, v0
v_lshlrev_b32 v160, 2, v160
v_bfe_u32 v161, v0, 4, 1
v_lshlrev_b32 v161, 6, v161
v_add_u32 v160, v160, v161
s_lshl_b32 s52, s42, 8
s_add_u32 s52, s52, 162048
v_add_u32 v160, s52, v160
v_and_b32 v161, 16, v0
v_cmp_eq_u32 vcc, 0, v161
v_lshrrev_b32 v161, 4, v0
v_lshlrev_b32 v161, 4, v161
v_add_u32 v161, s52, v161
v_cndmask_b32 v162, v253, v252, vcc
ds_write_b32 v160, v162 offset:0
v_cndmask_b32 v162, v255, v254, vcc
ds_write_b32 v160, v162 offset:128
v_cndmask_b32 v162, v235, v234, vcc
v_subrev_u32 v163, s52, v160
v_add_u32 v163, 163072, v163
ds_write_b32 v163, v162
ds_read_b128 v[120:123], v161 offset:0
ds_read_b128 v[124:127], v161 offset:64
ds_read_b128 v[128:131], v161 offset:128
ds_read_b128 v[132:135], v161 offset:192
v_lshrrev_b32 v212, 4, v0
v_lshlrev_b32 v212, 4, v212
v_add_u32 v212, 160768, v212
v_and_b32 v213, 15, v0
v_lshlrev_b32 v213, 2, v213
v_add_u32 v213, 161024, v213
s_lshl_b32 s52, s42, 12
s_add_u32 s52, s52, 65536
v_add_u32 v214, s52, v1
s_barrier
ds_write_b128 v214, v[104:107] offset:0
ds_write_b128 v214, v[108:111] offset:1024
ds_write_b128 v214, v[112:115] offset:2048
ds_write_b128 v214, v[116:119] offset:3072
ds_read_b128 v[22:25], v212 offset:128
ds_read_b32 v30, v213 offset:0
ds_read_b128 v[14:17], v212 offset:0
ds_read_b128 v[26:29], v212 offset:192
ds_read_b32 v31, v213 offset:64
ds_read_b128 v[18:21], v212 offset:64
s_waitcnt lgkmcnt(0)
s_barrier
v_pk_mul_f32 v[144:145], v[22:23], v[252:253] op_sel:[0,1] op_sel_hi:[1,1]
v_pk_mul_f32 v[146:147], v[24:25], v[252:253] op_sel:[0,1] op_sel_hi:[1,1]
v_pk_fma_f32 v[144:145], v[72:73], v[252:253], v[144:145] op_sel_hi:[1,0,1] neg_lo:[0,0,1] neg_hi:[0,0,1]
v_pk_fma_f32 v[146:147], v[74:75], v[252:253], v[146:147] op_sel_hi:[1,0,1] neg_lo:[0,0,1] neg_hi:[0,0,1]
v_cvt_pk_bf16_f32 v164, v144, v145
v_cvt_pk_bf16_f32 v165, v146, v147
v_pk_mul_f32 v[148:149], v[22:23], v[254:255] op_sel:[0,1] op_sel_hi:[1,1]
v_pk_mul_f32 v[150:151], v[24:25], v[254:255] op_sel:[0,1] op_sel_hi:[1,1]
v_pk_fma_f32 v[148:149], v[76:77], v[254:255], v[148:149] op_sel_hi:[1,0,1] neg_lo:[0,0,1] neg_hi:[0,0,1]
v_pk_fma_f32 v[150:151], v[78:79], v[254:255], v[150:151] op_sel_hi:[1,0,1] neg_lo:[0,0,1] neg_hi:[0,0,1]
v_cvt_pk_bf16_f32 v166, v148, v149
v_cvt_pk_bf16_f32 v167, v150, v151
v_pk_mul_f32 v[144:145], v[26:27], v[252:253] op_sel:[0,1] op_sel_hi:[1,1]
v_pk_mul_f32 v[146:147], v[28:29], v[252:253] op_sel:[0,1] op_sel_hi:[1,1]
v_pk_fma_f32 v[144:145], v[80:81], v[252:253], v[144:145] op_sel_hi:[1,0,1] neg_lo:[0,0,1] neg_hi:[0,0,1]
v_pk_fma_f32 v[146:147], v[82:83], v[252:253], v[146:147] op_sel_hi:[1,0,1] neg_lo:[0,0,1] neg_hi:[0,0,1]
v_cvt_pk_bf16_f32 v170, v144, v145
v_cvt_pk_bf16_f32 v171, v146, v147
v_pk_mul_f32 v[148:149], v[26:27], v[254:255] op_sel:[0,1] op_sel_hi:[1,1]
v_pk_mul_f32 v[150:151], v[28:29], v[254:255] op_sel:[0,1] op_sel_hi:[1,1]
v_pk_fma_f32 v[148:149], v[84:85], v[254:255], v[148:149] op_sel_hi:[1,0,1] neg_lo:[0,0,1] neg_hi:[0,0,1]
v_pk_fma_f32 v[150:151], v[86:87], v[254:255], v[150:151] op_sel_hi:[1,0,1] neg_lo:[0,0,1] neg_hi:[0,0,1]
v_cvt_pk_bf16_f32 v172, v148, v149
v_cvt_pk_bf16_f32 v173, v150, v151
v_pk_mul_f32 v[144:145], v[124:125], v[30:31] op_sel:[0,0] op_sel_hi:[1,0]
v_pk_mul_f32 v[146:147], v[126:127], v[30:31] op_sel:[0,0] op_sel_hi:[1,0]
v_pk_fma_f32 v[144:145], v[88:89], v[120:121], v[144:145] neg_lo:[0,0,1] neg_hi:[0,0,1]
v_pk_fma_f32 v[146:147], v[90:91], v[122:123], v[146:147] neg_lo:[0,0,1] neg_hi:[0,0,1]
v_cvt_pk_bf16_f32 v178, v144, v145
v_cvt_pk_bf16_f32 v179, v146, v147
v_pk_mul_f32 v[148:149], v[132:133], v[30:31] op_sel:[0,0] op_sel_hi:[1,0]
v_pk_mul_f32 v[150:151], v[134:135], v[30:31] op_sel:[0,0] op_sel_hi:[1,0]
v_pk_fma_f32 v[148:149], v[92:93], v[128:129], v[148:149] neg_lo:[0,0,1] neg_hi:[0,0,1]
v_pk_fma_f32 v[150:151], v[94:95], v[130:131], v[150:151] neg_lo:[0,0,1] neg_hi:[0,0,1]
v_cvt_pk_bf16_f32 v180, v148, v149
v_cvt_pk_bf16_f32 v181, v150, v151
v_pk_mul_f32 v[144:145], v[124:125], v[30:31] op_sel:[0,1] op_sel_hi:[1,1]
v_pk_mul_f32 v[146:147], v[126:127], v[30:31] op_sel:[0,1] op_sel_hi:[1,1]
v_pk_fma_f32 v[144:145], v[96:97], v[120:121], v[144:145] neg_lo:[0,0,1] neg_hi:[0,0,1]
v_pk_fma_f32 v[146:147], v[98:99], v[122:123], v[146:147] neg_lo:[0,0,1] neg_hi:[0,0,1]
v_cvt_pk_bf16_f32 v184, v144, v145
v_cvt_pk_bf16_f32 v185, v146, v147
v_pk_mul_f32 v[148:149], v[132:133], v[30:31] op_sel:[0,1] op_sel_hi:[1,1]
v_pk_mul_f32 v[150:151], v[134:135], v[30:31] op_sel:[0,1] op_sel_hi:[1,1]
v_pk_fma_f32 v[148:149], v[100:101], v[128:129], v[148:149] neg_lo:[0,0,1] neg_hi:[0,0,1]
v_pk_fma_f32 v[150:151], v[102:103], v[130:131], v[150:151] neg_lo:[0,0,1] neg_hi:[0,0,1]
v_cvt_pk_bf16_f32 v186, v148, v149
v_cvt_pk_bf16_f32 v187, v150, v151
s_lshl_b32 s52, s42, 11
s_add_u32 s52, s52, 57344
v_lshlrev_b32 v160, 3, v0
v_add_u32 v160, s52, v160
s_cmp_eq_u32 s42, 3
s_cbranch_scc1 L_w3_8
ds_write_b64 v160, v[166:167] offset:2048
ds_write_b64 v160, v[180:181] offset:3072
ds_write_b64 v160, v[172:173] offset:2560
ds_write_b64 v160, v[186:187] offset:3584
L_w3_8:
v_pk_mul_f32 v[144:145], v[14:15], v[252:253] op_sel:[0,1] op_sel_hi:[1,1]
v_pk_mul_f32 v[146:147], v[16:17], v[252:253] op_sel:[0,1] op_sel_hi:[1,1]
v_pk_fma_f32 v[144:145], v[56:57], v[252:253], v[144:145] op_sel_hi:[1,0,1] neg_lo:[0,0,1] neg_hi:[0,0,1]
v_pk_fma_f32 v[146:147], v[58:59], v[252:253], v[146:147] op_sel_hi:[1,0,1] neg_lo:[0,0,1] neg_hi:[0,0,1]
v_cvt_pk_bf16_f32 v136, v144, v145
v_cvt_pk_bf16_f32 v137, v146, v147
v_pk_mul_f32 v[148:149], v[14:15], v[254:255] op_sel:[0,1] op_sel_hi:[1,1]
v_pk_mul_f32 v[150:151], v[16:17], v[254:255] op_sel:[0,1] op_sel_hi:[1,1]
v_pk_fma_f32 v[148:149], v[60:61], v[254:255], v[148:149] op_sel_hi:[1,0,1] neg_lo:[0,0,1] neg_hi:[0,0,1]
v_pk_fma_f32 v[150:151], v[62:63], v[254:255], v[150:151] op_sel_hi:[1,0,1] neg_lo:[0,0,1] neg_hi:[0,0,1]
v_cvt_pk_bf16_f32 v138, v148, v149
v_cvt_pk_bf16_f32 v139, v150, v151
v_pk_mul_f32 v[144:145], v[18:19], v[252:253] op_sel:[0,1] op_sel_hi:[1,1]
v_pk_mul_f32 v[146:147], v[20:21], v[252:253] op_sel:[0,1] op_sel_hi:[1,1]
v_pk_fma_f32 v[144:145], v[64:65], v[252:253], v[144:145] op_sel_hi:[1,0,1] neg_lo:[0,0,1] neg_hi:[0,0,1]
v_pk_fma_f32 v[146:147], v[66:67], v[252:253], v[146:147] op_sel_hi:[1,0,1] neg_lo:[0,0,1] neg_hi:[0,0,1]
v_cvt_pk_bf16_f32 v140, v144, v145
v_cvt_pk_bf16_f32 v141, v146, v147
v_pk_mul_f32 v[148:149], v[18:19], v[254:255] op_sel:[0,1] op_sel_hi:[1,1]
v_pk_mul_f32 v[150:151], v[20:21], v[254:255] op_sel:[0,1] op_sel_hi:[1,1]
v_pk_fma_f32 v[148:149], v[68:69], v[254:255], v[148:149] op_sel_hi:[1,0,1] neg_lo:[0,0,1] neg_hi:[0,0,1]
v_pk_fma_f32 v[150:151], v[70:71], v[254:255], v[150:151] op_sel_hi:[1,0,1] neg_lo:[0,0,1] neg_hi:[0,0,1]
v_cvt_pk_bf16_f32 v142, v148, v149
v_cvt_pk_bf16_f32 v143, v150, v151
s_waitcnt lgkmcnt(0)
s_barrier
ds_read_b64 v[162:163], v160 offset:0
ds_read_b64 v[176:177], v160 offset:1024
ds_read_b64 v[168:169], v160 offset:512
ds_read_b64 v[182:183], v160 offset:1536
s_mov_b32 s90, 0x3eb8aa3b
s_waitcnt lgkmcnt(3)
v_mfma_f32_16x16x16_bf16 v[72:75], v[162:163], v[136:137], 0
v_mfma_f32_16x16x16_bf16 v[76:79], v[164:165], v[136:137], 0
s_waitcnt lgkmcnt(1)
v_mfma_f32_16x16x16_bf16 v[80:83], v[168:169], v[140:141], 0
v_mfma_f32_16x16x16_bf16 v[84:87], v[170:171], v[140:141], 0
v_mfma_f32_16x16x16_bf16 v[88:91], v[164:165], v[138:139], 0
v_mfma_f32_16x16x16_bf16 v[92:95], v[166:167], v[138:139], 0
v_mfma_f32_16x16x16_bf16 v[96:99], v[170:171], v[142:143], 0
v_mfma_f32_16x16x16_bf16 v[100:103], v[172:173], v[142:143], 0
v_pk_fma_f32 v[72:73], v[72:73], s[90:91], v[40:41] op_sel_hi:[1,0,1]
v_pk_fma_f32 v[76:77], v[76:77], s[90:91], v[32:33] op_sel_hi:[1,0,1]
v_pk_fma_f32 v[74:75], v[74:75], s[90:91], v[42:43] op_sel_hi:[1,0,1]
v_pk_fma_f32 v[78:79], v[78:79], s[90:91], v[34:35] op_sel_hi:[1,0,1]
v_pk_fma_f32 v[80:81], v[80:81], s[90:91], v[40:41] op_sel_hi:[1,0,1]
v_pk_fma_f32 v[84:85], v[84:85], s[90:91], v[32:33] op_sel_hi:[1,0,1]
v_pk_fma_f32 v[82:83], v[82:83], s[90:91], v[42:43] op_sel_hi:[1,0,1]
v_pk_fma_f32 v[86:87], v[86:87], s[90:91], v[34:35] op_sel_hi:[1,0,1]
v_pk_fma_f32 v[88:89], v[88:89], s[90:91], v[36:37] op_sel_hi:[1,0,1]
v_pk_fma_f32 v[92:93], v[92:93], s[90:91], v[32:33] op_sel_hi:[1,0,1]
v_pk_fma_f32 v[90:91], v[90:91], s[90:91], v[38:39] op_sel_hi:[1,0,1]
v_pk_fma_f32 v[94:95], v[94:95], s[90:91], v[34:35] op_sel_hi:[1,0,1]
v_pk_fma_f32 v[96:97], v[96:97], s[90:91], v[36:37] op_sel_hi:[1,0,1]
v_pk_fma_f32 v[100:101], v[100:101], s[90:91], v[32:33] op_sel_hi:[1,0,1]
v_pk_fma_f32 v[98:99], v[98:99], s[90:91], v[38:39] op_sel_hi:[1,0,1]
v_pk_fma_f32 v[102:103], v[102:103], s[90:91], v[34:35] op_sel_hi:[1,0,1]
v_max3_f32 v120, v72, v73, v74
v_max3_f32 v121, v80, v81, v82
v_max3_f32 v122, v88, v89, v90
v_max3_f32 v123, v96, v97, v98
v_max3_f32 v120, v120, v75, v76
v_max3_f32 v121, v121, v83, v84
v_max3_f32 v122, v122, v91, v92
v_max3_f32 v123, v123, v99, v100
v_max3_f32 v120, v120, v77, v78
v_max3_f32 v121, v121, v85, v86
v_max3_f32 v122, v122, v93, v94
v_max3_f32 v123, v123, v101, v102
v_max_f32 v120, v120, v79
v_max_f32 v121, v121, v87
v_max_f32 v122, v122, v95
v_max_f32 v123, v123, v103
v_permlane32_swap_b32 v120, v121
s_nop 0
v_permlane32_swap_b32 v122, v123
v_max_f32 v120, v120, v121
v_max_f32 v122, v122, v123
v_mov_b32 v124, v120
v_mov_b32 v125, v122
s_nop 0
v_permlane16_swap_b32 v124, v120
v_permlane16_swap_b32 v125, v122
v_max_f32 v120, v120, v124
v_max_f32 v122, v122, v125
v_mov_b32 v121, v120
v_mov_b32 v123, v122
s_nop 0
v_permlane32_swap_b32 v120, v121
v_permlane32_swap_b32 v122, v123
v_pk_add_f32 v[72:73], v[72:73], v[120:121] op_sel:[0,0] op_sel_hi:[1,0] neg_lo:[0,1] neg_hi:[0,1]
v_pk_add_f32 v[74:75], v[74:75], v[120:121] op_sel:[0,0] op_sel_hi:[1,0] neg_lo:[0,1] neg_hi:[0,1]
v_pk_add_f32 v[76:77], v[76:77], v[120:121] op_sel:[0,0] op_sel_hi:[1,0] neg_lo:[0,1] neg_hi:[0,1]
v_pk_add_f32 v[78:79], v[78:79], v[120:121] op_sel:[0,0] op_sel_hi:[1,0] neg_lo:[0,1] neg_hi:[0,1]
v_exp_f32 v72, v72
v_exp_f32 v73, v73
v_exp_f32 v74, v74
v_exp_f32 v75, v75
v_exp_f32 v76, v76
v_exp_f32 v77, v77
v_exp_f32 v78, v78
v_exp_f32 v79, v79
v_pk_add_f32 v[80:81], v[80:81], v[120:121] op_sel:[0,1] op_sel_hi:[1,1] neg_lo:[0,1] neg_hi:[0,1]
v_pk_add_f32 v[82:83], v[82:83], v[120:121] op_sel:[0,1] op_sel_hi:[1,1] neg_lo:[0,1] neg_hi:[0,1]
v_pk_add_f32 v[84:85], v[84:85], v[120:121] op_sel:[0,1] op_sel_hi:[1,1] neg_lo:[0,1] neg_hi:[0,1]
v_pk_add_f32 v[86:87], v[86:87], v[120:121] op_sel:[0,1] op_sel_hi:[1,1] neg_lo:[0,1] neg_hi:[0,1]
v_exp_f32 v80, v80
v_exp_f32 v81, v81
v_exp_f32 v82, v82
v_exp_f32 v83, v83
v_exp_f32 v84, v84
v_exp_f32 v85, v85
v_exp_f32 v86, v86
v_exp_f32 v87, v87
v_pk_add_f32 v[88:89], v[88:89], v[122:123] op_sel:[0,0] op_sel_hi:[1,0] neg_lo:[0,1] neg_hi:[0,1]
v_pk_add_f32 v[90:91], v[90:91], v[122:123] op_sel:[0,0] op_sel_hi:[1,0] neg_lo:[0,1] neg_hi:[0,1]
v_pk_add_f32 v[92:93], v[92:93], v[122:123] op_sel:[0,0] op_sel_hi:[1,0] neg_lo:[0,1] neg_hi:[0,1]
v_pk_add_f32 v[94:95], v[94:95], v[122:123] op_sel:[0,0] op_sel_hi:[1,0] neg_lo:[0,1] neg_hi:[0,1]
v_exp_f32 v88, v88
v_exp_f32 v89, v89
v_exp_f32 v90, v90
v_exp_f32 v91, v91
v_exp_f32 v92, v92
v_exp_f32 v93, v93
v_exp_f32 v94, v94
v_exp_f32 v95, v95
v_pk_add_f32 v[96:97], v[96:97], v[122:123] op_sel:[0,1] op_sel_hi:[1,1] neg_lo:[0,1] neg_hi:[0,1]
v_pk_add_f32 v[98:99], v[98:99], v[122:123] op_sel:[0,1] op_sel_hi:[1,1] neg_lo:[0,1] neg_hi:[0,1]
v_pk_add_f32 v[100:101], v[100:101], v[122:123] op_sel:[0,1] op_sel_hi:[1,1] neg_lo:[0,1] neg_hi:[0,1]
v_pk_add_f32 v[102:103], v[102:103], v[122:123] op_sel:[0,1] op_sel_hi:[1,1] neg_lo:[0,1] neg_hi:[0,1]
v_exp_f32 v96, v96
v_exp_f32 v97, v97
v_exp_f32 v98, v98
v_exp_f32 v99, v99
v_exp_f32 v100, v100
v_exp_f32 v101, v101
v_exp_f32 v102, v102
v_exp_f32 v103, v103
v_cvt_pk_bf16_f32 v104, v72, v73
v_cvt_pk_bf16_f32 v105, v74, v75
v_cvt_pk_bf16_f32 v106, v76, v77
v_cvt_pk_bf16_f32 v107, v78, v79
v_cvt_pk_bf16_f32 v108, v80, v81
v_cvt_pk_bf16_f32 v109, v82, v83
v_cvt_pk_bf16_f32 v110, v84, v85
v_cvt_pk_bf16_f32 v111, v86, v87
v_mfma_f32_16x16x32_bf16 v[192:195], v[176:179], v[104:107], 0
s_waitcnt lgkmcnt(0)
v_mfma_f32_16x16x32_bf16 v[196:199], v[182:185], v[108:111], 0
v_cvt_pk_bf16_f32 v112, v88, v89
v_cvt_pk_bf16_f32 v113, v90, v91
v_cvt_pk_bf16_f32 v114, v92, v93
v_cvt_pk_bf16_f32 v115, v94, v95
v_cvt_pk_bf16_f32 v116, v96, v97
v_cvt_pk_bf16_f32 v117, v98, v99
v_cvt_pk_bf16_f32 v118, v100, v101
v_cvt_pk_bf16_f32 v119, v102, v103
v_mfma_f32_16x16x32_bf16 v[200:203], v[178:181], v[112:115], 0
s_nop 0
v_mfma_f32_16x16x32_bf16 v[204:207], v[184:187], v[116:119], 0
v_pk_add_f32 v[132:133], v[72:73], v[74:75]
v_pk_add_f32 v[136:137], v[76:77], v[78:79]
v_pk_add_f32 v[134:135], v[80:81], v[82:83]
v_pk_add_f32 v[138:139], v[84:85], v[86:87]
v_pk_add_f32 v[132:133], v[132:133], v[136:137]
v_pk_add_f32 v[134:135], v[134:135], v[138:139]
v_add_f32 v128, v132, v133
v_add_f32 v129, v134, v135
v_pk_add_f32 v[140:141], v[88:89], v[90:91]
v_pk_add_f32 v[144:145], v[92:93], v[94:95]
v_pk_add_f32 v[142:143], v[96:97], v[98:99]
v_pk_add_f32 v[146:147], v[100:101], v[102:103]
v_pk_add_f32 v[140:141], v[140:141], v[144:145]
v_pk_add_f32 v[142:143], v[142:143], v[146:147]
v_add_f32 v130, v140, v141
v_add_f32 v131, v142, v143
v_permlane32_swap_b32 v128, v129
s_nop 0
v_permlane32_swap_b32 v130, v131
v_add_f32 v128, v128, v129
v_add_f32 v130, v130, v131
v_mov_b32 v124, v128
v_mov_b32 v125, v130
s_nop 0
v_permlane16_swap_b32 v124, v128
v_permlane16_swap_b32 v125, v130
v_add_f32 v128, v128, v124
v_add_f32 v130, v130, v125
v_mov_b32 v129, v128
v_mov_b32 v131, v130
s_nop 0
v_permlane32_swap_b32 v128, v129
v_permlane32_swap_b32 v130, v131
v_rcp_f32 v128, v128
v_rcp_f32 v129, v129
v_rcp_f32 v130, v130
v_rcp_f32 v131, v131
s_lshl_b32 s52, s43, 3
s_lshl_b32 s53, s42, 1
s_add_u32 s52, s52, s53
s_mul_i32 s52, s52, 57344
s_lshl_b32 s53, s44, 10
s_add_u32 s52, s52, s53
s_add_u32 s52, s52, 0x100000
s_add_u32 s53, s52, 57344
v_pk_mul_f32 v[192:193], v[192:193], v[128:129] op_sel:[0,0] op_sel_hi:[1,0]
v_pk_mul_f32 v[194:195], v[194:195], v[128:129] op_sel:[0,0] op_sel_hi:[1,0]
v_cvt_pk_bf16_f32 v208, v192, v193
v_cvt_pk_bf16_f32 v209, v194, v195
v_pk_mul_f32 v[196:197], v[196:197], v[128:129] op_sel:[0,1] op_sel_hi:[1,1]
v_pk_mul_f32 v[198:199], v[198:199], v[128:129] op_sel:[0,1] op_sel_hi:[1,1]
v_cvt_pk_bf16_f32 v210, v196, v197
v_cvt_pk_bf16_f32 v211, v198, v199
buffer_store_dwordx4 v[208:211], v1, s[8:11], s52 offen
v_pk_mul_f32 v[200:201], v[200:201], v[130:131] op_sel:[0,0] op_sel_hi:[1,0]
v_pk_mul_f32 v[202:203], v[202:203], v[130:131] op_sel:[0,0] op_sel_hi:[1,0]
v_cvt_pk_bf16_f32 v212, v200, v201
v_cvt_pk_bf16_f32 v213, v202, v203
v_pk_mul_f32 v[204:205], v[204:205], v[130:131] op_sel:[0,1] op_sel_hi:[1,1]
v_pk_mul_f32 v[206:207], v[206:207], v[130:131] op_sel:[0,1] op_sel_hi:[1,1]
v_cvt_pk_bf16_f32 v214, v204, v205
v_cvt_pk_bf16_f32 v215, v206, v207
buffer_store_dwordx4 v[212:215], v1, s[8:11], s53 offen
s_add_u32 s48, s54, 2
s_waitcnt vmcnt(0)
v_mov_b32 v232, s48
s_mov_b64 exec, 1
buffer_store_dword v232, v2, s[8:11], s85 offen
s_mov_b64 exec, -1
s_lshl_b32 s48, s45, 2
s_add_u32 s48, s48, s42
s_and_b32 s49, s48, 7
s_lshr_b32 s49, s49, 1
s_lshl_b32 s50, s43, 6
s_add_u32 s49, s49, s50
v_and_b32 v233, 15, v0
v_lshlrev_b32 v233, 2, v233
v_add_u32 v233, s49, v233
v_lshlrev_b32 v3, 2, v233
s_add_u32 s51, s54, 2
v_add_u32 v244, 90112, v52
v_add_u32 v245, 90112, v53
v_add_u32 v246, 90112, v54
v_add_u32 v247, 90112, v55
s_lshl_b32 s49, s48, 14
s_lshl_b32 s50, s46, 11
s_add_u32 s50, s50, s49
s_add_u32 s50, s50, 0x10000
s_mul_i32 s49, s48, 57344
s_add_u32 s49, s49, 0x100000
s_waitcnt vmcnt(0) lgkmcnt(0)
s_mov_b32 s86, 0
L_poll_9:
buffer_load_dword v232, v3, s[8:11], 0 offen sc1
s_waitcnt vmcnt(0)
v_cmp_gt_u32 vcc, s51, v232
s_nop 0
s_cbranch_vccz L_pollok_10
s_add_u32 s86, s86, 1
s_cmp_lt_u32 s86, 0x40000
s_cbranch_scc1 L_poll_9
v_mov_b32 v232, 0xdead
s_movk_i32 s86, 252
buffer_store_dword v232, v2, s[36:39], s86 offen sc1
s_waitcnt vmcnt(0)
L_pollok_10:
buffer_load_dwordx4 v[152:155], v1, s[8:11], s49 offen offset:0 sc1
buffer_load_dwordx4 v[156:159], v1, s[8:11], s49 offen offset:1024 sc1
buffer_load_dwordx4 v[160:163], v1, s[8:11], s49 offen offset:2048 sc1
buffer_load_dwordx4 v[164:167], v1, s[8:11], s49 offen offset:3072 sc1
s_add_u32 s49, s49, 4096
buffer_load_dwordx4 v[168:171], v1, s[8:11], s49 offen offset:0 sc1
buffer_load_dwordx4 v[172:175], v1, s[8:11], s49 offen offset:1024 sc1
s_barrier
ds_read_b64_tr_b16 v[120:121], v8 offset:0
ds_read_b64_tr_b16 v[122:123], v8 offset:2048
ds_read_b64_tr_b16 v[124:125], v9 offset:0
ds_read_b64_tr_b16 v[126:127], v9 offset:2048
ds_read_b64_tr_b16 v[128:129], v10 offset:0
ds_read_b64_tr_b16 v[130:131], v10 offset:2048
ds_read_b64_tr_b16 v[132:133], v11 offset:0
ds_read_b64_tr_b16 v[134:135], v11 offset:2048
ds_read_b64_tr_b16 v[136:137], v8 offset:4096
ds_read_b64_tr_b16 v[138:139], v8 offset:6144
ds_read_b64_tr_b16 v[140:141], v9 offset:4096
ds_read_b64_tr_b16 v[142:143], v9 offset:6144
ds_read_b64_tr_b16 v[144:145], v10 offset:4096
ds_read_b64_tr_b16 v[146:147], v10 offset:6144
s_waitcnt vmcnt(5) lgkmcnt(12)
v_mfma_f32_16x16x32_bf16 v[56:59], v[120:123], v[152:155], 0
ds_read_b64_tr_b16 v[148:149], v11 offset:4096
ds_read_b64_tr_b16 v[150:151], v11 offset:6144
s_waitcnt lgkmcnt(12)
v_mfma_f32_16x16x32_bf16 v[60:63], v[124:127], v[152:155], 0
ds_read_b64_tr_b16 v[120:121], v8 offset:8192
ds_read_b64_tr_b16 v[122:123], v8 offset:10240
buffer_load_dwordx4 v[176:179], v1, s[8:11], s49 offen offset:2048 sc1
s_waitcnt lgkmcnt(12)
v_mfma_f32_16x16x32_bf16 v[64:67], v[128:131], v[152:155], 0
ds_read_b64_tr_b16 v[124:125], v9 offset:8192
ds_read_b64_tr_b16 v[126:127], v9 offset:10240
s_waitcnt lgkmcnt(12)
v_mfma_f32_16x16x32_bf16 v[68:71], v[132:135], v[152:155], 0
ds_read_b64_tr_b16 v[128:129], v10 offset:8192
ds_read_b64_tr_b16 v[130:131], v10 offset:10240
buffer_load_dwordx4 v[180:183], v1, s[8:11], s49 offen offset:3072 sc1
s_waitcnt vmcnt(6) lgkmcnt(12)
v_mfma_f32_16x16x32_bf16 v[56:59], v[136:139], v[156:159], v[56:59]
ds_read_b64_tr_b16 v[132:133], v11 offset:8192
ds_read_b64_tr_b16 v[134:135], v11 offset:10240
s_waitcnt lgkmcnt(12)
v_mfma_f32_16x16x32_bf16 v[60:63], v[140:143], v[156:159], v[60:63]
ds_read_b64_tr_b16 v[136:137], v8 offset:12288
ds_read_b64_tr_b16 v[138:139], v8 offset:14336
s_add_u32 s49, s49, 4096
buffer_load_dwordx4 v[184:187], v1, s[8:11], s49 offen offset:0 sc1
s_waitcnt lgkmcnt(12)
v_mfma_f32_16x16x32_bf16 v[64:67], v[144:147], v[156:159], v[64:67]
ds_read_b64_tr_b16 v[140:141], v9 offset:12288
ds_read_b64_tr_b16 v[142:143], v9 offset:14336
s_waitcnt lgkmcnt(12)
v_mfma_f32_16x16x32_bf16 v[68:71], v[148:151], v[156:159], v[68:71]
ds_read_b64_tr_b16 v[144:145], v10 offset:12288
ds_read_b64_tr_b16 v[146:147], v10 offset:14336
buffer_load_dwordx4 v[188:191], v1, s[8:11], s49 offen offset:1024 sc1
s_waitcnt vmcnt(7) lgkmcnt(12)
v_mfma_f32_16x16x32_bf16 v[56:59], v[120:123], v[160:163], v[56:59]
ds_read_b64_tr_b16 v[148:149], v11 offset:12288
ds_read_b64_tr_b16 v[150:151], v11 offset:14336
s_waitcnt lgkmcnt(12)
v_mfma_f32_16x16x32_bf16 v[60:63], v[124:127], v[160:163], v[60:63]
ds_read_b64_tr_b16 v[120:121], v8 offset:16384
ds_read_b64_tr_b16 v[122:123], v8 offset:18432
buffer_load_dwordx4 v[192:195], v1, s[8:11], s49 offen offset:2048 sc1
s_waitcnt lgkmcnt(12)
v_mfma_f32_16x16x32_bf16 v[64:67], v[128:131], v[160:163], v[64:67]
ds_read_b64_tr_b16 v[124:125], v9 offset:16384
ds_read_b64_tr_b16 v[126:127], v9 offset:18432
s_waitcnt lgkmcnt(12)
v_mfma_f32_16x16x32_bf16 v[68:71], v[132:135], v[160:163], v[68:71]
ds_read_b64_tr_b16 v[128:129], v10 offset:16384
ds_read_b64_tr_b16 v[130:131], v10 offset:18432
buffer_load_dwordx4 v[196:199], v1, s[8:11], s49 offen offset:3072 sc1
s_waitcnt vmcnt(8) lgkmcnt(12)
v_mfma_f32_16x16x32_bf16 v[56:59], v[136:139], v[164:167], v[56:59]
ds_read_b64_tr_b16 v[132:133], v11 offset:16384
ds_read_b64_tr_b16 v[134:135], v11 offset:18432
s_waitcnt lgkmcnt(12)
v_mfma_f32_16x16x32_bf16 v[60:63], v[140:143], v[164:167], v[60:63]
ds_read_b64_tr_b16 v[136:137], v8 offset:20480
ds_read_b64_tr_b16 v[138:139], v8 offset:22528
s_add_u32 s49, s49, 4096
buffer_load_dwordx4 v[200:203], v1, s[8:11], s49 offen offset:0 sc1
s_waitcnt lgkmcnt(12)
v_mfma_f32_16x16x32_bf16 v[64:67], v[144:147], v[164:167], v[64:67]
ds_read_b64_tr_b16 v[140:141], v9 offset:20480
ds_read_b64_tr_b16 v[142:143], v9 offset:22528
s_waitcnt lgkmcnt(12)
v_mfma_f32_16x16x32_bf16 v[68:71], v[148:151], v[164:167], v[68:71]
ds_read_b64_tr_b16 v[144:145], v10 offset:20480
ds_read_b64_tr_b16 v[146:147], v10 offset:22528
buffer_load_dwordx4 v[204:207], v1, s[8:11], s49 offen offset:1024 sc1
s_waitcnt vmcnt(9) lgkmcnt(12)
v_mfma_f32_16x16x32_bf16 v[56:59], v[120:123], v[168:171], v[56:59]
ds_read_b64_tr_b16 v[148:149], v11 offset:20480
ds_read_b64_tr_b16 v[150:151], v11 offset:22528
s_waitcnt lgkmcnt(12)
v_mfma_f32_16x16x32_bf16 v[60:63], v[124:127], v[168:171], v[60:63]
ds_read_b64_tr_b16 v[120:121], v8 offset:24576
ds_read_b64_tr_b16 v[122:123], v8 offset:26624
buffer_load_dwordx4 v[208:211], v1, s[8:11], s49 offen offset:2048 sc1
s_waitcnt lgkmcnt(12)
v_mfma_f32_16x16x32_bf16 v[64:67], v[128:131], v[168:171], v[64:67]
ds_read_b64_tr_b16 v[124:125], v9 offset:24576
ds_read_b64_tr_b16 v[126:127], v9 offset:26624
s_waitcnt lgkmcnt(12)
v_mfma_f32_16x16x32_bf16 v[68:71], v[132:135], v[168:171], v[68:71]
ds_read_b64_tr_b16 v[128:129], v10 offset:24576
ds_read_b64_tr_b16 v[130:131], v10 offset:26624
buffer_load_dwordx4 v[212:215], v1, s[8:11], s49 offen offset:3072 sc1
s_waitcnt vmcnt(10) lgkmcnt(12)
v_mfma_f32_16x16x32_bf16 v[56:59], v[136:139], v[172:175], v[56:59]
ds_read_b64_tr_b16 v[132:133], v11 offset:24576
ds_read_b64_tr_b16 v[134:135], v11 offset:26624
s_waitcnt lgkmcnt(12)
v_mfma_f32_16x16x32_bf16 v[60:63], v[140:143], v[172:175], v[60:63]
ds_read_b64_tr_b16 v[136:137], v8 offset:28672
ds_read_b64_tr_b16 v[138:139], v8 offset:30720
s_cmp_lg_u32 s47, 0
s_cbranch_scc1 L_res0_11
v_and_b32 v248, 15, v0
v_lshlrev_b32 v248, 10, v248
v_lshrrev_b32 v249, 4, v0
v_lshlrev_b32 v249, 3, v249
v_add_u32 v248, v248, v249
s_lshl_b32 s52, s40, 4
s_add_u32 s52, s52, s48
s_lshl_b32 s52, s52, 14
s_lshl_b32 s53, s46, 7
s_add_u32 s52, s52, s53
buffer_load_dwordx2 v[44:45], v248, s[12:15], s52 offen offset:0
buffer_load_dwordx2 v[46:47], v248, s[12:15], s52 offen offset:32
buffer_load_dwordx2 v[48:49], v248, s[12:15], s52 offen offset:64
buffer_load_dwordx2 v[50:51], v248, s[12:15], s52 offen offset:96
s_branch L_res1_12
L_res0_11:
buffer_load_dwordx4 v[44:47], v1, s[8:11], s50 offen sc1
buffer_load_dwordx4 v[48:51], v1, s[8:11], s50 offen offset:1024 sc1
L_res1_12:
s_barrier
s_waitcnt lgkmcnt(12)
v_mfma_f32_16x16x32_bf16 v[64:67], v[144:147], v[172:175], v[64:67]
ds_read_b64_tr_b16 v[140:141], v9 offset:28672
ds_read_b64_tr_b16 v[142:143], v9 offset:30720
s_waitcnt lgkmcnt(12)
v_mfma_f32_16x16x32_bf16 v[68:71], v[148:151], v[172:175], v[68:71]
ds_read_b64_tr_b16 v[144:145], v10 offset:28672
ds_read_b64_tr_b16 v[146:147], v10 offset:30720
s_waitcnt vmcnt(11) lgkmcnt(12)
v_mfma_f32_16x16x32_bf16 v[56:59], v[120:123], v[176:179], v[56:59]
ds_read_b64_tr_b16 v[148:149], v11 offset:28672
ds_read_b64_tr_b16 v[150:151], v11 offset:30720
s_waitcnt lgkmcnt(12)
v_mfma_f32_16x16x32_bf16 v[60:63], v[124:127], v[176:179], v[60:63]
ds_read_b64_tr_b16 v[120:121], v8 offset:32768
ds_read_b64_tr_b16 v[122:123], v8 offset:34816
s_waitcnt lgkmcnt(12)
v_mfma_f32_16x16x32_bf16 v[64:67], v[128:131], v[176:179], v[64:67]
ds_read_b64_tr_b16 v[124:125], v9 offset:32768
ds_read_b64_tr_b16 v[126:127], v9 offset:34816
s_waitcnt lgkmcnt(12)
v_mfma_f32_16x16x32_bf16 v[68:71], v[132:135], v[176:179], v[68:71]
ds_read_b64_tr_b16 v[128:129], v10 offset:32768
ds_read_b64_tr_b16 v[130:131], v10 offset:34816
s_waitcnt vmcnt(10) lgkmcnt(12)
v_mfma_f32_16x16x32_bf16 v[56:59], v[136:139], v[180:183], v[56:59]
ds_read_b64_tr_b16 v[132:133], v11 offset:32768
ds_read_b64_tr_b16 v[134:135], v11 offset:34816
s_waitcnt lgkmcnt(12)
v_mfma_f32_16x16x32_bf16 v[60:63], v[140:143], v[180:183], v[60:63]
ds_read_b64_tr_b16 v[136:137], v8 offset:36864
ds_read_b64_tr_b16 v[138:139], v8 offset:38912
s_waitcnt lgkmcnt(12)
v_mfma_f32_16x16x32_bf16 v[64:67], v[144:147], v[180:183], v[64:67]
ds_read_b64_tr_b16 v[140:141], v9 offset:36864
ds_read_b64_tr_b16 v[142:143], v9 offset:38912
s_waitcnt lgkmcnt(12)
v_mfma_f32_16x16x32_bf16 v[68:71], v[148:151], v[180:183], v[68:71]
ds_read_b64_tr_b16 v[144:145], v10 offset:36864
ds_read_b64_tr_b16 v[146:147], v10 offset:38912
s_waitcnt vmcnt(9) lgkmcnt(12)
v_mfma_f32_16x16x32_bf16 v[56:59], v[120:123], v[184:187], v[56:59]
ds_read_b64_tr_b16 v[148:149], v11 offset:36864
ds_read_b64_tr_b16 v[150:151], v11 offset:38912
s_waitcnt lgkmcnt(12)
v_mfma_f32_16x16x32_bf16 v[60:63], v[124:127], v[184:187], v[60:63]
ds_read_b64_tr_b16 v[120:121], v8 offset:40960
ds_read_b64_tr_b16 v[122:123], v8 offset:43008
s_waitcnt lgkmcnt(12)
v_mfma_f32_16x16x32_bf16 v[64:67], v[128:131], v[184:187], v[64:67]
ds_read_b64_tr_b16 v[124:125], v9 offset:40960
ds_read_b64_tr_b16 v[126:127], v9 offset:43008
s_waitcnt lgkmcnt(12)
v_mfma_f32_16x16x32_bf16 v[68:71], v[132:135], v[184:187], v[68:71]
ds_read_b64_tr_b16 v[128:129], v10 offset:40960
ds_read_b64_tr_b16 v[130:131], v10 offset:43008
s_waitcnt vmcnt(8) lgkmcnt(12)
v_mfma_f32_16x16x32_bf16 v[56:59], v[136:139], v[188:191], v[56:59]
ds_read_b64_tr_b16 v[132:133], v11 offset:40960
ds_read_b64_tr_b16 v[134:135], v11 offset:43008
s_waitcnt lgkmcnt(12)
v_mfma_f32_16x16x32_bf16 v[60:63], v[140:143], v[188:191], v[60:63]
ds_read_b64_tr_b16 v[136:137], v8 offset:45056
ds_read_b64_tr_b16 v[138:139], v8 offset:47104
s_waitcnt lgkmcnt(12)
v_mfma_f32_16x16x32_bf16 v[64:67], v[144:147], v[188:191], v[64:67]
ds_read_b64_tr_b16 v[140:141], v9 offset:45056
ds_read_b64_tr_b16 v[142:143], v9 offset:47104
s_waitcnt lgkmcnt(12)
v_mfma_f32_16x16x32_bf16 v[68:71], v[148:151], v[188:191], v[68:71]
ds_read_b64_tr_b16 v[144:145], v10 offset:45056
ds_read_b64_tr_b16 v[146:147], v10 offset:47104
s_waitcnt vmcnt(7) lgkmcnt(12)
v_mfma_f32_16x16x32_bf16 v[56:59], v[120:123], v[192:195], v[56:59]
ds_read_b64_tr_b16 v[148:149], v11 offset:45056
ds_read_b64_tr_b16 v[150:151], v11 offset:47104
s_waitcnt lgkmcnt(12)
v_mfma_f32_16x16x32_bf16 v[60:63], v[124:127], v[192:195], v[60:63]
ds_read_b64_tr_b16 v[120:121], v8 offset:49152
ds_read_b64_tr_b16 v[122:123], v8 offset:51200
s_waitcnt lgkmcnt(12)
v_mfma_f32_16x16x32_bf16 v[64:67], v[128:131], v[192:195], v[64:67]
ds_read_b64_tr_b16 v[124:125], v9 offset:49152
ds_read_b64_tr_b16 v[126:127], v9 offset:51200
s_waitcnt lgkmcnt(12)
v_mfma_f32_16x16x32_bf16 v[68:71], v[132:135], v[192:195], v[68:71]
ds_read_b64_tr_b16 v[128:129], v10 offset:49152
ds_read_b64_tr_b16 v[130:131], v10 offset:51200
s_waitcnt vmcnt(6) lgkmcnt(12)
v_mfma_f32_16x16x32_bf16 v[56:59], v[136:139], v[196:199], v[56:59]
ds_read_b64_tr_b16 v[132:133], v11 offset:49152
ds_read_b64_tr_b16 v[134:135], v11 offset:51200
s_waitcnt lgkmcnt(12)
v_mfma_f32_16x16x32_bf16 v[60:63], v[140:143], v[196:199], v[60:63]
ds_read_b64_tr_b16 v[136:137], v8 offset:53248
ds_read_b64_tr_b16 v[138:139], v8 offset:55296
s_waitcnt lgkmcnt(12)
v_mfma_f32_16x16x32_bf16 v[64:67], v[144:147], v[196:199], v[64:67]
ds_read_b64_tr_b16 v[140:141], v9 offset:53248
ds_read_b64_tr_b16 v[142:143], v9 offset:55296
s_waitcnt lgkmcnt(12)
v_mfma_f32_16x16x32_bf16 v[68:71], v[148:151], v[196:199], v[68:71]
ds_read_b64_tr_b16 v[144:145], v10 offset:53248
ds_read_b64_tr_b16 v[146:147], v10 offset:55296
s_waitcnt vmcnt(5) lgkmcnt(12)
v_mfma_f32_16x16x32_bf16 v[56:59], v[120:123], v[200:203], v[56:59]
ds_read_b64_tr_b16 v[148:149], v11 offset:53248
ds_read_b64_tr_b16 v[150:151], v11 offset:55296
s_waitcnt lgkmcnt(12)
v_mfma_f32_16x16x32_bf16 v[60:63], v[124:127], v[200:203], v[60:63]
ds_read_b64_tr_b16 v[120:121], v8 offset:57344
ds_read_b64_tr_b16 v[122:123], v8 offset:59392
s_waitcnt lgkmcnt(12)
v_mfma_f32_16x16x32_bf16 v[64:67], v[128:131], v[200:203], v[64:67]
ds_read_b64_tr_b16 v[124:125], v9 offset:57344
ds_read_b64_tr_b16 v[126:127], v9 offset:59392
s_waitcnt lgkmcnt(12)
v_mfma_f32_16x16x32_bf16 v[68:71], v[132:135], v[200:203], v[68:71]
ds_read_b64_tr_b16 v[128:129], v10 offset:57344
ds_read_b64_tr_b16 v[130:131], v10 offset:59392
s_waitcnt vmcnt(4) lgkmcnt(12)
v_mfma_f32_16x16x32_bf16 v[56:59], v[136:139], v[204:207], v[56:59]
ds_read_b64_tr_b16 v[132:133], v11 offset:57344
ds_read_b64_tr_b16 v[134:135], v11 offset:59392
s_waitcnt lgkmcnt(12)
v_mfma_f32_16x16x32_bf16 v[60:63], v[140:143], v[204:207], v[60:63]
ds_read_b64_tr_b16 v[136:137], v244 offset:0
ds_read_b64_tr_b16 v[138:139], v244 offset:2048
s_waitcnt lgkmcnt(12)
v_mfma_f32_16x16x32_bf16 v[64:67], v[144:147], v[204:207], v[64:67]
ds_read_b64_tr_b16 v[140:141], v245 offset:0
ds_read_b64_tr_b16 v[142:143], v245 offset:2048
s_waitcnt lgkmcnt(12)
v_mfma_f32_16x16x32_bf16 v[68:71], v[148:151], v[204:207], v[68:71]
ds_read_b64_tr_b16 v[144:145], v246 offset:0
ds_read_b64_tr_b16 v[146:147], v246 offset:2048
s_waitcnt vmcnt(3) lgkmcnt(12)
v_mfma_f32_16x16x32_bf16 v[56:59], v[120:123], v[208:211], v[56:59]
ds_read_b64_tr_b16 v[148:149], v247 offset:0
ds_read_b64_tr_b16 v[150:151], v247 offset:2048
s_waitcnt lgkmcnt(12)
v_mfma_f32_16x16x32_bf16 v[60:63], v[124:127], v[208:211], v[60:63]
s_waitcnt lgkmcnt(10)
v_mfma_f32_16x16x32_bf16 v[64:67], v[128:131], v[208:211], v[64:67]
s_waitcnt lgkmcnt(8)
v_mfma_f32_16x16x32_bf16 v[68:71], v[132:135], v[208:211], v[68:71]
s_waitcnt vmcnt(2) lgkmcnt(6)
v_mfma_f32_16x16x32_bf16 v[56:59], v[136:139], v[212:215], v[56:59]
s_waitcnt lgkmcnt(4)
v_mfma_f32_16x16x32_bf16 v[60:63], v[140:143], v[212:215], v[60:63]
s_waitcnt lgkmcnt(2)
v_mfma_f32_16x16x32_bf16 v[64:67], v[144:147], v[212:215], v[64:67]
s_waitcnt lgkmcnt(0)
v_mfma_f32_16x16x32_bf16 v[68:71], v[148:151], v[212:215], v[68:71]
s_barrier
s_waitcnt vmcnt(0)
v_lshlrev_b32 v236, 16, v44
v_and_b32 v237, 0xffff0000, v44
v_lshlrev_b32 v238, 16, v45
v_and_b32 v239, 0xffff0000, v45
v_pk_add_f32 v[236:237], v[236:237], v[56:57]
v_pk_add_f32 v[238:239], v[238:239], v[58:59]
v_cvt_pk_bf16_f32 v44, v236, v237
v_cvt_pk_bf16_f32 v45, v238, v239
v_lshlrev_b32 v236, 16, v46
v_and_b32 v237, 0xffff0000, v46
v_lshlrev_b32 v238, 16, v47
v_and_b32 v239, 0xffff0000, v47
v_pk_add_f32 v[236:237], v[236:237], v[60:61]
v_pk_add_f32 v[238:239], v[238:239], v[62:63]
v_cvt_pk_bf16_f32 v46, v236, v237
v_cvt_pk_bf16_f32 v47, v238, v239
v_lshlrev_b32 v236, 16, v48
v_and_b32 v237, 0xffff0000, v48
v_lshlrev_b32 v238, 16, v49
v_and_b32 v239, 0xffff0000, v49
v_pk_add_f32 v[236:237], v[236:237], v[64:65]
v_pk_add_f32 v[238:239], v[238:239], v[66:67]
v_cvt_pk_bf16_f32 v48, v236, v237
v_cvt_pk_bf16_f32 v49, v238, v239
v_lshlrev_b32 v236, 16, v50
v_and_b32 v237, 0xffff0000, v50
v_lshlrev_b32 v238, 16, v51
v_and_b32 v239, 0xffff0000, v51
v_pk_add_f32 v[236:237], v[236:237], v[68:69]
v_pk_add_f32 v[238:239], v[238:239], v[70:71]
v_cvt_pk_bf16_f32 v50, v236, v237
v_cvt_pk_bf16_f32 v51, v238, v239
s_lshl_b32 s52, s45, 2
s_add_u32 s52, s52, s42
s_lshl_b32 s48, s52, 14
s_lshl_b32 s49, s46, 11
s_add_u32 s48, s48, s49
s_add_u32 s48, s48, 0x10000
buffer_store_dwordx4 v[44:47], v1, s[8:11], s48 offen
buffer_store_dwordx4 v[48:51], v1, s[8:11], s48 offen offset:1024
v_dot2_f32_bf16 v240, v44, s89, 0
v_dot2_f32_bf16 v241, v44, v44, 0
v_dot2_f32_bf16 v240, v45, s89, v240
v_dot2_f32_bf16 v241, v45, v45, v241
v_dot2_f32_bf16 v240, v46, s89, v240
v_dot2_f32_bf16 v241, v46, v46, v241
v_dot2_f32_bf16 v240, v47, s89, v240
v_dot2_f32_bf16 v241, v47, v47, v241
v_dot2_f32_bf16 v240, v48, s89, v240
v_dot2_f32_bf16 v241, v48, v48, v241
v_dot2_f32_bf16 v240, v49, s89, v240
v_dot2_f32_bf16 v241, v49, v49, v241
v_dot2_f32_bf16 v240, v50, s89, v240
v_dot2_f32_bf16 v241, v50, v50, v241
v_dot2_f32_bf16 v240, v51, s89, v240
v_dot2_f32_bf16 v241, v51, v51, v241
s_nop 2
v_permlane32_swap_b32 v240, v241
v_add_f32 v240, v240, v241
v_mov_b32 v242, v240
s_nop 1
v_permlane16_swap_b32 v242, v240
v_add_f32 v240, v240, v242
s_lshl_b32 s49, s52, 10
s_add_u32 s49, s49, 0x50000
buffer_store_dword v240, v4, s[8:11], s49 offen
s_add_u32 s48, s54, 3
s_waitcnt vmcnt(0)
v_mov_b32 v232, s48
s_mov_b64 exec, 1
buffer_store_dword v232, v2, s[8:11], s85 offen
s_mov_b64 exec, -1
s_lshl_b32 s48, s43, 3
s_lshl_b32 s49, s42, 1
s_add_u32 s48, s48, s49
s_lshr_b32 s49, s48, 2
s_lshl_b32 s49, s49, 3
s_and_b32 s48, s48, 3
s_lshl_b32 s49, s49, 2
s_add_u32 s48, s48, s49
v_and_b32 v233, 7, v0
v_lshlrev_b32 v233, 2, v233
v_bfe_u32 v234, v0, 3, 1
v_add_u32 v233, v233, v234
v_add_u32 v233, s48, v233
v_lshlrev_b32 v3, 2, v233
s_add_u32 s51, s54, 3
v_add_u32 v244, 64512, v12
s_lshl_b32 s52, s43, 3
s_lshl_b32 s53, s42, 1
s_add_u32 s52, s52, s53
s_lshl_b32 s48, s52, 14
s_add_u32 s48, s48, 0x10000
s_add_u32 s49, s48, 16384
s_lshl_b32 s50, s52, 10
s_add_u32 s50, s50, 0x50000
s_waitcnt vmcnt(0) lgkmcnt(0)
s_mov_b32 s86, 0
L_poll_13:
buffer_load_dword v232, v3, s[8:11], 0 offen sc1
s_waitcnt vmcnt(0)
v_cmp_gt_u32 vcc, s51, v232
s_nop 0
s_cbranch_vccz L_pollok_14
s_add_u32 s86, s86, 1
s_cmp_lt_u32 s86, 0x40000
s_cbranch_scc1 L_poll_13
v_mov_b32 v232, 0xdead
s_movk_i32 s86, 252
buffer_store_dword v232, v2, s[36:39], s86 offen sc1
s_waitcnt vmcnt(0)
L_pollok_14:
buffer_load_dwordx4 v[152:155], v1, s[8:11], s48 offen offset:0 sc1
buffer_load_dwordx4 v[156:159], v1, s[8:11], s49 offen offset:0 sc1
buffer_load_dwordx4 v[160:163], v1, s[8:11], s48 offen offset:1024 sc1
buffer_load_dwordx4 v[164:167], v1, s[8:11], s49 offen offset:1024 sc1
s_barrier
ds_read_b64_tr_b16 v[120:121], v12 offset:0
ds_read_b64_tr_b16 v[122:123], v12 offset:3584
ds_read_b64_tr_b16 v[124:125], v12 offset:32
ds_read_b64_tr_b16 v[126:127], v12 offset:3616
ds_read_b64_tr_b16 v[128:129], v12 offset:64
ds_read_b64_tr_b16 v[130:131], v12 offset:3648
ds_read_b64_tr_b16 v[132:133], v12 offset:96
ds_read_b64_tr_b16 v[134:135], v12 offset:3680
ds_read_b64_tr_b16 v[136:137], v12 offset:128
ds_read_b64_tr_b16 v[138:139], v12 offset:3712
ds_read_b64_tr_b16 v[140:141], v12 offset:160
ds_read_b64_tr_b16 v[142:143], v12 offset:3744
ds_read_b64_tr_b16 v[144:145], v12 offset:192
ds_read_b64_tr_b16 v[146:147], v12 offset:3776
s_waitcnt vmcnt(3) lgkmcnt(12)
v_mfma_f32_16x16x32_bf16 v[56:59], v[120:123], v[152:155], 0
s_waitcnt vmcnt(2)
v_mfma_f32_16x16x32_bf16 v[60:63], v[120:123], v[156:159], 0
ds_read_b64_tr_b16 v[120:121], v12 offset:7168
buffer_load_dwordx4 v[168:171], v1, s[8:11], s48 offen offset:2048 sc1
s_waitcnt lgkmcnt(11)
v_mfma_f32_16x16x32_bf16 v[64:67], v[124:127], v[152:155], 0
ds_read_b64_tr_b16 v[122:123], v12 offset:10752
v_mfma_f32_16x16x32_bf16 v[68:71], v[124:127], v[156:159], 0
ds_read_b64_tr_b16 v[124:125], v12 offset:7200
s_waitcnt lgkmcnt(11)
v_mfma_f32_16x16x32_bf16 v[72:75], v[128:131], v[152:155], 0
ds_read_b64_tr_b16 v[126:127], v12 offset:10784
v_mfma_f32_16x16x32_bf16 v[76:79], v[128:131], v[156:159], 0
ds_read_b64_tr_b16 v[128:129], v12 offset:7232
s_waitcnt lgkmcnt(11)
v_mfma_f32_16x16x32_bf16 v[80:83], v[132:135], v[152:155], 0
ds_read_b64_tr_b16 v[130:131], v12 offset:10816
v_mfma_f32_16x16x32_bf16 v[84:87], v[132:135], v[156:159], 0
ds_read_b64_tr_b16 v[132:133], v12 offset:7264
buffer_load_dwordx4 v[172:175], v1, s[8:11], s49 offen offset:2048 sc1
s_waitcnt lgkmcnt(11)
v_mfma_f32_16x16x32_bf16 v[88:91], v[136:139], v[152:155], 0
ds_read_b64_tr_b16 v[134:135], v12 offset:10848
v_mfma_f32_16x16x32_bf16 v[92:95], v[136:139], v[156:159], 0
ds_read_b64_tr_b16 v[136:137], v12 offset:7296
s_waitcnt lgkmcnt(11)
v_mfma_f32_16x16x32_bf16 v[96:99], v[140:143], v[152:155], 0
ds_read_b64_tr_b16 v[138:139], v12 offset:10880
v_mfma_f32_16x16x32_bf16 v[100:103], v[140:143], v[156:159], 0
ds_read_b64_tr_b16 v[140:141], v12 offset:7328
s_waitcnt lgkmcnt(11)
v_mfma_f32_16x16x32_bf16 v[104:107], v[144:147], v[152:155], 0
ds_read_b64_tr_b16 v[142:143], v12 offset:10912
v_mfma_f32_16x16x32_bf16 v[108:111], v[144:147], v[156:159], 0
ds_read_b64_tr_b16 v[144:145], v12 offset:7360
s_waitcnt vmcnt(3) lgkmcnt(11)
v_mfma_f32_16x16x32_bf16 v[56:59], v[120:123], v[160:163], v[56:59]
ds_read_b64_tr_b16 v[146:147], v12 offset:10944
s_waitcnt vmcnt(2)
v_mfma_f32_16x16x32_bf16 v[60:63], v[120:123], v[164:167], v[60:63]
ds_read_b64_tr_b16 v[120:121], v12 offset:14336
buffer_load_dwordx4 v[176:179], v1, s[8:11], s48 offen offset:3072 sc1
s_waitcnt lgkmcnt(11)
v_mfma_f32_16x16x32_bf16 v[64:67], v[124:127], v[160:163], v[64:67]
ds_read_b64_tr_b16 v[122:123], v12 offset:17920
v_mfma_f32_16x16x32_bf16 v[68:71], v[124:127], v[164:167], v[68:71]
ds_read_b64_tr_b16 v[124:125], v12 offset:14368
buffer_load_dwordx4 v[180:183], v1, s[8:11], s49 offen offset:3072 sc1
s_waitcnt lgkmcnt(11)
v_mfma_f32_16x16x32_bf16 v[72:75], v[128:131], v[160:163], v[72:75]
ds_read_b64_tr_b16 v[126:127], v12 offset:17952
v_mfma_f32_16x16x32_bf16 v[76:79], v[128:131], v[164:167], v[76:79]
ds_read_b64_tr_b16 v[128:129], v12 offset:14400
s_add_u32 s48, s48, 4096
s_waitcnt lgkmcnt(11)
v_mfma_f32_16x16x32_bf16 v[80:83], v[132:135], v[160:163], v[80:83]
ds_read_b64_tr_b16 v[130:131], v12 offset:17984
v_mfma_f32_16x16x32_bf16 v[84:87], v[132:135], v[164:167], v[84:87]
ds_read_b64_tr_b16 v[132:133], v12 offset:14432
s_add_u32 s49, s49, 4096
s_waitcnt lgkmcnt(11)
v_mfma_f32_16x16x32_bf16 v[88:91], v[136:139], v[160:163], v[88:91]
ds_read_b64_tr_b16 v[134:135], v12 offset:18016
v_mfma_f32_16x16x32_bf16 v[92:95], v[136:139], v[164:167], v[92:95]
ds_read_b64_tr_b16 v[136:137], v12 offset:14464
buffer_load_dwordx4 v[184:187], v1, s[8:11], s48 offen offset:0 sc1
s_waitcnt lgkmcnt(11)
v_mfma_f32_16x16x32_bf16 v[96:99], v[140:143], v[160:163], v[96:99]
ds_read_b64_tr_b16 v[138:139], v12 offset:18048
v_mfma_f32_16x16x32_bf16 v[100:103], v[140:143], v[164:167], v[100:103]
ds_read_b64_tr_b16 v[140:141], v12 offset:14496
buffer_load_dwordx4 v[188:191], v1, s[8:11], s49 offen offset:0 sc1
s_waitcnt lgkmcnt(11)
v_mfma_f32_16x16x32_bf16 v[104:107], v[144:147], v[160:163], v[104:107]
ds_read_b64_tr_b16 v[142:143], v12 offset:18080
v_mfma_f32_16x16x32_bf16 v[108:111], v[144:147], v[164:167], v[108:111]
ds_read_b64_tr_b16 v[144:145], v12 offset:14528
s_waitcnt vmcnt(5) lgkmcnt(11)
v_mfma_f32_16x16x32_bf16 v[56:59], v[120:123], v[168:171], v[56:59]
ds_read_b64_tr_b16 v[146:147], v12 offset:18112
s_waitcnt vmcnt(4)
v_mfma_f32_16x16x32_bf16 v[60:63], v[120:123], v[172:175], v[60:63]
ds_read_b64_tr_b16 v[120:121], v12 offset:21504
buffer_load_dwordx4 v[192:195], v1, s[8:11], s48 offen offset:1024 sc1
s_waitcnt lgkmcnt(11)
v_mfma_f32_16x16x32_bf16 v[64:67], v[124:127], v[168:171], v[64:67]
ds_read_b64_tr_b16 v[122:123], v12 offset:25088
v_mfma_f32_16x16x32_bf16 v[68:71], v[124:127], v[172:175], v[68:71]
ds_read_b64_tr_b16 v[124:125], v12 offset:21536
s_waitcnt lgkmcnt(11)
v_mfma_f32_16x16x32_bf16 v[72:75], v[128:131], v[168:171], v[72:75]
ds_read_b64_tr_b16 v[126:127], v12 offset:25120
v_mfma_f32_16x16x32_bf16 v[76:79], v[128:131], v[172:175], v[76:79]
ds_read_b64_tr_b16 v[128:129], v12 offset:21568
s_waitcnt lgkmcnt(11)
v_mfma_f32_16x16x32_bf16 v[80:83], v[132:135], v[168:171], v[80:83]
ds_read_b64_tr_b16 v[130:131], v12 offset:25152
v_mfma_f32_16x16x32_bf16 v[84:87], v[132:135], v[172:175], v[84:87]
ds_read_b64_tr_b16 v[132:133], v12 offset:21600
buffer_load_dwordx4 v[196:199], v1, s[8:11], s49 offen offset:1024 sc1
s_waitcnt lgkmcnt(11)
v_mfma_f32_16x16x32_bf16 v[88:91], v[136:139], v[168:171], v[88:91]
ds_read_b64_tr_b16 v[134:135], v12 offset:25184
v_mfma_f32_16x16x32_bf16 v[92:95], v[136:139], v[172:175], v[92:95]
ds_read_b64_tr_b16 v[136:137], v12 offset:21632
s_waitcnt lgkmcnt(11)
v_mfma_f32_16x16x32_bf16 v[96:99], v[140:143], v[168:171], v[96:99]
ds_read_b64_tr_b16 v[138:139], v12 offset:25216
v_mfma_f32_16x16x32_bf16 v[100:103], v[140:143], v[172:175], v[100:103]
ds_read_b64_tr_b16 v[140:141], v12 offset:21664
s_waitcnt lgkmcnt(11)
v_mfma_f32_16x16x32_bf16 v[104:107], v[144:147], v[168:171], v[104:107]
ds_read_b64_tr_b16 v[142:143], v12 offset:25248
v_mfma_f32_16x16x32_bf16 v[108:111], v[144:147], v[172:175], v[108:111]
ds_read_b64_tr_b16 v[144:145], v12 offset:21696
s_waitcnt vmcnt(5) lgkmcnt(11)
v_mfma_f32_16x16x32_bf16 v[56:59], v[120:123], v[176:179], v[56:59]
ds_read_b64_tr_b16 v[146:147], v12 offset:25280
s_waitcnt vmcnt(4)
v_mfma_f32_16x16x32_bf16 v[60:63], v[120:123], v[180:183], v[60:63]
ds_read_b64_tr_b16 v[120:121], v12 offset:28672
buffer_load_dwordx4 v[200:203], v1, s[8:11], s48 offen offset:2048 sc1
s_waitcnt lgkmcnt(11)
v_mfma_f32_16x16x32_bf16 v[64:67], v[124:127], v[176:179], v[64:67]
ds_read_b64_tr_b16 v[122:123], v12 offset:32256
v_mfma_f32_16x16x32_bf16 v[68:71], v[124:127], v[180:183], v[68:71]
ds_read_b64_tr_b16 v[124:125], v12 offset:28704
s_waitcnt lgkmcnt(11)
v_mfma_f32_16x16x32_bf16 v[72:75], v[128:131], v[176:179], v[72:75]
ds_read_b64_tr_b16 v[126:127], v12 offset:32288
buffer_load_dwordx4 v[204:207], v1, s[8:11], s49 offen offset:2048 sc1
v_mfma_f32_16x16x32_bf16 v[76:79], v[128:131], v[180:183], v[76:79]
ds_read_b64_tr_b16 v[128:129], v12 offset:28736
s_waitcnt lgkmcnt(11)
v_mfma_f32_16x16x32_bf16 v[80:83], v[132:135], v[176:179], v[80:83]
ds_read_b64_tr_b16 v[130:131], v12 offset:32320
v_mfma_f32_16x16x32_bf16 v[84:87], v[132:135], v[180:183], v[84:87]
ds_read_b64_tr_b16 v[132:133], v12 offset:28768
buffer_load_dwordx4 v[208:211], v1, s[8:11], s48 offen offset:3072 sc1
s_waitcnt lgkmcnt(11)
v_mfma_f32_16x16x32_bf16 v[88:91], v[136:139], v[176:179], v[88:91]
ds_read_b64_tr_b16 v[134:135], v12 offset:32352
v_mfma_f32_16x16x32_bf16 v[92:95], v[136:139], v[180:183], v[92:95]
ds_read_b64_tr_b16 v[136:137], v12 offset:28800
s_waitcnt lgkmcnt(11)
v_mfma_f32_16x16x32_bf16 v[96:99], v[140:143], v[176:179], v[96:99]
ds_read_b64_tr_b16 v[138:139], v12 offset:32384
buffer_load_dwordx4 v[212:215], v1, s[8:11], s49 offen offset:3072 sc1
v_mfma_f32_16x16x32_bf16 v[100:103], v[140:143], v[180:183], v[100:103]
ds_read_b64_tr_b16 v[140:141], v12 offset:28832
s_waitcnt lgkmcnt(11)
v_mfma_f32_16x16x32_bf16 v[104:107], v[144:147], v[176:179], v[104:107]
ds_read_b64_tr_b16 v[142:143], v12 offset:32416
v_mfma_f32_16x16x32_bf16 v[108:111], v[144:147], v[180:183], v[108:111]
ds_read_b64_tr_b16 v[144:145], v12 offset:28864
s_waitcnt vmcnt(7) lgkmcnt(11)
v_mfma_f32_16x16x32_bf16 v[56:59], v[120:123], v[184:187], v[56:59]
ds_read_b64_tr_b16 v[146:147], v12 offset:32448
s_waitcnt vmcnt(6)
v_mfma_f32_16x16x32_bf16 v[60:63], v[120:123], v[188:191], v[60:63]
ds_read_b64_tr_b16 v[120:121], v12 offset:35840
s_add_u32 s48, s48, 4096
s_waitcnt lgkmcnt(11)
v_mfma_f32_16x16x32_bf16 v[64:67], v[124:127], v[184:187], v[64:67]
ds_read_b64_tr_b16 v[122:123], v12 offset:39424
v_mfma_f32_16x16x32_bf16 v[68:71], v[124:127], v[188:191], v[68:71]
ds_read_b64_tr_b16 v[124:125], v12 offset:35872
s_waitcnt lgkmcnt(11)
v_mfma_f32_16x16x32_bf16 v[72:75], v[128:131], v[184:187], v[72:75]
ds_read_b64_tr_b16 v[126:127], v12 offset:39456
s_add_u32 s49, s49, 4096
v_mfma_f32_16x16x32_bf16 v[76:79], v[128:131], v[188:191], v[76:79]
ds_read_b64_tr_b16 v[128:129], v12 offset:35904
s_waitcnt lgkmcnt(11)
v_mfma_f32_16x16x32_bf16 v[80:83], v[132:135], v[184:187], v[80:83]
ds_read_b64_tr_b16 v[130:131], v12 offset:39488
v_mfma_f32_16x16x32_bf16 v[84:87], v[132:135], v[188:191], v[84:87]
ds_read_b64_tr_b16 v[132:133], v12 offset:35936
buffer_load_dwordx4 v[216:219], v1, s[8:11], s48 offen offset:0 sc1
s_waitcnt lgkmcnt(11)
v_mfma_f32_16x16x32_bf16 v[88:91], v[136:139], v[184:187], v[88:91]
ds_read_b64_tr_b16 v[134:135], v12 offset:39520
v_mfma_f32_16x16x32_bf16 v[92:95], v[136:139], v[188:191], v[92:95]
ds_read_b64_tr_b16 v[136:137], v12 offset:35968
s_waitcnt lgkmcnt(11)
v_mfma_f32_16x16x32_bf16 v[96:99], v[140:143], v[184:187], v[96:99]
ds_read_b64_tr_b16 v[138:139], v12 offset:39552
buffer_load_dwordx4 v[220:223], v1, s[8:11], s49 offen offset:0 sc1
v_mfma_f32_16x16x32_bf16 v[100:103], v[140:143], v[188:191], v[100:103]
ds_read_b64_tr_b16 v[140:141], v12 offset:36000
s_waitcnt lgkmcnt(11)
v_mfma_f32_16x16x32_bf16 v[104:107], v[144:147], v[184:187], v[104:107]
ds_read_b64_tr_b16 v[142:143], v12 offset:39584
v_mfma_f32_16x16x32_bf16 v[108:111], v[144:147], v[188:191], v[108:111]
ds_read_b64_tr_b16 v[144:145], v12 offset:36032
s_waitcnt vmcnt(7) lgkmcnt(11)
v_mfma_f32_16x16x32_bf16 v[56:59], v[120:123], v[192:195], v[56:59]
ds_read_b64_tr_b16 v[146:147], v12 offset:39616
s_waitcnt vmcnt(6)
v_mfma_f32_16x16x32_bf16 v[60:63], v[120:123], v[196:199], v[60:63]
ds_read_b64_tr_b16 v[120:121], v12 offset:43008
buffer_load_dwordx4 v[224:227], v1, s[8:11], s48 offen offset:1024 sc1
s_waitcnt lgkmcnt(11)
v_mfma_f32_16x16x32_bf16 v[64:67], v[124:127], v[192:195], v[64:67]
ds_read_b64_tr_b16 v[122:123], v12 offset:46592
v_mfma_f32_16x16x32_bf16 v[68:71], v[124:127], v[196:199], v[68:71]
ds_read_b64_tr_b16 v[124:125], v12 offset:43040
s_waitcnt lgkmcnt(11)
v_mfma_f32_16x16x32_bf16 v[72:75], v[128:131], v[192:195], v[72:75]
ds_read_b64_tr_b16 v[126:127], v12 offset:46624
buffer_load_dwordx4 v[228:231], v1, s[8:11], s49 offen offset:1024 sc1
v_mfma_f32_16x16x32_bf16 v[76:79], v[128:131], v[196:199], v[76:79]
ds_read_b64_tr_b16 v[128:129], v12 offset:43072
s_waitcnt lgkmcnt(11)
v_mfma_f32_16x16x32_bf16 v[80:83], v[132:135], v[192:195], v[80:83]
ds_read_b64_tr_b16 v[130:131], v12 offset:46656
v_mfma_f32_16x16x32_bf16 v[84:87], v[132:135], v[196:199], v[84:87]
ds_read_b64_tr_b16 v[132:133], v12 offset:43104
buffer_load_dwordx4 v[152:155], v1, s[8:11], s48 offen offset:2048 sc1
s_waitcnt lgkmcnt(11)
v_mfma_f32_16x16x32_bf16 v[88:91], v[136:139], v[192:195], v[88:91]
ds_read_b64_tr_b16 v[134:135], v12 offset:46688
v_mfma_f32_16x16x32_bf16 v[92:95], v[136:139], v[196:199], v[92:95]
ds_read_b64_tr_b16 v[136:137], v12 offset:43136
s_waitcnt lgkmcnt(11)
v_mfma_f32_16x16x32_bf16 v[96:99], v[140:143], v[192:195], v[96:99]
ds_read_b64_tr_b16 v[138:139], v12 offset:46720
buffer_load_dwordx4 v[156:159], v1, s[8:11], s49 offen offset:2048 sc1
v_mfma_f32_16x16x32_bf16 v[100:103], v[140:143], v[196:199], v[100:103]
ds_read_b64_tr_b16 v[140:141], v12 offset:43168
s_waitcnt lgkmcnt(11)
v_mfma_f32_16x16x32_bf16 v[104:107], v[144:147], v[192:195], v[104:107]
ds_read_b64_tr_b16 v[142:143], v12 offset:46752
v_mfma_f32_16x16x32_bf16 v[108:111], v[144:147], v[196:199], v[108:111]
ds_read_b64_tr_b16 v[144:145], v12 offset:43200
s_waitcnt vmcnt(9) lgkmcnt(11)
v_mfma_f32_16x16x32_bf16 v[56:59], v[120:123], v[200:203], v[56:59]
ds_read_b64_tr_b16 v[146:147], v12 offset:46784
s_waitcnt vmcnt(8)
v_mfma_f32_16x16x32_bf16 v[60:63], v[120:123], v[204:207], v[60:63]
ds_read_b64_tr_b16 v[120:121], v12 offset:50176
buffer_load_dwordx4 v[160:163], v1, s[8:11], s48 offen offset:3072 sc1
s_waitcnt lgkmcnt(11)
v_mfma_f32_16x16x32_bf16 v[64:67], v[124:127], v[200:203], v[64:67]
ds_read_b64_tr_b16 v[122:123], v12 offset:53760
v_mfma_f32_16x16x32_bf16 v[68:71], v[124:127], v[204:207], v[68:71]
ds_read_b64_tr_b16 v[124:125], v12 offset:50208
s_waitcnt lgkmcnt(11)
v_mfma_f32_16x16x32_bf16 v[72:75], v[128:131], v[200:203], v[72:75]
ds_read_b64_tr_b16 v[126:127], v12 offset:53792
v_mfma_f32_16x16x32_bf16 v[76:79], v[128:131], v[204:207], v[76:79]
ds_read_b64_tr_b16 v[128:129], v12 offset:50240
s_waitcnt lgkmcnt(11)
v_mfma_f32_16x16x32_bf16 v[80:83], v[132:135], v[200:203], v[80:83]
ds_read_b64_tr_b16 v[130:131], v12 offset:53824
v_mfma_f32_16x16x32_bf16 v[84:87], v[132:135], v[204:207], v[84:87]
ds_read_b64_tr_b16 v[132:133], v12 offset:50272
buffer_load_dwordx4 v[164:167], v1, s[8:11], s49 offen offset:3072 sc1
s_waitcnt lgkmcnt(11)
v_mfma_f32_16x16x32_bf16 v[88:91], v[136:139], v[200:203], v[88:91]
ds_read_b64_tr_b16 v[134:135], v12 offset:53856
v_mfma_f32_16x16x32_bf16 v[92:95], v[136:139], v[204:207], v[92:95]
ds_read_b64_tr_b16 v[136:137], v12 offset:50304
s_waitcnt lgkmcnt(11)
v_mfma_f32_16x16x32_bf16 v[96:99], v[140:143], v[200:203], v[96:99]
ds_read_b64_tr_b16 v[138:139], v12 offset:53888
v_mfma_f32_16x16x32_bf16 v[100:103], v[140:143], v[204:207], v[100:103]
ds_read_b64_tr_b16 v[140:141], v12 offset:50336
s_waitcnt lgkmcnt(11)
v_mfma_f32_16x16x32_bf16 v[104:107], v[144:147], v[200:203], v[104:107]
ds_read_b64_tr_b16 v[142:143], v12 offset:53920
v_mfma_f32_16x16x32_bf16 v[108:111], v[144:147], v[204:207], v[108:111]
ds_read_b64_tr_b16 v[144:145], v12 offset:50368
s_waitcnt vmcnt(9) lgkmcnt(11)
v_mfma_f32_16x16x32_bf16 v[56:59], v[120:123], v[208:211], v[56:59]
ds_read_b64_tr_b16 v[146:147], v12 offset:53952
s_waitcnt vmcnt(8)
v_mfma_f32_16x16x32_bf16 v[60:63], v[120:123], v[212:215], v[60:63]
ds_read_b64_tr_b16 v[120:121], v12 offset:57344
s_add_u32 s48, s48, 4096
s_waitcnt lgkmcnt(11)
v_mfma_f32_16x16x32_bf16 v[64:67], v[124:127], v[208:211], v[64:67]
ds_read_b64_tr_b16 v[122:123], v12 offset:60928
v_mfma_f32_16x16x32_bf16 v[68:71], v[124:127], v[212:215], v[68:71]
ds_read_b64_tr_b16 v[124:125], v12 offset:57376
s_add_u32 s49, s49, 4096
s_waitcnt lgkmcnt(11)
v_mfma_f32_16x16x32_bf16 v[72:75], v[128:131], v[208:211], v[72:75]
ds_read_b64_tr_b16 v[126:127], v12 offset:60960
v_mfma_f32_16x16x32_bf16 v[76:79], v[128:131], v[212:215], v[76:79]
ds_read_b64_tr_b16 v[128:129], v12 offset:57408
buffer_load_dwordx4 v[168:171], v1, s[8:11], s48 offen offset:0 sc1
s_waitcnt lgkmcnt(11)
v_mfma_f32_16x16x32_bf16 v[80:83], v[132:135], v[208:211], v[80:83]
ds_read_b64_tr_b16 v[130:131], v12 offset:60992
v_mfma_f32_16x16x32_bf16 v[84:87], v[132:135], v[212:215], v[84:87]
ds_read_b64_tr_b16 v[132:133], v12 offset:57440
buffer_load_dwordx4 v[172:175], v1, s[8:11], s49 offen offset:0 sc1
s_waitcnt lgkmcnt(11)
v_mfma_f32_16x16x32_bf16 v[88:91], v[136:139], v[208:211], v[88:91]
ds_read_b64_tr_b16 v[134:135], v12 offset:61024
v_mfma_f32_16x16x32_bf16 v[92:95], v[136:139], v[212:215], v[92:95]
ds_read_b64_tr_b16 v[136:137], v12 offset:57472
buffer_load_dwordx4 v[176:179], v1, s[8:11], s48 offen offset:1024 sc1
s_waitcnt lgkmcnt(11)
v_mfma_f32_16x16x32_bf16 v[96:99], v[140:143], v[208:211], v[96:99]
ds_read_b64_tr_b16 v[138:139], v12 offset:61056
v_mfma_f32_16x16x32_bf16 v[100:103], v[140:143], v[212:215], v[100:103]
ds_read_b64_tr_b16 v[140:141], v12 offset:57504
buffer_load_dwordx4 v[180:183], v1, s[8:11], s49 offen offset:1024 sc1
s_waitcnt lgkmcnt(11)
v_mfma_f32_16x16x32_bf16 v[104:107], v[144:147], v[208:211], v[104:107]
ds_read_b64_tr_b16 v[142:143], v12 offset:61088
v_mfma_f32_16x16x32_bf16 v[108:111], v[144:147], v[212:215], v[108:111]
ds_read_b64_tr_b16 v[144:145], v12 offset:57536
s_waitcnt vmcnt(11) lgkmcnt(11)
v_mfma_f32_16x16x32_bf16 v[56:59], v[120:123], v[216:219], v[56:59]
ds_read_b64_tr_b16 v[146:147], v12 offset:61120
s_waitcnt vmcnt(10)
v_mfma_f32_16x16x32_bf16 v[60:63], v[120:123], v[220:223], v[60:63]
ds_read_b64_tr_b16 v[120:121], v244 offset:0
buffer_load_dwordx4 v[184:187], v1, s[8:11], s48 offen offset:2048 sc1
s_waitcnt lgkmcnt(11)
v_mfma_f32_16x16x32_bf16 v[64:67], v[124:127], v[216:219], v[64:67]
ds_read_b64_tr_b16 v[122:123], v244 offset:3584
v_mfma_f32_16x16x32_bf16 v[68:71], v[124:127], v[220:223], v[68:71]
ds_read_b64_tr_b16 v[124:125], v244 offset:32
s_waitcnt lgkmcnt(11)
v_mfma_f32_16x16x32_bf16 v[72:75], v[128:131], v[216:219], v[72:75]
ds_read_b64_tr_b16 v[126:127], v244 offset:3616
v_mfma_f32_16x16x32_bf16 v[76:79], v[128:131], v[220:223], v[76:79]
ds_read_b64_tr_b16 v[128:129], v244 offset:64
s_waitcnt lgkmcnt(11)
v_mfma_f32_16x16x32_bf16 v[80:83], v[132:135], v[216:219], v[80:83]
ds_read_b64_tr_b16 v[130:131], v244 offset:3648
v_mfma_f32_16x16x32_bf16 v[84:87], v[132:135], v[220:223], v[84:87]
ds_read_b64_tr_b16 v[132:133], v244 offset:96
buffer_load_dwordx4 v[188:191], v1, s[8:11], s49 offen offset:2048 sc1
s_waitcnt lgkmcnt(11)
v_mfma_f32_16x16x32_bf16 v[88:91], v[136:139], v[216:219], v[88:91]
ds_read_b64_tr_b16 v[134:135], v244 offset:3680
v_mfma_f32_16x16x32_bf16 v[92:95], v[136:139], v[220:223], v[92:95]
ds_read_b64_tr_b16 v[136:137], v244 offset:128
s_waitcnt lgkmcnt(11)
v_mfma_f32_16x16x32_bf16 v[96:99], v[140:143], v[216:219], v[96:99]
ds_read_b64_tr_b16 v[138:139], v244 offset:3712
v_mfma_f32_16x16x32_bf16 v[100:103], v[140:143], v[220:223], v[100:103]
ds_read_b64_tr_b16 v[140:141], v244 offset:160
s_waitcnt lgkmcnt(11)
v_mfma_f32_16x16x32_bf16 v[104:107], v[144:147], v[216:219], v[104:107]
ds_read_b64_tr_b16 v[142:143], v244 offset:3744
v_mfma_f32_16x16x32_bf16 v[108:111], v[144:147], v[220:223], v[108:111]
ds_read_b64_tr_b16 v[144:145], v244 offset:192
s_waitcnt vmcnt(11) lgkmcnt(11)
v_mfma_f32_16x16x32_bf16 v[56:59], v[120:123], v[224:227], v[56:59]
ds_read_b64_tr_b16 v[146:147], v244 offset:3776
s_waitcnt vmcnt(10)
v_mfma_f32_16x16x32_bf16 v[60:63], v[120:123], v[228:231], v[60:63]
ds_read_b64_tr_b16 v[120:121], v244 offset:7168
buffer_load_dwordx4 v[192:195], v1, s[8:11], s48 offen offset:3072 sc1
s_waitcnt lgkmcnt(11)
v_mfma_f32_16x16x32_bf16 v[64:67], v[124:127], v[224:227], v[64:67]
ds_read_b64_tr_b16 v[122:123], v244 offset:10752
v_mfma_f32_16x16x32_bf16 v[68:71], v[124:127], v[228:231], v[68:71]
ds_read_b64_tr_b16 v[124:125], v244 offset:7200
s_waitcnt lgkmcnt(11)
v_mfma_f32_16x16x32_bf16 v[72:75], v[128:131], v[224:227], v[72:75]
ds_read_b64_tr_b16 v[126:127], v244 offset:10784
v_mfma_f32_16x16x32_bf16 v[76:79], v[128:131], v[228:231], v[76:79]
ds_read_b64_tr_b16 v[128:129], v244 offset:7232
s_waitcnt lgkmcnt(11)
v_mfma_f32_16x16x32_bf16 v[80:83], v[132:135], v[224:227], v[80:83]
ds_read_b64_tr_b16 v[130:131], v244 offset:10816
v_mfma_f32_16x16x32_bf16 v[84:87], v[132:135], v[228:231], v[84:87]
ds_read_b64_tr_b16 v[132:133], v244 offset:7264
buffer_load_dwordx4 v[196:199], v1, s[8:11], s49 offen offset:3072 sc1
s_waitcnt lgkmcnt(11)
v_mfma_f32_16x16x32_bf16 v[88:91], v[136:139], v[224:227], v[88:91]
ds_read_b64_tr_b16 v[134:135], v244 offset:10848
v_mfma_f32_16x16x32_bf16 v[92:95], v[136:139], v[228:231], v[92:95]
ds_read_b64_tr_b16 v[136:137], v244 offset:7296
s_waitcnt lgkmcnt(11)
v_mfma_f32_16x16x32_bf16 v[96:99], v[140:143], v[224:227], v[96:99]
ds_read_b64_tr_b16 v[138:139], v244 offset:10880
v_mfma_f32_16x16x32_bf16 v[100:103], v[140:143], v[228:231], v[100:103]
ds_read_b64_tr_b16 v[140:141], v244 offset:7328
s_waitcnt lgkmcnt(11)
v_mfma_f32_16x16x32_bf16 v[104:107], v[144:147], v[224:227], v[104:107]
ds_read_b64_tr_b16 v[142:143], v244 offset:10912
v_mfma_f32_16x16x32_bf16 v[108:111], v[144:147], v[228:231], v[108:111]
ds_read_b64_tr_b16 v[144:145], v244 offset:7360
s_waitcnt vmcnt(11) lgkmcnt(11)
v_mfma_f32_16x16x32_bf16 v[56:59], v[120:123], v[152:155], v[56:59]
ds_read_b64_tr_b16 v[146:147], v244 offset:10944
s_waitcnt vmcnt(10)
v_mfma_f32_16x16x32_bf16 v[60:63], v[120:123], v[156:159], v[60:63]
ds_read_b64_tr_b16 v[120:121], v244 offset:14336
buffer_load_dwordx4 v[236:239], v1, s[8:11], s50 offen sc1
s_waitcnt lgkmcnt(11)
v_mfma_f32_16x16x32_bf16 v[64:67], v[124:127], v[152:155], v[64:67]
ds_read_b64_tr_b16 v[122:123], v244 offset:17920
v_mfma_f32_16x16x32_bf16 v[68:71], v[124:127], v[156:159], v[68:71]
ds_read_b64_tr_b16 v[124:125], v244 offset:14368
s_waitcnt lgkmcnt(11)
v_mfma_f32_16x16x32_bf16 v[72:75], v[128:131], v[152:155], v[72:75]
ds_read_b64_tr_b16 v[126:127], v244 offset:17952
v_mfma_f32_16x16x32_bf16 v[76:79], v[128:131], v[156:159], v[76:79]
ds_read_b64_tr_b16 v[128:129], v244 offset:14400
buffer_load_dwordx4 v[240:243], v1, s[8:11], s50 offen offset:1024 sc1
s_waitcnt lgkmcnt(11)
v_mfma_f32_16x16x32_bf16 v[80:83], v[132:135], v[152:155], v[80:83]
ds_read_b64_tr_b16 v[130:131], v244 offset:17984
v_mfma_f32_16x16x32_bf16 v[84:87], v[132:135], v[156:159], v[84:87]
ds_read_b64_tr_b16 v[132:133], v244 offset:14432
s_waitcnt lgkmcnt(11)
v_mfma_f32_16x16x32_bf16 v[88:91], v[136:139], v[152:155], v[88:91]
ds_read_b64_tr_b16 v[134:135], v244 offset:18016
v_mfma_f32_16x16x32_bf16 v[92:95], v[136:139], v[156:159], v[92:95]
ds_read_b64_tr_b16 v[136:137], v244 offset:14464
s_waitcnt lgkmcnt(11)
v_mfma_f32_16x16x32_bf16 v[96:99], v[140:143], v[152:155], v[96:99]
ds_read_b64_tr_b16 v[138:139], v244 offset:18048
v_mfma_f32_16x16x32_bf16 v[100:103], v[140:143], v[156:159], v[100:103]
ds_read_b64_tr_b16 v[140:141], v244 offset:14496
s_waitcnt lgkmcnt(11)
v_mfma_f32_16x16x32_bf16 v[104:107], v[144:147], v[152:155], v[104:107]
ds_read_b64_tr_b16 v[142:143], v244 offset:18080
v_mfma_f32_16x16x32_bf16 v[108:111], v[144:147], v[156:159], v[108:111]
ds_read_b64_tr_b16 v[144:145], v244 offset:14528
s_barrier
s_waitcnt vmcnt(11) lgkmcnt(11)
v_mfma_f32_16x16x32_bf16 v[56:59], v[120:123], v[160:163], v[56:59]
ds_read_b64_tr_b16 v[146:147], v244 offset:18112
s_waitcnt vmcnt(10)
v_mfma_f32_16x16x32_bf16 v[60:63], v[120:123], v[164:167], v[60:63]
ds_read_b64_tr_b16 v[120:121], v244 offset:21504
s_waitcnt lgkmcnt(11)
v_mfma_f32_16x16x32_bf16 v[64:67], v[124:127], v[160:163], v[64:67]
ds_read_b64_tr_b16 v[122:123], v244 offset:25088
v_mfma_f32_16x16x32_bf16 v[68:71], v[124:127], v[164:167], v[68:71]
ds_read_b64_tr_b16 v[124:125], v244 offset:21536
s_waitcnt lgkmcnt(11)
v_mfma_f32_16x16x32_bf16 v[72:75], v[128:131], v[160:163], v[72:75]
ds_read_b64_tr_b16 v[126:127], v244 offset:25120
v_mfma_f32_16x16x32_bf16 v[76:79], v[128:131], v[164:167], v[76:79]
ds_read_b64_tr_b16 v[128:129], v244 offset:21568
s_waitcnt lgkmcnt(11)
v_mfma_f32_16x16x32_bf16 v[80:83], v[132:135], v[160:163], v[80:83]
ds_read_b64_tr_b16 v[130:131], v244 offset:25152
v_mfma_f32_16x16x32_bf16 v[84:87], v[132:135], v[164:167], v[84:87]
ds_read_b64_tr_b16 v[132:133], v244 offset:21600
s_waitcnt lgkmcnt(11)
v_mfma_f32_16x16x32_bf16 v[88:91], v[136:139], v[160:163], v[88:91]
ds_read_b64_tr_b16 v[134:135], v244 offset:25184
v_mfma_f32_16x16x32_bf16 v[92:95], v[136:139], v[164:167], v[92:95]
ds_read_b64_tr_b16 v[136:137], v244 offset:21632
s_waitcnt lgkmcnt(11)
v_mfma_f32_16x16x32_bf16 v[96:99], v[140:143], v[160:163], v[96:99]
ds_read_b64_tr_b16 v[138:139], v244 offset:25216
v_mfma_f32_16x16x32_bf16 v[100:103], v[140:143], v[164:167], v[100:103]
ds_read_b64_tr_b16 v[140:141], v244 offset:21664
s_waitcnt lgkmcnt(11)
v_mfma_f32_16x16x32_bf16 v[104:107], v[144:147], v[160:163], v[104:107]
ds_read_b64_tr_b16 v[142:143], v244 offset:25248
v_mfma_f32_16x16x32_bf16 v[108:111], v[144:147], v[164:167], v[108:111]
ds_read_b64_tr_b16 v[144:145], v244 offset:21696
s_waitcnt vmcnt(9) lgkmcnt(11)
v_mfma_f32_16x16x32_bf16 v[56:59], v[120:123], v[168:171], v[56:59]
ds_read_b64_tr_b16 v[146:147], v244 offset:25280
s_waitcnt vmcnt(1)
v_add_f32 v236, v236, v238
v_mfma_f32_16x16x32_bf16 v[60:63], v[120:123], v[172:175], v[60:63]
ds_read_b64_tr_b16 v[120:121], v244 offset:28672
v_add_f32 v237, v237, v239
s_waitcnt lgkmcnt(11)
v_mfma_f32_16x16x32_bf16 v[64:67], v[124:127], v[168:171], v[64:67]
ds_read_b64_tr_b16 v[122:123], v244 offset:32256
v_permlane32_swap_b32 v236, v237
v_mfma_f32_16x16x32_bf16 v[68:71], v[124:127], v[172:175], v[68:71]
ds_read_b64_tr_b16 v[124:125], v244 offset:28704
v_add_f32 v236, v236, v237
s_waitcnt lgkmcnt(11)
v_mfma_f32_16x16x32_bf16 v[72:75], v[128:131], v[168:171], v[72:75]
ds_read_b64_tr_b16 v[126:127], v244 offset:32288
v_mfma_f32_16x16x32_bf16 v[76:79], v[128:131], v[172:175], v[76:79]
ds_read_b64_tr_b16 v[128:129], v244 offset:28736
v_mov_b32 v238, v236
s_waitcnt lgkmcnt(11)
v_mfma_f32_16x16x32_bf16 v[80:83], v[132:135], v[168:171], v[80:83]
ds_read_b64_tr_b16 v[130:131], v244 offset:32320
v_permlane16_swap_b32 v238, v236
v_mfma_f32_16x16x32_bf16 v[84:87], v[132:135], v[172:175], v[84:87]
ds_read_b64_tr_b16 v[132:133], v244 offset:28768
v_add_f32 v236, v236, v238
s_waitcnt lgkmcnt(11)
v_mfma_f32_16x16x32_bf16 v[88:91], v[136:139], v[168:171], v[88:91]
ds_read_b64_tr_b16 v[134:135], v244 offset:32352
v_mfma_f32_16x16x32_bf16 v[92:95], v[136:139], v[172:175], v[92:95]
ds_read_b64_tr_b16 v[136:137], v244 offset:28800
v_mov_b32 v237, v236
s_waitcnt lgkmcnt(11)
v_mfma_f32_16x16x32_bf16 v[96:99], v[140:143], v[168:171], v[96:99]
ds_read_b64_tr_b16 v[138:139], v244 offset:32384
v_permlane32_swap_b32 v236, v237
v_mfma_f32_16x16x32_bf16 v[100:103], v[140:143], v[172:175], v[100:103]
ds_read_b64_tr_b16 v[140:141], v244 offset:28832
v_mul_f32 v236, 0x3b000000, v236
s_waitcnt lgkmcnt(11)
v_mfma_f32_16x16x32_bf16 v[104:107], v[144:147], v[168:171], v[104:107]
ds_read_b64_tr_b16 v[142:143], v244 offset:32416
v_mul_f32 v237, 0x3b000000, v237
v_mfma_f32_16x16x32_bf16 v[108:111], v[144:147], v[172:175], v[108:111]
ds_read_b64_tr_b16 v[144:145], v244 offset:28864
s_waitcnt lgkmcnt(11)
v_mfma_f32_16x16x32_bf16 v[56:59], v[120:123], v[176:179], v[56:59]
ds_read_b64_tr_b16 v[146:147], v244 offset:32448
v_fma_f32 v237, -v236, v236, v237
v_mfma_f32_16x16x32_bf16 v[60:63], v[120:123], v[180:183], v[60:63]
ds_read_b64_tr_b16 v[120:121], v244 offset:35840
v_max_f32 v237, 0, v237
s_waitcnt lgkmcnt(11)
v_mfma_f32_16x16x32_bf16 v[64:67], v[124:127], v[176:179], v[64:67]
ds_read_b64_tr_b16 v[122:123], v244 offset:39424
v_add_f32 v237, s94, v237
v_mfma_f32_16x16x32_bf16 v[68:71], v[124:127], v[180:183], v[68:71]
ds_read_b64_tr_b16 v[124:125], v244 offset:35872
s_waitcnt lgkmcnt(11)
v_mfma_f32_16x16x32_bf16 v[72:75], v[128:131], v[176:179], v[72:75]
ds_read_b64_tr_b16 v[126:127], v244 offset:39456
v_rsq_f32 v248, v237
v_mfma_f32_16x16x32_bf16 v[76:79], v[128:131], v[180:183], v[76:79]
ds_read_b64_tr_b16 v[128:129], v244 offset:35904
v_mul_f32 v249, v236, v248
s_waitcnt lgkmcnt(11)
v_mfma_f32_16x16x32_bf16 v[80:83], v[132:135], v[176:179], v[80:83]
ds_read_b64_tr_b16 v[130:131], v244 offset:39488
s_waitcnt vmcnt(0)
v_add_f32 v240, v240, v242
v_mfma_f32_16x16x32_bf16 v[84:87], v[132:135], v[180:183], v[84:87]
ds_read_b64_tr_b16 v[132:133], v244 offset:35936
s_waitcnt lgkmcnt(11)
v_mfma_f32_16x16x32_bf16 v[88:91], v[136:139], v[176:179], v[88:91]
ds_read_b64_tr_b16 v[134:135], v244 offset:39520
v_add_f32 v241, v241, v243
v_mfma_f32_16x16x32_bf16 v[92:95], v[136:139], v[180:183], v[92:95]
ds_read_b64_tr_b16 v[136:137], v244 offset:35968
v_permlane32_swap_b32 v240, v241
s_waitcnt lgkmcnt(11)
v_mfma_f32_16x16x32_bf16 v[96:99], v[140:143], v[176:179], v[96:99]
ds_read_b64_tr_b16 v[138:139], v244 offset:39552
v_add_f32 v240, v240, v241
v_mfma_f32_16x16x32_bf16 v[100:103], v[140:143], v[180:183], v[100:103]
ds_read_b64_tr_b16 v[140:141], v244 offset:36000
v_mov_b32 v242, v240
s_waitcnt lgkmcnt(11)
v_mfma_f32_16x16x32_bf16 v[104:107], v[144:147], v[176:179], v[104:107]
ds_read_b64_tr_b16 v[142:143], v244 offset:39584
v_mfma_f32_16x16x32_bf16 v[108:111], v[144:147], v[180:183], v[108:111]
ds_read_b64_tr_b16 v[144:145], v244 offset:36032
v_permlane16_swap_b32 v242, v240
s_waitcnt lgkmcnt(11)
v_mfma_f32_16x16x32_bf16 v[56:59], v[120:123], v[184:187], v[56:59]
ds_read_b64_tr_b16 v[146:147], v244 offset:39616
v_add_f32 v240, v240, v242
v_mfma_f32_16x16x32_bf16 v[60:63], v[120:123], v[188:191], v[60:63]
ds_read_b64_tr_b16 v[120:121], v244 offset:43008
v_mov_b32 v241, v240
s_waitcnt lgkmcnt(11)
v_mfma_f32_16x16x32_bf16 v[64:67], v[124:127], v[184:187], v[64:67]
ds_read_b64_tr_b16 v[122:123], v244 offset:46592
v_mfma_f32_16x16x32_bf16 v[68:71], v[124:127], v[188:191], v[68:71]
ds_read_b64_tr_b16 v[124:125], v244 offset:43040
v_permlane32_swap_b32 v240, v241
s_waitcnt lgkmcnt(11)
v_mfma_f32_16x16x32_bf16 v[72:75], v[128:131], v[184:187], v[72:75]
ds_read_b64_tr_b16 v[126:127], v244 offset:46624
v_mul_f32 v240, 0x3b000000, v240
v_mfma_f32_16x16x32_bf16 v[76:79], v[128:131], v[188:191], v[76:79]
ds_read_b64_tr_b16 v[128:129], v244 offset:43072
v_mul_f32 v241, 0x3b000000, v241
s_waitcnt lgkmcnt(11)
v_mfma_f32_16x16x32_bf16 v[80:83], v[132:135], v[184:187], v[80:83]
ds_read_b64_tr_b16 v[130:131], v244 offset:46656
v_mfma_f32_16x16x32_bf16 v[84:87], v[132:135], v[188:191], v[84:87]
ds_read_b64_tr_b16 v[132:133], v244 offset:43104
v_fma_f32 v241, -v240, v240, v241
s_waitcnt lgkmcnt(11)
v_mfma_f32_16x16x32_bf16 v[88:91], v[136:139], v[184:187], v[88:91]
ds_read_b64_tr_b16 v[134:135], v244 offset:46688
v_max_f32 v241, 0, v241
v_mfma_f32_16x16x32_bf16 v[92:95], v[136:139], v[188:191], v[92:95]
ds_read_b64_tr_b16 v[136:137], v244 offset:43136
v_add_f32 v241, s94, v241
s_waitcnt lgkmcnt(11)
v_mfma_f32_16x16x32_bf16 v[96:99], v[140:143], v[184:187], v[96:99]
ds_read_b64_tr_b16 v[138:139], v244 offset:46720
v_rsq_f32 v250, v241
v_mfma_f32_16x16x32_bf16 v[100:103], v[140:143], v[188:191], v[100:103]
ds_read_b64_tr_b16 v[140:141], v244 offset:43168
s_waitcnt lgkmcnt(11)
v_mfma_f32_16x16x32_bf16 v[104:107], v[144:147], v[184:187], v[104:107]
ds_read_b64_tr_b16 v[142:143], v244 offset:46752
v_mul_f32 v251, v240, v250
v_mfma_f32_16x16x32_bf16 v[108:111], v[144:147], v[188:191], v[108:111]
ds_read_b64_tr_b16 v[144:145], v244 offset:43200
s_mov_b32 s90, 0x3fb8aa3b
s_waitcnt lgkmcnt(11)
v_mfma_f32_16x16x32_bf16 v[56:59], v[120:123], v[192:195], v[56:59]
ds_read_b64_tr_b16 v[146:147], v244 offset:46784
v_mul_f32 v248, s90, v248
v_mfma_f32_16x16x32_bf16 v[60:63], v[120:123], v[196:199], v[60:63]
s_waitcnt lgkmcnt(10)
v_mfma_f32_16x16x32_bf16 v[64:67], v[124:127], v[192:195], v[64:67]
v_mul_f32 v249, s90, v249
v_mfma_f32_16x16x32_bf16 v[68:71], v[124:127], v[196:199], v[68:71]
v_mul_f32 v250, s90, v250
s_waitcnt lgkmcnt(8)
v_mfma_f32_16x16x32_bf16 v[72:75], v[128:131], v[192:195], v[72:75]
v_mul_f32 v251, s90, v251
v_mfma_f32_16x16x32_bf16 v[76:79], v[128:131], v[196:199], v[76:79]
s_waitcnt lgkmcnt(6)
v_mfma_f32_16x16x32_bf16 v[80:83], v[132:135], v[192:195], v[80:83]
v_mfma_f32_16x16x32_bf16 v[84:87], v[132:135], v[196:199], v[84:87]
s_waitcnt lgkmcnt(4)
v_mfma_f32_16x16x32_bf16 v[88:91], v[136:139], v[192:195], v[88:91]
v_mfma_f32_16x16x32_bf16 v[92:95], v[136:139], v[196:199], v[92:95]
s_waitcnt lgkmcnt(2)
v_mfma_f32_16x16x32_bf16 v[96:99], v[140:143], v[192:195], v[96:99]
v_mfma_f32_16x16x32_bf16 v[100:103], v[140:143], v[196:199], v[100:103]
s_waitcnt lgkmcnt(0)
v_mfma_f32_16x16x32_bf16 v[104:107], v[144:147], v[192:195], v[104:107]
v_mfma_f32_16x16x32_bf16 v[108:111], v[144:147], v[196:199], v[108:111]
s_barrier
v_lshrrev_b32 v245, 4, v0
v_lshlrev_b32 v245, 4, v245
v_add_u32 v245, 159744, v245
ds_read_b128 v[120:123], v245 offset:0
ds_read_b128 v[124:127], v245 offset:512
ds_read_b128 v[128:131], v245 offset:64
ds_read_b128 v[132:135], v245 offset:576
s_lshl_b32 s52, s43, 3
s_lshl_b32 s53, s42, 1
s_add_u32 s52, s52, s53
s_mul_i32 s52, s52, 57344
s_add_u32 s52, s52, 0x100000
s_lshr_b32 s53, s44, 1
s_mul_i32 s53, s53, 7168
s_add_u32 s52, s52, s53
s_and_b32 s53, s44, 1
s_mul_i32 s48, s53, 3072
s_add_u32 s48, s48, s52
s_lshl_b32 s49, s53, 3
s_add_u32 s49, s49, s52
s_add_u32 s49, s49, 6144
s_add_u32 s50, s48, 57344
s_add_u32 s51, s49, 57344
s_mov_b32 s90, 0xbfb17218
s_mov_b32 s91, 0x3f317218
v_mov_b32 v252, s91
v_mov_b32 v253, s91
s_lshl_b32 s52, s43, 4
s_lshl_b32 s53, s42, 2
s_add_u32 s52, s52, s53
s_lshl_b32 s52, s52, 2
s_and_b32 s53, s45, 1
s_lshl_b32 s53, s53, 1
s_add_u32 s52, s52, s53
v_and_b32 v233, 3, v0
v_lshlrev_b32 v233, 2, v233
v_bfe_u32 v234, v0, 2, 1
v_add_u32 v233, v233, v234
v_add_u32 v233, s52, v233
v_lshlrev_b32 v3, 2, v233
s_add_u32 s52, s42, 0
s_and_b32 s52, s52, 3
s_lshl_b32 s53, s45, 2
s_add_u32 s52, s52, s53
s_mul_i32 s52, s52, 57344
s_mul_i32 s53, s42, 14336
s_add_u32 s52, s52, s53
s_add_u32 s55, s52, 0x100000
s_add_u32 s52, s42, 1
s_and_b32 s52, s52, 3
s_lshl_b32 s53, s45, 2
s_add_u32 s52, s52, s53
s_mul_i32 s52, s52, 57344
s_mul_i32 s53, s42, 14336
s_add_u32 s52, s52, s53
s_add_u32 s56, s52, 0x100000
s_add_u32 s52, s42, 2
s_and_b32 s52, s52, 3
s_lshl_b32 s53, s45, 2
s_add_u32 s52, s52, s53
s_mul_i32 s52, s52, 57344
s_mul_i32 s53, s42, 14336
s_add_u32 s52, s52, s53
s_add_u32 s57, s52, 0x100000
s_add_u32 s52, s42, 3
s_and_b32 s52, s52, 3
s_lshl_b32 s53, s45, 2
s_add_u32 s52, s52, s53
s_mul_i32 s52, s52, 57344
s_mul_i32 s53, s42, 14336
s_add_u32 s52, s52, s53
s_add_u32 s58, s52, 0x100000
v_add_u32 v236, s62, v52
v_add_u32 v240, s63, v52
v_add_u32 v237, s62, v53
v_add_u32 v241, s63, v53
v_add_u32 v238, s62, v54
v_add_u32 v242, s63, v54
v_add_u32 v239, s62, v55
v_add_u32 v243, s63, v55
v_add_u32 v246, 4096, v1
v_add_u32 v247, 8192, v1
v_add_u32 v254, 12288, v1
s_waitcnt lgkmcnt(2)
v_pk_fma_f32 v[168:169], v[120:121], v[248:249], v[124:125] op_sel:[0,1,0] op_sel_hi:[1,1,1] neg_lo:[0,1,0] neg_hi:[0,1,0]
v_pk_fma_f32 v[170:171], v[122:123], v[248:249], v[126:127] op_sel:[0,1,0] op_sel_hi:[1,1,1] neg_lo:[0,1,0] neg_hi:[0,1,0]
v_pk_fma_f32 v[172:173], v[120:121], v[250:251], v[124:125] op_sel:[0,1,0] op_sel_hi:[1,1,1] neg_lo:[0,1,0] neg_hi:[0,1,0]
v_pk_fma_f32 v[174:175], v[122:123], v[250:251], v[126:127] op_sel:[0,1,0] op_sel_hi:[1,1,1] neg_lo:[0,1,0] neg_hi:[0,1,0]
ds_read_b128 v[120:123], v245 offset:128
ds_read_b128 v[124:127], v245 offset:640
v_pk_fma_f32 v[168:169], v[56:57], v[248:249], v[168:169] op_sel_hi:[1,0,1]
v_pk_fma_f32 v[170:171], v[58:59], v[248:249], v[170:171] op_sel_hi:[1,0,1]
v_pk_fma_f32 v[172:173], v[60:61], v[250:251], v[172:173] op_sel_hi:[1,0,1]
v_pk_fma_f32 v[174:175], v[62:63], v[250:251], v[174:175] op_sel_hi:[1,0,1]
v_exp_f32 v176, v168
v_exp_f32 v177, v169
v_exp_f32 v178, v170
v_exp_f32 v179, v171
v_exp_f32 v180, v172
v_exp_f32 v181, v173
v_exp_f32 v182, v174
v_exp_f32 v183, v175
v_pk_add_f32 v[184:185], v[176:177], 2.0 op_sel_hi:[1,0]
v_pk_add_f32 v[186:187], v[178:179], 2.0 op_sel_hi:[1,0]
v_pk_add_f32 v[188:189], v[180:181], 2.0 op_sel_hi:[1,0]
v_pk_add_f32 v[190:191], v[182:183], 2.0 op_sel_hi:[1,0]
v_pk_fma_f32 v[184:185], v[176:177], v[184:185], 2.0 op_sel_hi:[1,1,0]
v_pk_fma_f32 v[186:187], v[178:179], v[186:187], 2.0 op_sel_hi:[1,1,0]
v_pk_fma_f32 v[188:189], v[180:181], v[188:189], 2.0 op_sel_hi:[1,1,0]
v_pk_fma_f32 v[190:191], v[182:183], v[190:191], 2.0 op_sel_hi:[1,1,0]
v_rcp_f32 v184, v184
v_rcp_f32 v185, v185
v_rcp_f32 v186, v186
v_rcp_f32 v187, v187
v_rcp_f32 v188, v188
v_rcp_f32 v189, v189
v_rcp_f32 v190, v190
v_rcp_f32 v191, v191
v_pk_fma_f32 v[184:185], v[184:185], s[90:91], v[252:253] op_sel_hi:[1,0,1]
v_pk_fma_f32 v[186:187], v[186:187], s[90:91], v[252:253] op_sel_hi:[1,0,1]
v_pk_fma_f32 v[188:189], v[188:189], s[90:91], v[252:253] op_sel_hi:[1,0,1]
v_pk_fma_f32 v[190:191], v[190:191], s[90:91], v[252:253] op_sel_hi:[1,0,1]
v_pk_mul_f32 v[168:169], v[168:169], v[184:185]
v_pk_mul_f32 v[170:171], v[170:171], v[186:187]
v_pk_mul_f32 v[172:173], v[172:173], v[188:189]
v_pk_mul_f32 v[174:175], v[174:175], v[190:191]
v_cvt_pk_bf16_f32 v152, v168, v169
v_cvt_pk_bf16_f32 v153, v170, v171
v_cvt_pk_bf16_f32 v156, v172, v173
v_cvt_pk_bf16_f32 v157, v174, v175
s_waitcnt lgkmcnt(2)
v_pk_fma_f32 v[168:169], v[128:129], v[248:249], v[132:133] op_sel:[0,1,0] op_sel_hi:[1,1,1] neg_lo:[0,1,0] neg_hi:[0,1,0]
v_pk_fma_f32 v[170:171], v[130:131], v[248:249], v[134:135] op_sel:[0,1,0] op_sel_hi:[1,1,1] neg_lo:[0,1,0] neg_hi:[0,1,0]
v_pk_fma_f32 v[172:173], v[128:129], v[250:251], v[132:133] op_sel:[0,1,0] op_sel_hi:[1,1,1] neg_lo:[0,1,0] neg_hi:[0,1,0]
v_pk_fma_f32 v[174:175], v[130:131], v[250:251], v[134:135] op_sel:[0,1,0] op_sel_hi:[1,1,1] neg_lo:[0,1,0] neg_hi:[0,1,0]
ds_read_b128 v[128:131], v245 offset:192
ds_read_b128 v[132:135], v245 offset:704
v_pk_fma_f32 v[168:169], v[64:65], v[248:249], v[168:169] op_sel_hi:[1,0,1]
v_pk_fma_f32 v[170:171], v[66:67], v[248:249], v[170:171] op_sel_hi:[1,0,1]
v_pk_fma_f32 v[172:173], v[68:69], v[250:251], v[172:173] op_sel_hi:[1,0,1]
v_pk_fma_f32 v[174:175], v[70:71], v[250:251], v[174:175] op_sel_hi:[1,0,1]
v_exp_f32 v176, v168
v_exp_f32 v177, v169
v_exp_f32 v178, v170
v_exp_f32 v179, v171
v_exp_f32 v180, v172
v_exp_f32 v181, v173
v_exp_f32 v182, v174
v_exp_f32 v183, v175
v_pk_add_f32 v[184:185], v[176:177], 2.0 op_sel_hi:[1,0]
v_pk_add_f32 v[186:187], v[178:179], 2.0 op_sel_hi:[1,0]
v_pk_add_f32 v[188:189], v[180:181], 2.0 op_sel_hi:[1,0]
v_pk_add_f32 v[190:191], v[182:183], 2.0 op_sel_hi:[1,0]
v_pk_fma_f32 v[184:185], v[176:177], v[184:185], 2.0 op_sel_hi:[1,1,0]
v_pk_fma_f32 v[186:187], v[178:179], v[186:187], 2.0 op_sel_hi:[1,1,0]
v_pk_fma_f32 v[188:189], v[180:181], v[188:189], 2.0 op_sel_hi:[1,1,0]
v_pk_fma_f32 v[190:191], v[182:183], v[190:191], 2.0 op_sel_hi:[1,1,0]
v_rcp_f32 v184, v184
v_rcp_f32 v185, v185
v_rcp_f32 v186, v186
v_rcp_f32 v187, v187
v_rcp_f32 v188, v188
v_rcp_f32 v189, v189
v_rcp_f32 v190, v190
v_rcp_f32 v191, v191
v_pk_fma_f32 v[184:185], v[184:185], s[90:91], v[252:253] op_sel_hi:[1,0,1]
v_pk_fma_f32 v[186:187], v[186:187], s[90:91], v[252:253] op_sel_hi:[1,0,1]
v_pk_fma_f32 v[188:189], v[188:189], s[90:91], v[252:253] op_sel_hi:[1,0,1]
v_pk_fma_f32 v[190:191], v[190:191], s[90:91], v[252:253] op_sel_hi:[1,0,1]
v_pk_mul_f32 v[168:169], v[168:169], v[184:185]
v_pk_mul_f32 v[170:171], v[170:171], v[186:187]
v_pk_mul_f32 v[172:173], v[172:173], v[188:189]
v_pk_mul_f32 v[174:175], v[174:175], v[190:191]
v_cvt_pk_bf16_f32 v154, v168, v169
v_cvt_pk_bf16_f32 v155, v170, v171
v_cvt_pk_bf16_f32 v158, v172, v173
v_cvt_pk_bf16_f32 v159, v174, v175
buffer_store_dwordx4 v[152:155], v1, s[8:11], s48 offen offset:0
buffer_store_dwordx4 v[156:159], v1, s[8:11], s50 offen offset:0
s_waitcnt lgkmcnt(2)
v_pk_fma_f32 v[168:169], v[120:121], v[248:249], v[124:125] op_sel:[0,1,0] op_sel_hi:[1,1,1] neg_lo:[0,1,0] neg_hi:[0,1,0]
v_pk_fma_f32 v[170:171], v[122:123], v[248:249], v[126:127] op_sel:[0,1,0] op_sel_hi:[1,1,1] neg_lo:[0,1,0] neg_hi:[0,1,0]
v_pk_fma_f32 v[172:173], v[120:121], v[250:251], v[124:125] op_sel:[0,1,0] op_sel_hi:[1,1,1] neg_lo:[0,1,0] neg_hi:[0,1,0]
v_pk_fma_f32 v[174:175], v[122:123], v[250:251], v[126:127] op_sel:[0,1,0] op_sel_hi:[1,1,1] neg_lo:[0,1,0] neg_hi:[0,1,0]
ds_read_b128 v[120:123], v245 offset:256
ds_read_b128 v[124:127], v245 offset:768
v_pk_fma_f32 v[168:169], v[72:73], v[248:249], v[168:169] op_sel_hi:[1,0,1]
v_pk_fma_f32 v[170:171], v[74:75], v[248:249], v[170:171] op_sel_hi:[1,0,1]
v_pk_fma_f32 v[172:173], v[76:77], v[250:251], v[172:173] op_sel_hi:[1,0,1]
v_pk_fma_f32 v[174:175], v[78:79], v[250:251], v[174:175] op_sel_hi:[1,0,1]
v_exp_f32 v176, v168
v_exp_f32 v177, v169
v_exp_f32 v178, v170
v_exp_f32 v179, v171
v_exp_f32 v180, v172
v_exp_f32 v181, v173
v_exp_f32 v182, v174
v_exp_f32 v183, v175
v_pk_add_f32 v[184:185], v[176:177], 2.0 op_sel_hi:[1,0]
v_pk_add_f32 v[186:187], v[178:179], 2.0 op_sel_hi:[1,0]
v_pk_add_f32 v[188:189], v[180:181], 2.0 op_sel_hi:[1,0]
v_pk_add_f32 v[190:191], v[182:183], 2.0 op_sel_hi:[1,0]
v_pk_fma_f32 v[184:185], v[176:177], v[184:185], 2.0 op_sel_hi:[1,1,0]
v_pk_fma_f32 v[186:187], v[178:179], v[186:187], 2.0 op_sel_hi:[1,1,0]
v_pk_fma_f32 v[188:189], v[180:181], v[188:189], 2.0 op_sel_hi:[1,1,0]
v_pk_fma_f32 v[190:191], v[182:183], v[190:191], 2.0 op_sel_hi:[1,1,0]
v_rcp_f32 v184, v184
v_rcp_f32 v185, v185
v_rcp_f32 v186, v186
v_rcp_f32 v187, v187
v_rcp_f32 v188, v188
v_rcp_f32 v189, v189
v_rcp_f32 v190, v190
v_rcp_f32 v191, v191
v_pk_fma_f32 v[184:185], v[184:185], s[90:91], v[252:253] op_sel_hi:[1,0,1]
v_pk_fma_f32 v[186:187], v[186:187], s[90:91], v[252:253] op_sel_hi:[1,0,1]
v_pk_fma_f32 v[188:189], v[188:189], s[90:91], v[252:253] op_sel_hi:[1,0,1]
v_pk_fma_f32 v[190:191], v[190:191], s[90:91], v[252:253] op_sel_hi:[1,0,1]
v_pk_mul_f32 v[168:169], v[168:169], v[184:185]
v_pk_mul_f32 v[170:171], v[170:171], v[186:187]
v_pk_mul_f32 v[172:173], v[172:173], v[188:189]
v_pk_mul_f32 v[174:175], v[174:175], v[190:191]
v_cvt_pk_bf16_f32 v160, v168, v169
v_cvt_pk_bf16_f32 v161, v170, v171
v_cvt_pk_bf16_f32 v164, v172, v173
v_cvt_pk_bf16_f32 v165, v174, v175
s_waitcnt lgkmcnt(2)
v_pk_fma_f32 v[168:169], v[128:129], v[248:249], v[132:133] op_sel:[0,1,0] op_sel_hi:[1,1,1] neg_lo:[0,1,0] neg_hi:[0,1,0]
v_pk_fma_f32 v[170:171], v[130:131], v[248:249], v[134:135] op_sel:[0,1,0] op_sel_hi:[1,1,1] neg_lo:[0,1,0] neg_hi:[0,1,0]
v_pk_fma_f32 v[172:173], v[128:129], v[250:251], v[132:133] op_sel:[0,1,0] op_sel_hi:[1,1,1] neg_lo:[0,1,0] neg_hi:[0,1,0]
v_pk_fma_f32 v[174:175], v[130:131], v[250:251], v[134:135] op_sel:[0,1,0] op_sel_hi:[1,1,1] neg_lo:[0,1,0] neg_hi:[0,1,0]
ds_read_b128 v[128:131], v245 offset:320
ds_read_b128 v[132:135], v245 offset:832
v_pk_fma_f32 v[168:169], v[80:81], v[248:249], v[168:169] op_sel_hi:[1,0,1]
v_pk_fma_f32 v[170:171], v[82:83], v[248:249], v[170:171] op_sel_hi:[1,0,1]
v_pk_fma_f32 v[172:173], v[84:85], v[250:251], v[172:173] op_sel_hi:[1,0,1]
v_pk_fma_f32 v[174:175], v[86:87], v[250:251], v[174:175] op_sel_hi:[1,0,1]
v_exp_f32 v176, v168
v_exp_f32 v177, v169
v_exp_f32 v178, v170
v_exp_f32 v179, v171
v_exp_f32 v180, v172
v_exp_f32 v181, v173
v_exp_f32 v182, v174
v_exp_f32 v183, v175
v_pk_add_f32 v[184:185], v[176:177], 2.0 op_sel_hi:[1,0]
v_pk_add_f32 v[186:187], v[178:179], 2.0 op_sel_hi:[1,0]
v_pk_add_f32 v[188:189], v[180:181], 2.0 op_sel_hi:[1,0]
v_pk_add_f32 v[190:191], v[182:183], 2.0 op_sel_hi:[1,0]
v_pk_fma_f32 v[184:185], v[176:177], v[184:185], 2.0 op_sel_hi:[1,1,0]
v_pk_fma_f32 v[186:187], v[178:179], v[186:187], 2.0 op_sel_hi:[1,1,0]
v_pk_fma_f32 v[188:189], v[180:181], v[188:189], 2.0 op_sel_hi:[1,1,0]
v_pk_fma_f32 v[190:191], v[182:183], v[190:191], 2.0 op_sel_hi:[1,1,0]
v_rcp_f32 v184, v184
v_rcp_f32 v185, v185
v_rcp_f32 v186, v186
v_rcp_f32 v187, v187
v_rcp_f32 v188, v188
v_rcp_f32 v189, v189
v_rcp_f32 v190, v190
v_rcp_f32 v191, v191
v_pk_fma_f32 v[184:185], v[184:185], s[90:91], v[252:253] op_sel_hi:[1,0,1]
v_pk_fma_f32 v[186:187], v[186:187], s[90:91], v[252:253] op_sel_hi:[1,0,1]
v_pk_fma_f32 v[188:189], v[188:189], s[90:91], v[252:253] op_sel_hi:[1,0,1]
v_pk_fma_f32 v[190:191], v[190:191], s[90:91], v[252:253] op_sel_hi:[1,0,1]
v_pk_mul_f32 v[168:169], v[168:169], v[184:185]
v_pk_mul_f32 v[170:171], v[170:171], v[186:187]
v_pk_mul_f32 v[172:173], v[172:173], v[188:189]
v_pk_mul_f32 v[174:175], v[174:175], v[190:191]
v_cvt_pk_bf16_f32 v162, v168, v169
v_cvt_pk_bf16_f32 v163, v170, v171
v_cvt_pk_bf16_f32 v166, v172, v173
v_cvt_pk_bf16_f32 v167, v174, v175
buffer_store_dwordx4 v[160:163], v1, s[8:11], s48 offen offset:1024
buffer_store_dwordx4 v[164:167], v1, s[8:11], s50 offen offset:1024
s_waitcnt lgkmcnt(2)
v_pk_fma_f32 v[168:169], v[120:121], v[248:249], v[124:125] op_sel:[0,1,0] op_sel_hi:[1,1,1] neg_lo:[0,1,0] neg_hi:[0,1,0]
v_pk_fma_f32 v[170:171], v[122:123], v[248:249], v[126:127] op_sel:[0,1,0] op_sel_hi:[1,1,1] neg_lo:[0,1,0] neg_hi:[0,1,0]
v_pk_fma_f32 v[172:173], v[120:121], v[250:251], v[124:125] op_sel:[0,1,0] op_sel_hi:[1,1,1] neg_lo:[0,1,0] neg_hi:[0,1,0]
v_pk_fma_f32 v[174:175], v[122:123], v[250:251], v[126:127] op_sel:[0,1,0] op_sel_hi:[1,1,1] neg_lo:[0,1,0] neg_hi:[0,1,0]
ds_read_b128 v[120:123], v245 offset:384
ds_read_b128 v[124:127], v245 offset:896
v_pk_fma_f32 v[168:169], v[88:89], v[248:249], v[168:169] op_sel_hi:[1,0,1]
v_pk_fma_f32 v[170:171], v[90:91], v[248:249], v[170:171] op_sel_hi:[1,0,1]
v_pk_fma_f32 v[172:173], v[92:93], v[250:251], v[172:173] op_sel_hi:[1,0,1]
v_pk_fma_f32 v[174:175], v[94:95], v[250:251], v[174:175] op_sel_hi:[1,0,1]
v_exp_f32 v176, v168
v_exp_f32 v177, v169
v_exp_f32 v178, v170
v_exp_f32 v179, v171
v_exp_f32 v180, v172
v_exp_f32 v181, v173
v_exp_f32 v182, v174
v_exp_f32 v183, v175
v_pk_add_f32 v[184:185], v[176:177], 2.0 op_sel_hi:[1,0]
v_pk_add_f32 v[186:187], v[178:179], 2.0 op_sel_hi:[1,0]
v_pk_add_f32 v[188:189], v[180:181], 2.0 op_sel_hi:[1,0]
v_pk_add_f32 v[190:191], v[182:183], 2.0 op_sel_hi:[1,0]
v_pk_fma_f32 v[184:185], v[176:177], v[184:185], 2.0 op_sel_hi:[1,1,0]
v_pk_fma_f32 v[186:187], v[178:179], v[186:187], 2.0 op_sel_hi:[1,1,0]
v_pk_fma_f32 v[188:189], v[180:181], v[188:189], 2.0 op_sel_hi:[1,1,0]
v_pk_fma_f32 v[190:191], v[182:183], v[190:191], 2.0 op_sel_hi:[1,1,0]
v_rcp_f32 v184, v184
v_rcp_f32 v185, v185
v_rcp_f32 v186, v186
v_rcp_f32 v187, v187
v_rcp_f32 v188, v188
v_rcp_f32 v189, v189
v_rcp_f32 v190, v190
v_rcp_f32 v191, v191
v_pk_fma_f32 v[184:185], v[184:185], s[90:91], v[252:253] op_sel_hi:[1,0,1]
v_pk_fma_f32 v[186:187], v[186:187], s[90:91], v[252:253] op_sel_hi:[1,0,1]
v_pk_fma_f32 v[188:189], v[188:189], s[90:91], v[252:253] op_sel_hi:[1,0,1]
v_pk_fma_f32 v[190:191], v[190:191], s[90:91], v[252:253] op_sel_hi:[1,0,1]
v_pk_mul_f32 v[168:169], v[168:169], v[184:185]
v_pk_mul_f32 v[170:171], v[170:171], v[186:187]
v_pk_mul_f32 v[172:173], v[172:173], v[188:189]
v_pk_mul_f32 v[174:175], v[174:175], v[190:191]
v_cvt_pk_bf16_f32 v152, v168, v169
v_cvt_pk_bf16_f32 v153, v170, v171
v_cvt_pk_bf16_f32 v156, v172, v173
v_cvt_pk_bf16_f32 v157, v174, v175
s_waitcnt vmcnt(0)
s_add_u32 s52, s54, 4
v_mov_b32 v232, s52
s_mov_b64 exec, 1
buffer_store_dword v232, v2, s[8:11], s85 offen
s_mov_b64 exec, -1
s_waitcnt lgkmcnt(2)
v_pk_fma_f32 v[168:169], v[128:129], v[248:249], v[132:133] op_sel:[0,1,0] op_sel_hi:[1,1,1] neg_lo:[0,1,0] neg_hi:[0,1,0]
v_pk_fma_f32 v[170:171], v[130:131], v[248:249], v[134:135] op_sel:[0,1,0] op_sel_hi:[1,1,1] neg_lo:[0,1,0] neg_hi:[0,1,0]
v_pk_fma_f32 v[172:173], v[128:129], v[250:251], v[132:133] op_sel:[0,1,0] op_sel_hi:[1,1,1] neg_lo:[0,1,0] neg_hi:[0,1,0]
v_pk_fma_f32 v[174:175], v[130:131], v[250:251], v[134:135] op_sel:[0,1,0] op_sel_hi:[1,1,1] neg_lo:[0,1,0] neg_hi:[0,1,0]
v_pk_fma_f32 v[168:169], v[96:97], v[248:249], v[168:169] op_sel_hi:[1,0,1]
v_pk_fma_f32 v[170:171], v[98:99], v[248:249], v[170:171] op_sel_hi:[1,0,1]
v_pk_fma_f32 v[172:173], v[100:101], v[250:251], v[172:173] op_sel_hi:[1,0,1]
v_pk_fma_f32 v[174:175], v[102:103], v[250:251], v[174:175] op_sel_hi:[1,0,1]
v_exp_f32 v176, v168
v_exp_f32 v177, v169
v_exp_f32 v178, v170
v_exp_f32 v179, v171
v_exp_f32 v180, v172
v_exp_f32 v181, v173
v_exp_f32 v182, v174
v_exp_f32 v183, v175
v_pk_add_f32 v[184:185], v[176:177], 2.0 op_sel_hi:[1,0]
v_pk_add_f32 v[186:187], v[178:179], 2.0 op_sel_hi:[1,0]
v_pk_add_f32 v[188:189], v[180:181], 2.0 op_sel_hi:[1,0]
v_pk_add_f32 v[190:191], v[182:183], 2.0 op_sel_hi:[1,0]
v_pk_fma_f32 v[184:185], v[176:177], v[184:185], 2.0 op_sel_hi:[1,1,0]
v_pk_fma_f32 v[186:187], v[178:179], v[186:187], 2.0 op_sel_hi:[1,1,0]
v_pk_fma_f32 v[188:189], v[180:181], v[188:189], 2.0 op_sel_hi:[1,1,0]
v_pk_fma_f32 v[190:191], v[182:183], v[190:191], 2.0 op_sel_hi:[1,1,0]
v_rcp_f32 v184, v184
v_rcp_f32 v185, v185
v_rcp_f32 v186, v186
v_rcp_f32 v187, v187
v_rcp_f32 v188, v188
v_rcp_f32 v189, v189
v_rcp_f32 v190, v190
v_rcp_f32 v191, v191
v_pk_fma_f32 v[184:185], v[184:185], s[90:91], v[252:253] op_sel_hi:[1,0,1]
v_pk_fma_f32 v[186:187], v[186:187], s[90:91], v[252:253] op_sel_hi:[1,0,1]
v_pk_fma_f32 v[188:189], v[188:189], s[90:91], v[252:253] op_sel_hi:[1,0,1]
v_pk_fma_f32 v[190:191], v[190:191], s[90:91], v[252:253] op_sel_hi:[1,0,1]
v_pk_mul_f32 v[168:169], v[168:169], v[184:185]
v_pk_mul_f32 v[170:171], v[170:171], v[186:187]
v_pk_mul_f32 v[172:173], v[172:173], v[188:189]
v_pk_mul_f32 v[174:175], v[174:175], v[190:191]
v_cvt_pk_bf16_f32 v154, v168, v169
v_cvt_pk_bf16_f32 v155, v170, v171
v_cvt_pk_bf16_f32 v158, v172, v173
v_cvt_pk_bf16_f32 v159, v174, v175
buffer_store_dwordx4 v[152:155], v1, s[8:11], s48 offen offset:2048
buffer_store_dwordx4 v[156:159], v1, s[8:11], s50 offen offset:2048
buffer_load_dword v255, v3, s[8:11], 0 offen sc1
s_waitcnt lgkmcnt(0)
v_pk_fma_f32 v[168:169], v[120:121], v[248:249], v[124:125] op_sel:[0,1,0] op_sel_hi:[1,1,1] neg_lo:[0,1,0] neg_hi:[0,1,0]
v_pk_fma_f32 v[170:171], v[122:123], v[248:249], v[126:127] op_sel:[0,1,0] op_sel_hi:[1,1,1] neg_lo:[0,1,0] neg_hi:[0,1,0]
v_pk_fma_f32 v[172:173], v[120:121], v[250:251], v[124:125] op_sel:[0,1,0] op_sel_hi:[1,1,1] neg_lo:[0,1,0] neg_hi:[0,1,0]
v_pk_fma_f32 v[174:175], v[122:123], v[250:251], v[126:127] op_sel:[0,1,0] op_sel_hi:[1,1,1] neg_lo:[0,1,0] neg_hi:[0,1,0]
v_pk_fma_f32 v[168:169], v[104:105], v[248:249], v[168:169] op_sel_hi:[1,0,1]
v_pk_fma_f32 v[170:171], v[106:107], v[248:249], v[170:171] op_sel_hi:[1,0,1]
v_pk_fma_f32 v[172:173], v[108:109], v[250:251], v[172:173] op_sel_hi:[1,0,1]
v_pk_fma_f32 v[174:175], v[110:111], v[250:251], v[174:175] op_sel_hi:[1,0,1]
v_exp_f32 v176, v168
v_exp_f32 v177, v169
v_exp_f32 v178, v170
v_exp_f32 v179, v171
v_exp_f32 v180, v172
v_exp_f32 v181, v173
v_exp_f32 v182, v174
v_exp_f32 v183, v175
v_pk_add_f32 v[184:185], v[176:177], 2.0 op_sel_hi:[1,0]
v_pk_add_f32 v[186:187], v[178:179], 2.0 op_sel_hi:[1,0]
v_pk_add_f32 v[188:189], v[180:181], 2.0 op_sel_hi:[1,0]
v_pk_add_f32 v[190:191], v[182:183], 2.0 op_sel_hi:[1,0]
v_pk_fma_f32 v[184:185], v[176:177], v[184:185], 2.0 op_sel_hi:[1,1,0]
v_pk_fma_f32 v[186:187], v[178:179], v[186:187], 2.0 op_sel_hi:[1,1,0]
v_pk_fma_f32 v[188:189], v[180:181], v[188:189], 2.0 op_sel_hi:[1,1,0]
v_pk_fma_f32 v[190:191], v[182:183], v[190:191], 2.0 op_sel_hi:[1,1,0]
v_rcp_f32 v184, v184
v_rcp_f32 v185, v185
v_rcp_f32 v186, v186
v_rcp_f32 v187, v187
v_rcp_f32 v188, v188
v_rcp_f32 v189, v189
v_rcp_f32 v190, v190
v_rcp_f32 v191, v191
v_pk_fma_f32 v[184:185], v[184:185], s[90:91], v[252:253] op_sel_hi:[1,0,1]
v_pk_fma_f32 v[186:187], v[186:187], s[90:91], v[252:253] op_sel_hi:[1,0,1]
v_pk_fma_f32 v[188:189], v[188:189], s[90:91], v[252:253] op_sel_hi:[1,0,1]
v_pk_fma_f32 v[190:191], v[190:191], s[90:91], v[252:253] op_sel_hi:[1,0,1]
v_pk_mul_f32 v[168:169], v[168:169], v[184:185]
v_pk_mul_f32 v[170:171], v[170:171], v[186:187]
v_pk_mul_f32 v[172:173], v[172:173], v[188:189]
v_pk_mul_f32 v[174:175], v[174:175], v[190:191]
v_cvt_pk_bf16_f32 v160, v168, v169
v_cvt_pk_bf16_f32 v161, v170, v171
v_cvt_pk_bf16_f32 v164, v172, v173
v_cvt_pk_bf16_f32 v165, v174, v175
buffer_store_dwordx2 v[160:161], v1, s[8:11], s49 offen
buffer_store_dwordx2 v[164:165], v1, s[8:11], s51 offen
s_add_u32 s84, s54, 4
s_waitcnt vmcnt(2)
v_cmp_gt_u32 vcc, s84, v255
s_nop 0
s_cbranch_vccz L_p4rdy_15
s_waitcnt vmcnt(0) lgkmcnt(0)
s_mov_b32 s86, 0
L_poll_16:
buffer_load_dword v232, v3, s[8:11], 0 offen sc1
s_waitcnt vmcnt(0)
v_cmp_gt_u32 vcc, s84, v232
s_nop 0
s_cbranch_vccz L_pollok_17
s_add_u32 s86, s86, 1
s_cmp_lt_u32 s86, 0x40000
s_cbranch_scc1 L_poll_16
v_mov_b32 v232, 0xdead
s_movk_i32 s86, 252
buffer_store_dword v232, v2, s[36:39], s86 offen sc1
s_waitcnt vmcnt(0)
L_pollok_17:
L_p4rdy_15:
buffer_load_dwordx4 v[152:155], v1, s[8:11], s55 offen offset:0 sc1
buffer_load_dwordx4 v[156:159], v1, s[8:11], s56 offen offset:0 sc1
buffer_load_dwordx4 v[160:163], v1, s[8:11], s57 offen offset:0 sc1
buffer_load_dwordx4 v[164:167], v1, s[8:11], s58 offen offset:0 sc1
buffer_load_dwordx4 v[168:171], v1, s[8:11], s55 offen offset:1024 sc1
buffer_load_dwordx4 v[172:175], v1, s[8:11], s56 offen offset:1024 sc1
buffer_load_dwordx4 v[176:179], v1, s[8:11], s57 offen offset:1024 sc1
buffer_load_dwordx4 v[180:183], v1, s[8:11], s58 offen offset:1024 sc1
s_waitcnt vmcnt(8)
s_add_u32 s52, s54, 5
v_mov_b32 v232, s52
s_mov_b64 exec, 1
buffer_store_dword v232, v2, s[8:11], s85 offen
s_mov_b64 exec, -1
s_barrier
ds_read_b64_tr_b16 v[120:121], v236 offset:0
ds_read_b64_tr_b16 v[122:123], v236 offset:2048
ds_read_b64_tr_b16 v[124:125], v237 offset:0
ds_read_b64_tr_b16 v[126:127], v237 offset:2048
ds_read_b64_tr_b16 v[128:129], v238 offset:0
ds_read_b64_tr_b16 v[130:131], v238 offset:2048
ds_read_b64_tr_b16 v[132:133], v239 offset:0
ds_read_b64_tr_b16 v[134:135], v239 offset:2048
s_waitcnt vmcnt(8) lgkmcnt(6)
v_mfma_f32_16x16x32_bf16 v[56:59], v[120:123], v[152:155], 0
ds_read_b64_tr_b16 v[136:137], v236 offset:4096
s_waitcnt vmcnt(7)
v_mfma_f32_16x16x32_bf16 v[72:75], v[120:123], v[156:159], 0
buffer_load_dwordx4 v[184:187], v1, s[8:11], s55 offen offset:3072 sc1
s_waitcnt vmcnt(7)
v_mfma_f32_16x16x32_bf16 v[88:91], v[120:123], v[160:163], 0
ds_read_b64_tr_b16 v[138:139], v236 offset:6144
s_waitcnt vmcnt(6)
v_mfma_f32_16x16x32_bf16 v[104:107], v[120:123], v[164:167], 0
buffer_load_dwordx4 v[188:191], v1, s[8:11], s56 offen offset:3072 sc1
s_waitcnt lgkmcnt(6)
v_mfma_f32_16x16x32_bf16 v[60:63], v[124:127], v[152:155], 0
ds_read_b64_tr_b16 v[140:141], v237 offset:4096
v_mfma_f32_16x16x32_bf16 v[76:79], v[124:127], v[156:159], 0
buffer_load_dwordx4 v[192:195], v1, s[8:11], s57 offen offset:3072 sc1
v_mfma_f32_16x16x32_bf16 v[92:95], v[124:127], v[160:163], 0
ds_read_b64_tr_b16 v[142:143], v237 offset:6144
v_mfma_f32_16x16x32_bf16 v[108:111], v[124:127], v[164:167], 0
buffer_load_dwordx4 v[196:199], v1, s[8:11], s58 offen offset:3072 sc1
s_waitcnt lgkmcnt(6)
v_mfma_f32_16x16x32_bf16 v[64:67], v[128:131], v[152:155], 0
ds_read_b64_tr_b16 v[144:145], v238 offset:4096
v_mfma_f32_16x16x32_bf16 v[80:83], v[128:131], v[156:159], 0
ds_read_b64_tr_b16 v[146:147], v238 offset:6144
v_mfma_f32_16x16x32_bf16 v[96:99], v[128:131], v[160:163], 0
ds_read_b64_tr_b16 v[148:149], v239 offset:4096
v_mfma_f32_16x16x32_bf16 v[112:115], v[128:131], v[164:167], 0
ds_read_b64_tr_b16 v[150:151], v239 offset:6144
s_waitcnt lgkmcnt(8)
v_mfma_f32_16x16x32_bf16 v[68:71], v[132:135], v[152:155], 0
v_mfma_f32_16x16x32_bf16 v[84:87], v[132:135], v[156:159], 0
v_mfma_f32_16x16x32_bf16 v[100:103], v[132:135], v[160:163], 0
v_mfma_f32_16x16x32_bf16 v[116:119], v[132:135], v[164:167], 0
s_waitcnt vmcnt(8) lgkmcnt(6)
v_mfma_f32_16x16x32_bf16 v[56:59], v[136:139], v[168:171], v[56:59]
ds_read_b64_tr_b16 v[120:121], v240 offset:0
s_waitcnt vmcnt(7)
v_mfma_f32_16x16x32_bf16 v[72:75], v[136:139], v[172:175], v[72:75]
buffer_load_dwordx4 v[200:203], v246, s[8:11], s55 offen offset:0 sc1
s_waitcnt vmcnt(7)
v_mfma_f32_16x16x32_bf16 v[88:91], v[136:139], v[176:179], v[88:91]
ds_read_b64_tr_b16 v[122:123], v240 offset:2048
s_waitcnt vmcnt(6)
v_mfma_f32_16x16x32_bf16 v[104:107], v[136:139], v[180:183], v[104:107]
buffer_load_dwordx4 v[204:207], v246, s[8:11], s56 offen offset:0 sc1
s_waitcnt lgkmcnt(6)
v_mfma_f32_16x16x32_bf16 v[60:63], v[140:143], v[168:171], v[60:63]
ds_read_b64_tr_b16 v[124:125], v241 offset:0
v_mfma_f32_16x16x32_bf16 v[76:79], v[140:143], v[172:175], v[76:79]
buffer_load_dwordx4 v[208:211], v246, s[8:11], s57 offen offset:0 sc1
v_mfma_f32_16x16x32_bf16 v[92:95], v[140:143], v[176:179], v[92:95]
ds_read_b64_tr_b16 v[126:127], v241 offset:2048
v_mfma_f32_16x16x32_bf16 v[108:111], v[140:143], v[180:183], v[108:111]
buffer_load_dwordx4 v[212:215], v246, s[8:11], s58 offen offset:0 sc1
s_waitcnt lgkmcnt(6)
v_mfma_f32_16x16x32_bf16 v[64:67], v[144:147], v[168:171], v[64:67]
ds_read_b64_tr_b16 v[128:129], v242 offset:0
v_mfma_f32_16x16x32_bf16 v[80:83], v[144:147], v[172:175], v[80:83]
ds_read_b64_tr_b16 v[130:131], v242 offset:2048
v_mfma_f32_16x16x32_bf16 v[96:99], v[144:147], v[176:179], v[96:99]
ds_read_b64_tr_b16 v[132:133], v243 offset:0
v_mfma_f32_16x16x32_bf16 v[112:115], v[144:147], v[180:183], v[112:115]
ds_read_b64_tr_b16 v[134:135], v243 offset:2048
s_waitcnt lgkmcnt(8)
v_mfma_f32_16x16x32_bf16 v[68:71], v[148:151], v[168:171], v[68:71]
v_mfma_f32_16x16x32_bf16 v[84:87], v[148:151], v[172:175], v[84:87]
v_mfma_f32_16x16x32_bf16 v[100:103], v[148:151], v[176:179], v[100:103]
v_mfma_f32_16x16x32_bf16 v[116:119], v[148:151], v[180:183], v[116:119]
s_barrier
s_waitcnt vmcnt(7) lgkmcnt(6)
v_mfma_f32_16x16x32_bf16 v[56:59], v[120:123], v[184:187], v[56:59]
ds_read_b64_tr_b16 v[136:137], v240 offset:4096
s_waitcnt vmcnt(6)
v_mfma_f32_16x16x32_bf16 v[72:75], v[120:123], v[188:191], v[72:75]
buffer_load_dwordx4 v[216:219], v246, s[8:11], s55 offen offset:3072 sc1
s_waitcnt vmcnt(6)
v_mfma_f32_16x16x32_bf16 v[88:91], v[120:123], v[192:195], v[88:91]
ds_read_b64_tr_b16 v[138:139], v240 offset:6144
s_waitcnt vmcnt(5)
v_mfma_f32_16x16x32_bf16 v[104:107], v[120:123], v[196:199], v[104:107]
buffer_load_dwordx4 v[220:223], v246, s[8:11], s56 offen offset:3072 sc1
s_waitcnt lgkmcnt(6)
v_mfma_f32_16x16x32_bf16 v[60:63], v[124:127], v[184:187], v[60:63]
ds_read_b64_tr_b16 v[140:141], v241 offset:4096
v_mfma_f32_16x16x32_bf16 v[76:79], v[124:127], v[188:191], v[76:79]
buffer_load_dwordx4 v[224:227], v246, s[8:11], s57 offen offset:3072 sc1
v_mfma_f32_16x16x32_bf16 v[92:95], v[124:127], v[192:195], v[92:95]
ds_read_b64_tr_b16 v[142:143], v241 offset:6144
v_mfma_f32_16x16x32_bf16 v[108:111], v[124:127], v[196:199], v[108:111]
buffer_load_dwordx4 v[228:231], v246, s[8:11], s58 offen offset:3072 sc1
s_waitcnt lgkmcnt(6)
v_mfma_f32_16x16x32_bf16 v[64:67], v[128:131], v[184:187], v[64:67]
ds_read_b64_tr_b16 v[144:145], v242 offset:4096
v_mfma_f32_16x16x32_bf16 v[80:83], v[128:131], v[188:191], v[80:83]
ds_read_b64_tr_b16 v[146:147], v242 offset:6144
v_mfma_f32_16x16x32_bf16 v[96:99], v[128:131], v[192:195], v[96:99]
ds_read_b64_tr_b16 v[148:149], v243 offset:4096
v_mfma_f32_16x16x32_bf16 v[112:115], v[128:131], v[196:199], v[112:115]
ds_read_b64_tr_b16 v[150:151], v243 offset:6144
s_waitcnt lgkmcnt(8)
v_mfma_f32_16x16x32_bf16 v[68:71], v[132:135], v[184:187], v[68:71]
v_mfma_f32_16x16x32_bf16 v[84:87], v[132:135], v[188:191], v[84:87]
v_mfma_f32_16x16x32_bf16 v[100:103], v[132:135], v[192:195], v[100:103]
v_mfma_f32_16x16x32_bf16 v[116:119], v[132:135], v[196:199], v[116:119]
s_waitcnt vmcnt(7) lgkmcnt(6)
v_mfma_f32_16x16x32_bf16 v[56:59], v[136:139], v[200:203], v[56:59]
ds_read_b64_tr_b16 v[120:121], v240 offset:8192
s_waitcnt vmcnt(6)
v_mfma_f32_16x16x32_bf16 v[72:75], v[136:139], v[204:207], v[72:75]
buffer_load_dwordx4 v[152:155], v247, s[8:11], s55 offen offset:0 sc1
s_waitcnt vmcnt(6)
v_mfma_f32_16x16x32_bf16 v[88:91], v[136:139], v[208:211], v[88:91]
ds_read_b64_tr_b16 v[122:123], v240 offset:10240
s_waitcnt vmcnt(5)
v_mfma_f32_16x16x32_bf16 v[104:107], v[136:139], v[212:215], v[104:107]
buffer_load_dwordx4 v[156:159], v247, s[8:11], s56 offen offset:0 sc1
s_waitcnt lgkmcnt(6)
v_mfma_f32_16x16x32_bf16 v[60:63], v[140:143], v[200:203], v[60:63]
ds_read_b64_tr_b16 v[124:125], v241 offset:8192
v_mfma_f32_16x16x32_bf16 v[76:79], v[140:143], v[204:207], v[76:79]
buffer_load_dwordx4 v[160:163], v247, s[8:11], s57 offen offset:0 sc1
v_mfma_f32_16x16x32_bf16 v[92:95], v[140:143], v[208:211], v[92:95]
ds_read_b64_tr_b16 v[126:127], v241 offset:10240
v_mfma_f32_16x16x32_bf16 v[108:111], v[140:143], v[212:215], v[108:111]
buffer_load_dwordx4 v[164:167], v247, s[8:11], s58 offen offset:0 sc1
s_waitcnt lgkmcnt(6)
v_mfma_f32_16x16x32_bf16 v[64:67], v[144:147], v[200:203], v[64:67]
ds_read_b64_tr_b16 v[128:129], v242 offset:8192
v_mfma_f32_16x16x32_bf16 v[80:83], v[144:147], v[204:207], v[80:83]
ds_read_b64_tr_b16 v[130:131], v242 offset:10240
v_mfma_f32_16x16x32_bf16 v[96:99], v[144:147], v[208:211], v[96:99]
ds_read_b64_tr_b16 v[132:133], v243 offset:8192
v_mfma_f32_16x16x32_bf16 v[112:115], v[144:147], v[212:215], v[112:115]
ds_read_b64_tr_b16 v[134:135], v243 offset:10240
s_waitcnt lgkmcnt(8)
v_mfma_f32_16x16x32_bf16 v[68:71], v[148:151], v[200:203], v[68:71]
v_mfma_f32_16x16x32_bf16 v[84:87], v[148:151], v[204:207], v[84:87]
v_mfma_f32_16x16x32_bf16 v[100:103], v[148:151], v[208:211], v[100:103]
v_mfma_f32_16x16x32_bf16 v[116:119], v[148:151], v[212:215], v[116:119]
buffer_load_dword v255, v3, s[8:11], 0 offen sc1
s_waitcnt vmcnt(8) lgkmcnt(6)
v_mfma_f32_16x16x32_bf16 v[56:59], v[120:123], v[216:219], v[56:59]
ds_read_b64_tr_b16 v[136:137], v240 offset:12288
s_waitcnt vmcnt(7)
v_mfma_f32_16x16x32_bf16 v[72:75], v[120:123], v[220:223], v[72:75]
buffer_load_dwordx4 v[168:171], v247, s[8:11], s55 offen offset:2048 sc1
s_waitcnt vmcnt(7)
v_mfma_f32_16x16x32_bf16 v[88:91], v[120:123], v[224:227], v[88:91]
ds_read_b64_tr_b16 v[138:139], v240 offset:14336
s_waitcnt vmcnt(6)
v_mfma_f32_16x16x32_bf16 v[104:107], v[120:123], v[228:231], v[104:107]
buffer_load_dwordx4 v[172:175], v247, s[8:11], s56 offen offset:2048 sc1
s_waitcnt lgkmcnt(6)
v_mfma_f32_16x16x32_bf16 v[60:63], v[124:127], v[216:219], v[60:63]
ds_read_b64_tr_b16 v[140:141], v241 offset:12288
v_mfma_f32_16x16x32_bf16 v[76:79], v[124:127], v[220:223], v[76:79]
buffer_load_dwordx4 v[176:179], v247, s[8:11], s57 offen offset:2048 sc1
v_mfma_f32_16x16x32_bf16 v[92:95], v[124:127], v[224:227], v[92:95]
ds_read_b64_tr_b16 v[142:143], v241 offset:14336
v_mfma_f32_16x16x32_bf16 v[108:111], v[124:127], v[228:231], v[108:111]
buffer_load_dwordx4 v[180:183], v247, s[8:11], s58 offen offset:2048 sc1
s_waitcnt lgkmcnt(6)
v_mfma_f32_16x16x32_bf16 v[64:67], v[128:131], v[216:219], v[64:67]
ds_read_b64_tr_b16 v[144:145], v242 offset:12288
v_mfma_f32_16x16x32_bf16 v[80:83], v[128:131], v[220:223], v[80:83]
ds_read_b64_tr_b16 v[146:147], v242 offset:14336
v_mfma_f32_16x16x32_bf16 v[96:99], v[128:131], v[224:227], v[96:99]
ds_read_b64_tr_b16 v[148:149], v243 offset:12288
v_mfma_f32_16x16x32_bf16 v[112:115], v[128:131], v[228:231], v[112:115]
ds_read_b64_tr_b16 v[150:151], v243 offset:14336
s_waitcnt lgkmcnt(8)
v_mfma_f32_16x16x32_bf16 v[68:71], v[132:135], v[216:219], v[68:71]
v_mfma_f32_16x16x32_bf16 v[84:87], v[132:135], v[220:223], v[84:87]
v_mfma_f32_16x16x32_bf16 v[100:103], v[132:135], v[224:227], v[100:103]
v_mfma_f32_16x16x32_bf16 v[116:119], v[132:135], v[228:231], v[116:119]
s_barrier
s_waitcnt vmcnt(8) lgkmcnt(6)
v_mfma_f32_16x16x32_bf16 v[56:59], v[136:139], v[152:155], v[56:59]
ds_read_b64_tr_b16 v[120:121], v240 offset:16384
s_waitcnt vmcnt(7)
v_mfma_f32_16x16x32_bf16 v[72:75], v[136:139], v[156:159], v[72:75]
buffer_load_dwordx4 v[184:187], v247, s[8:11], s55 offen offset:3072 sc1
s_waitcnt vmcnt(7)
v_mfma_f32_16x16x32_bf16 v[88:91], v[136:139], v[160:163], v[88:91]
ds_read_b64_tr_b16 v[122:123], v240 offset:18432
s_waitcnt vmcnt(6)
v_mfma_f32_16x16x32_bf16 v[104:107], v[136:139], v[164:167], v[104:107]
buffer_load_dwordx4 v[188:191], v247, s[8:11], s56 offen offset:3072 sc1
s_waitcnt lgkmcnt(6)
v_mfma_f32_16x16x32_bf16 v[60:63], v[140:143], v[152:155], v[60:63]
ds_read_b64_tr_b16 v[124:125], v241 offset:16384
v_mfma_f32_16x16x32_bf16 v[76:79], v[140:143], v[156:159], v[76:79]
buffer_load_dwordx4 v[192:195], v247, s[8:11], s57 offen offset:3072 sc1
v_mfma_f32_16x16x32_bf16 v[92:95], v[140:143], v[160:163], v[92:95]
ds_read_b64_tr_b16 v[126:127], v241 offset:18432
v_mfma_f32_16x16x32_bf16 v[108:111], v[140:143], v[164:167], v[108:111]
buffer_load_dwordx4 v[196:199], v247, s[8:11], s58 offen offset:3072 sc1
s_waitcnt lgkmcnt(6)
v_mfma_f32_16x16x32_bf16 v[64:67], v[144:147], v[152:155], v[64:67]
ds_read_b64_tr_b16 v[128:129], v242 offset:16384
v_mfma_f32_16x16x32_bf16 v[80:83], v[144:147], v[156:159], v[80:83]
ds_read_b64_tr_b16 v[130:131], v242 offset:18432
v_mfma_f32_16x16x32_bf16 v[96:99], v[144:147], v[160:163], v[96:99]
ds_read_b64_tr_b16 v[132:133], v243 offset:16384
v_mfma_f32_16x16x32_bf16 v[112:115], v[144:147], v[164:167], v[112:115]
ds_read_b64_tr_b16 v[134:135], v243 offset:18432
s_waitcnt lgkmcnt(8)
v_mfma_f32_16x16x32_bf16 v[68:71], v[148:151], v[152:155], v[68:71]
v_mfma_f32_16x16x32_bf16 v[84:87], v[148:151], v[156:159], v[84:87]
v_mfma_f32_16x16x32_bf16 v[100:103], v[148:151], v[160:163], v[100:103]
v_mfma_f32_16x16x32_bf16 v[116:119], v[148:151], v[164:167], v[116:119]
s_add_u32 s84, s54, 5
s_waitcnt vmcnt(8)
v_cmp_gt_u32 vcc, s84, v255
s_nop 0
s_cbranch_vccz L_p4late_18
s_waitcnt vmcnt(0)
s_mov_b32 s86, 0
L_poll_19:
buffer_load_dword v232, v3, s[8:11], 0 offen sc1
s_waitcnt vmcnt(0)
v_cmp_gt_u32 vcc, s84, v232
s_nop 0
s_cbranch_vccz L_pollok_20
s_add_u32 s86, s86, 1
s_cmp_lt_u32 s86, 0x40000
s_cbranch_scc1 L_poll_19
v_mov_b32 v232, 0xdead
s_movk_i32 s86, 252
buffer_store_dword v232, v2, s[36:39], s86 offen sc1
s_waitcnt vmcnt(0)
L_pollok_20:
L_p4late_18:
s_waitcnt vmcnt(7) lgkmcnt(6)
v_mfma_f32_16x16x32_bf16 v[56:59], v[120:123], v[168:171], v[56:59]
ds_read_b64_tr_b16 v[136:137], v240 offset:20480
s_waitcnt vmcnt(6)
v_mfma_f32_16x16x32_bf16 v[72:75], v[120:123], v[172:175], v[72:75]
buffer_load_dwordx4 v[200:203], v1, s[8:11], s55 offen offset:2048 sc1
s_waitcnt vmcnt(6)
v_mfma_f32_16x16x32_bf16 v[88:91], v[120:123], v[176:179], v[88:91]
ds_read_b64_tr_b16 v[138:139], v240 offset:22528
s_waitcnt vmcnt(5)
v_mfma_f32_16x16x32_bf16 v[104:107], v[120:123], v[180:183], v[104:107]
buffer_load_dwordx4 v[204:207], v1, s[8:11], s56 offen offset:2048 sc1
s_waitcnt lgkmcnt(6)
v_mfma_f32_16x16x32_bf16 v[60:63], v[124:127], v[168:171], v[60:63]
ds_read_b64_tr_b16 v[140:141], v241 offset:20480
v_mfma_f32_16x16x32_bf16 v[76:79], v[124:127], v[172:175], v[76:79]
buffer_load_dwordx4 v[208:211], v1, s[8:11], s57 offen offset:2048 sc1
v_mfma_f32_16x16x32_bf16 v[92:95], v[124:127], v[176:179], v[92:95]
ds_read_b64_tr_b16 v[142:143], v241 offset:22528
v_mfma_f32_16x16x32_bf16 v[108:111], v[124:127], v[180:183], v[108:111]
buffer_load_dwordx4 v[212:215], v1, s[8:11], s58 offen offset:2048 sc1
s_waitcnt lgkmcnt(6)
v_mfma_f32_16x16x32_bf16 v[64:67], v[128:131], v[168:171], v[64:67]
ds_read_b64_tr_b16 v[144:145], v242 offset:20480
v_mfma_f32_16x16x32_bf16 v[80:83], v[128:131], v[172:175], v[80:83]
ds_read_b64_tr_b16 v[146:147], v242 offset:22528
v_mfma_f32_16x16x32_bf16 v[96:99], v[128:131], v[176:179], v[96:99]
ds_read_b64_tr_b16 v[148:149], v243 offset:20480
v_mfma_f32_16x16x32_bf16 v[112:115], v[128:131], v[180:183], v[112:115]
ds_read_b64_tr_b16 v[150:151], v243 offset:22528
s_waitcnt lgkmcnt(8)
v_mfma_f32_16x16x32_bf16 v[68:71], v[132:135], v[168:171], v[68:71]
v_mfma_f32_16x16x32_bf16 v[84:87], v[132:135], v[172:175], v[84:87]
v_mfma_f32_16x16x32_bf16 v[100:103], v[132:135], v[176:179], v[100:103]
v_mfma_f32_16x16x32_bf16 v[116:119], v[132:135], v[180:183], v[116:119]
s_waitcnt vmcnt(7) lgkmcnt(6)
v_mfma_f32_16x16x32_bf16 v[56:59], v[136:139], v[184:187], v[56:59]
ds_read_b64_tr_b16 v[120:121], v240 offset:24576
s_waitcnt vmcnt(6)
v_mfma_f32_16x16x32_bf16 v[72:75], v[136:139], v[188:191], v[72:75]
buffer_load_dwordx4 v[216:219], v246, s[8:11], s55 offen offset:1024 sc1
s_waitcnt vmcnt(6)
v_mfma_f32_16x16x32_bf16 v[88:91], v[136:139], v[192:195], v[88:91]
ds_read_b64_tr_b16 v[122:123], v240 offset:26624
s_waitcnt vmcnt(5)
v_mfma_f32_16x16x32_bf16 v[104:107], v[136:139], v[196:199], v[104:107]
buffer_load_dwordx4 v[220:223], v246, s[8:11], s56 offen offset:1024 sc1
s_waitcnt lgkmcnt(6)
v_mfma_f32_16x16x32_bf16 v[60:63], v[140:143], v[184:187], v[60:63]
ds_read_b64_tr_b16 v[124:125], v241 offset:24576
v_mfma_f32_16x16x32_bf16 v[76:79], v[140:143], v[188:191], v[76:79]
buffer_load_dwordx4 v[224:227], v246, s[8:11], s57 offen offset:1024 sc1
v_mfma_f32_16x16x32_bf16 v[92:95], v[140:143], v[192:195], v[92:95]
ds_read_b64_tr_b16 v[126:127], v241 offset:26624
v_mfma_f32_16x16x32_bf16 v[108:111], v[140:143], v[196:199], v[108:111]
buffer_load_dwordx4 v[228:231], v246, s[8:11], s58 offen offset:1024 sc1
s_waitcnt lgkmcnt(6)
v_mfma_f32_16x16x32_bf16 v[64:67], v[144:147], v[184:187], v[64:67]
ds_read_b64_tr_b16 v[128:129], v242 offset:24576
v_mfma_f32_16x16x32_bf16 v[80:83], v[144:147], v[188:191], v[80:83]
ds_read_b64_tr_b16 v[130:131], v242 offset:26624
v_mfma_f32_16x16x32_bf16 v[96:99], v[144:147], v[192:195], v[96:99]
ds_read_b64_tr_b16 v[132:133], v243 offset:24576
v_mfma_f32_16x16x32_bf16 v[112:115], v[144:147], v[196:199], v[112:115]
ds_read_b64_tr_b16 v[134:135], v243 offset:26624
s_waitcnt lgkmcnt(8)
v_mfma_f32_16x16x32_bf16 v[68:71], v[148:151], v[184:187], v[68:71]
v_mfma_f32_16x16x32_bf16 v[84:87], v[148:151], v[188:191], v[84:87]
v_mfma_f32_16x16x32_bf16 v[100:103], v[148:151], v[192:195], v[100:103]
v_mfma_f32_16x16x32_bf16 v[116:119], v[148:151], v[196:199], v[116:119]
s_barrier
s_waitcnt vmcnt(7) lgkmcnt(6)
v_mfma_f32_16x16x32_bf16 v[56:59], v[120:123], v[200:203], v[56:59]
ds_read_b64_tr_b16 v[136:137], v236 offset:0
s_waitcnt vmcnt(6)
v_mfma_f32_16x16x32_bf16 v[72:75], v[120:123], v[204:207], v[72:75]
buffer_load_dwordx4 v[152:155], v246, s[8:11], s55 offen offset:2048 sc1
s_waitcnt vmcnt(6)
v_mfma_f32_16x16x32_bf16 v[88:91], v[120:123], v[208:211], v[88:91]
ds_read_b64_tr_b16 v[138:139], v236 offset:2048
s_waitcnt vmcnt(5)
v_mfma_f32_16x16x32_bf16 v[104:107], v[120:123], v[212:215], v[104:107]
buffer_load_dwordx4 v[156:159], v246, s[8:11], s56 offen offset:2048 sc1
s_waitcnt lgkmcnt(6)
v_mfma_f32_16x16x32_bf16 v[60:63], v[124:127], v[200:203], v[60:63]
ds_read_b64_tr_b16 v[140:141], v237 offset:0
v_mfma_f32_16x16x32_bf16 v[76:79], v[124:127], v[204:207], v[76:79]
buffer_load_dwordx4 v[160:163], v246, s[8:11], s57 offen offset:2048 sc1
v_mfma_f32_16x16x32_bf16 v[92:95], v[124:127], v[208:211], v[92:95]
ds_read_b64_tr_b16 v[142:143], v237 offset:2048
v_mfma_f32_16x16x32_bf16 v[108:111], v[124:127], v[212:215], v[108:111]
buffer_load_dwordx4 v[164:167], v246, s[8:11], s58 offen offset:2048 sc1
s_waitcnt lgkmcnt(6)
v_mfma_f32_16x16x32_bf16 v[64:67], v[128:131], v[200:203], v[64:67]
ds_read_b64_tr_b16 v[144:145], v238 offset:0
v_mfma_f32_16x16x32_bf16 v[80:83], v[128:131], v[204:207], v[80:83]
ds_read_b64_tr_b16 v[146:147], v238 offset:2048
v_mfma_f32_16x16x32_bf16 v[96:99], v[128:131], v[208:211], v[96:99]
ds_read_b64_tr_b16 v[148:149], v239 offset:0
v_mfma_f32_16x16x32_bf16 v[112:115], v[128:131], v[212:215], v[112:115]
ds_read_b64_tr_b16 v[150:151], v239 offset:2048
s_waitcnt lgkmcnt(8)
v_mfma_f32_16x16x32_bf16 v[68:71], v[132:135], v[200:203], v[68:71]
v_mfma_f32_16x16x32_bf16 v[84:87], v[132:135], v[204:207], v[84:87]
v_mfma_f32_16x16x32_bf16 v[100:103], v[132:135], v[208:211], v[100:103]
v_mfma_f32_16x16x32_bf16 v[116:119], v[132:135], v[212:215], v[116:119]
s_waitcnt vmcnt(7) lgkmcnt(6)
v_mfma_f32_16x16x32_bf16 v[56:59], v[136:139], v[216:219], v[56:59]
ds_read_b64_tr_b16 v[120:121], v236 offset:4096
buffer_load_dwordx4 v[168:171], v247, s[8:11], s55 offen offset:1024 sc1
s_waitcnt vmcnt(7)
v_mfma_f32_16x16x32_bf16 v[72:75], v[136:139], v[220:223], v[72:75]
ds_read_b64_tr_b16 v[122:123], v236 offset:6144
s_waitcnt vmcnt(6)
v_mfma_f32_16x16x32_bf16 v[88:91], v[136:139], v[224:227], v[88:91]
buffer_load_dwordx4 v[172:175], v247, s[8:11], s56 offen offset:1024 sc1
s_waitcnt vmcnt(6)
v_mfma_f32_16x16x32_bf16 v[104:107], v[136:139], v[228:231], v[104:107]
ds_read_b64_tr_b16 v[124:125], v237 offset:4096
s_waitcnt lgkmcnt(7)
v_mfma_f32_16x16x32_bf16 v[60:63], v[140:143], v[216:219], v[60:63]
buffer_load_dwordx4 v[176:179], v247, s[8:11], s57 offen offset:1024 sc1
v_mfma_f32_16x16x32_bf16 v[76:79], v[140:143], v[220:223], v[76:79]
ds_read_b64_tr_b16 v[126:127], v237 offset:6144
v_mfma_f32_16x16x32_bf16 v[92:95], v[140:143], v[224:227], v[92:95]
buffer_load_dwordx4 v[180:183], v247, s[8:11], s58 offen offset:1024 sc1
v_mfma_f32_16x16x32_bf16 v[108:111], v[140:143], v[228:231], v[108:111]
ds_read_b64_tr_b16 v[128:129], v238 offset:4096
s_waitcnt lgkmcnt(7)
v_mfma_f32_16x16x32_bf16 v[64:67], v[144:147], v[216:219], v[64:67]
buffer_load_dwordx4 v[184:187], v254, s[8:11], s55 offen offset:0 sc1
v_mfma_f32_16x16x32_bf16 v[80:83], v[144:147], v[220:223], v[80:83]
ds_read_b64_tr_b16 v[130:131], v238 offset:6144
v_mfma_f32_16x16x32_bf16 v[96:99], v[144:147], v[224:227], v[96:99]
buffer_load_dwordx4 v[188:191], v254, s[8:11], s56 offen offset:0 sc1
v_mfma_f32_16x16x32_bf16 v[112:115], v[144:147], v[228:231], v[112:115]
ds_read_b64_tr_b16 v[132:133], v239 offset:4096
s_waitcnt lgkmcnt(7)
v_mfma_f32_16x16x32_bf16 v[68:71], v[148:151], v[216:219], v[68:71]
buffer_load_dwordx4 v[192:195], v254, s[8:11], s57 offen offset:0 sc1
v_mfma_f32_16x16x32_bf16 v[84:87], v[148:151], v[220:223], v[84:87]
ds_read_b64_tr_b16 v[134:135], v239 offset:6144
v_mfma_f32_16x16x32_bf16 v[100:103], v[148:151], v[224:227], v[100:103]
buffer_load_dwordx4 v[196:199], v254, s[8:11], s58 offen offset:0 sc1
v_mfma_f32_16x16x32_bf16 v[116:119], v[148:151], v[228:231], v[116:119]
s_barrier
s_waitcnt vmcnt(11) lgkmcnt(6)
v_mfma_f32_16x16x32_bf16 v[56:59], v[120:123], v[152:155], v[56:59]
ds_read_b64_tr_b16 v[136:137], v240 offset:0
buffer_load_dwordx4 v[200:203], v254, s[8:11], s55 offen offset:1024 sc1
s_waitcnt vmcnt(11)
v_mfma_f32_16x16x32_bf16 v[72:75], v[120:123], v[156:159], v[72:75]
ds_read_b64_tr_b16 v[138:139], v240 offset:2048
buffer_load_dwordx4 v[204:207], v254, s[8:11], s56 offen offset:1024 sc1
s_waitcnt vmcnt(11)
v_mfma_f32_16x16x32_bf16 v[88:91], v[120:123], v[160:163], v[88:91]
ds_read_b64_tr_b16 v[140:141], v241 offset:0
buffer_load_dwordx4 v[208:211], v254, s[8:11], s57 offen offset:1024 sc1
s_waitcnt vmcnt(11)
v_mfma_f32_16x16x32_bf16 v[104:107], v[120:123], v[164:167], v[104:107]
ds_read_b64_tr_b16 v[142:143], v241 offset:2048
buffer_load_dwordx4 v[212:215], v254, s[8:11], s58 offen offset:1024 sc1
ds_read_b64_tr_b16 v[120:121], v240 offset:4096
ds_read_b64_tr_b16 v[122:123], v240 offset:6144
s_waitcnt lgkmcnt(10)
v_mfma_f32_16x16x32_bf16 v[60:63], v[124:127], v[152:155], v[60:63]
ds_read_b64_tr_b16 v[144:145], v242 offset:0
ds_read_b64_tr_b16 v[146:147], v242 offset:2048
v_mfma_f32_16x16x32_bf16 v[76:79], v[124:127], v[156:159], v[76:79]
ds_read_b64_tr_b16 v[148:149], v243 offset:0
v_mfma_f32_16x16x32_bf16 v[92:95], v[124:127], v[160:163], v[92:95]
ds_read_b64_tr_b16 v[150:151], v243 offset:2048
v_mfma_f32_16x16x32_bf16 v[108:111], v[124:127], v[164:167], v[108:111]
ds_read_b64_tr_b16 v[216:217], v240 offset:8192
ds_read_b64_tr_b16 v[124:125], v241 offset:4096
ds_read_b64_tr_b16 v[126:127], v241 offset:6144
s_waitcnt lgkmcnt(15)
v_mfma_f32_16x16x32_bf16 v[64:67], v[128:131], v[152:155], v[64:67]
ds_read_b64_tr_b16 v[218:219], v240 offset:10240
v_mfma_f32_16x16x32_bf16 v[80:83], v[128:131], v[156:159], v[80:83]
ds_read_b64_tr_b16 v[220:221], v241 offset:8192
v_mfma_f32_16x16x32_bf16 v[96:99], v[128:131], v[160:163], v[96:99]
ds_read_b64_tr_b16 v[222:223], v241 offset:10240
v_mfma_f32_16x16x32_bf16 v[112:115], v[128:131], v[164:167], v[112:115]
ds_read_b64_tr_b16 v[224:225], v242 offset:8192
ds_read_b64_tr_b16 v[128:129], v242 offset:4096
ds_read_b64_tr_b16 v[130:131], v242 offset:6144
s_waitcnt lgkmcnt(15)
v_mfma_f32_16x16x32_bf16 v[68:71], v[132:135], v[152:155], v[68:71]
ds_read_b64_tr_b16 v[226:227], v242 offset:10240
v_mfma_f32_16x16x32_bf16 v[84:87], v[132:135], v[156:159], v[84:87]
ds_read_b64_tr_b16 v[228:229], v243 offset:8192
v_mfma_f32_16x16x32_bf16 v[100:103], v[132:135], v[160:163], v[100:103]
ds_read_b64_tr_b16 v[230:231], v243 offset:10240
v_mfma_f32_16x16x32_bf16 v[116:119], v[132:135], v[164:167], v[116:119]
ds_read_b64_tr_b16 v[132:133], v243 offset:4096
ds_read_b64_tr_b16 v[134:135], v243 offset:6144
v_add_u32 v244, s63, v1
s_waitcnt lgkmcnt(0)
s_waitcnt vmcnt(10)
v_mfma_f32_16x16x32_bf16 v[72:75], v[136:139], v[172:175], v[72:75]
v_mfma_f32_16x16x32_bf16 v[76:79], v[140:143], v[172:175], v[76:79]
v_mfma_f32_16x16x32_bf16 v[80:83], v[144:147], v[172:175], v[80:83]
v_mfma_f32_16x16x32_bf16 v[84:87], v[148:151], v[172:175], v[84:87]
s_waitcnt vmcnt(6)
v_mfma_f32_16x16x32_bf16 v[72:75], v[120:123], v[188:191], v[72:75]
v_mfma_f32_16x16x32_bf16 v[76:79], v[124:127], v[188:191], v[76:79]
v_mfma_f32_16x16x32_bf16 v[80:83], v[128:131], v[188:191], v[80:83]
v_mfma_f32_16x16x32_bf16 v[84:87], v[132:135], v[188:191], v[84:87]
s_waitcnt vmcnt(2)
v_mfma_f32_16x16x32_bf16 v[72:75], v[216:219], v[204:207], v[72:75]
v_mfma_f32_16x16x32_bf16 v[76:79], v[220:223], v[204:207], v[76:79]
v_mfma_f32_16x16x32_bf16 v[80:83], v[224:227], v[204:207], v[80:83]
v_mfma_f32_16x16x32_bf16 v[84:87], v[228:231], v[204:207], v[84:87]
v_mfma_f32_16x16x32_bf16 v[88:91], v[136:139], v[176:179], v[88:91]
v_mfma_f32_16x16x32_bf16 v[92:95], v[140:143], v[176:179], v[92:95]
v_mfma_f32_16x16x32_bf16 v[96:99], v[144:147], v[176:179], v[96:99]
s_nop 1
ds_write_b128 v244, v[72:75] offset:0
v_mfma_f32_16x16x32_bf16 v[100:103], v[148:151], v[176:179], v[100:103]
v_mfma_f32_16x16x32_bf16 v[88:91], v[120:123], v[192:195], v[88:91]
ds_write_b128 v244, v[76:79] offset:1024
v_mfma_f32_16x16x32_bf16 v[92:95], v[124:127], v[192:195], v[92:95]
v_mfma_f32_16x16x32_bf16 v[96:99], v[128:131], v[192:195], v[96:99]
ds_write_b128 v244, v[80:83] offset:2048
v_mfma_f32_16x16x32_bf16 v[100:103], v[132:135], v[192:195], v[100:103]
s_waitcnt vmcnt(1)
v_mfma_f32_16x16x32_bf16 v[88:91], v[216:219], v[208:211], v[88:91]
ds_write_b128 v244, v[84:87] offset:3072
v_mfma_f32_16x16x32_bf16 v[92:95], v[220:223], v[208:211], v[92:95]
v_mfma_f32_16x16x32_bf16 v[96:99], v[224:227], v[208:211], v[96:99]
v_mfma_f32_16x16x32_bf16 v[100:103], v[228:231], v[208:211], v[100:103]
v_mfma_f32_16x16x32_bf16 v[104:107], v[136:139], v[180:183], v[104:107]
v_mfma_f32_16x16x32_bf16 v[108:111], v[140:143], v[180:183], v[108:111]
v_mfma_f32_16x16x32_bf16 v[112:115], v[144:147], v[180:183], v[112:115]
s_nop 0
ds_write_b128 v244, v[88:91] offset:4096
v_mfma_f32_16x16x32_bf16 v[116:119], v[148:151], v[180:183], v[116:119]
v_mfma_f32_16x16x32_bf16 v[104:107], v[120:123], v[196:199], v[104:107]
ds_write_b128 v244, v[92:95] offset:5120
v_mfma_f32_16x16x32_bf16 v[108:111], v[124:127], v[196:199], v[108:111]
v_mfma_f32_16x16x32_bf16 v[112:115], v[128:131], v[196:199], v[112:115]
ds_write_b128 v244, v[96:99] offset:6144
v_mfma_f32_16x16x32_bf16 v[116:119], v[132:135], v[196:199], v[116:119]
s_waitcnt vmcnt(0)
v_mfma_f32_16x16x32_bf16 v[104:107], v[216:219], v[212:215], v[104:107]
ds_write_b128 v244, v[100:103] offset:7168
v_mfma_f32_16x16x32_bf16 v[108:111], v[220:223], v[212:215], v[108:111]
v_mfma_f32_16x16x32_bf16 v[112:115], v[224:227], v[212:215], v[112:115]
v_mfma_f32_16x16x32_bf16 v[116:119], v[228:231], v[212:215], v[116:119]
v_mfma_f32_16x16x32_bf16 v[56:59], v[136:139], v[168:171], v[56:59]
v_mfma_f32_16x16x32_bf16 v[60:63], v[140:143], v[168:171], v[60:63]
v_mfma_f32_16x16x32_bf16 v[64:67], v[144:147], v[168:171], v[64:67]
s_nop 0
ds_write_b128 v244, v[104:107] offset:8192
v_mfma_f32_16x16x32_bf16 v[68:71], v[148:151], v[168:171], v[68:71]
v_mfma_f32_16x16x32_bf16 v[56:59], v[120:123], v[184:187], v[56:59]
ds_write_b128 v244, v[108:111] offset:9216
v_mfma_f32_16x16x32_bf16 v[60:63], v[124:127], v[184:187], v[60:63]
v_mfma_f32_16x16x32_bf16 v[64:67], v[128:131], v[184:187], v[64:67]
ds_write_b128 v244, v[112:115] offset:10240
v_mfma_f32_16x16x32_bf16 v[68:71], v[132:135], v[184:187], v[68:71]
v_mfma_f32_16x16x32_bf16 v[56:59], v[216:219], v[200:203], v[56:59]
ds_write_b128 v244, v[116:119] offset:11264
v_mfma_f32_16x16x32_bf16 v[60:63], v[220:223], v[200:203], v[60:63]
v_mfma_f32_16x16x32_bf16 v[64:67], v[224:227], v[200:203], v[64:67]
v_mfma_f32_16x16x32_bf16 v[68:71], v[228:231], v[200:203], v[68:71]
s_sub_u32 s52, s42, 1
s_and_b32 s52, s52, 3
s_mul_i32 s52, s52, 28672
v_add_u32 v245, s52, v1
s_sub_u32 s52, s42, 2
s_and_b32 s52, s52, 3
s_mul_i32 s52, s52, 28672
v_add_u32 v246, s52, v1
s_sub_u32 s52, s42, 3
s_and_b32 s52, s52, 3
s_mul_i32 s52, s52, 28672
v_add_u32 v247, s52, v1
s_waitcnt lgkmcnt(0)
s_barrier
ds_read_b128 v[72:75], v245 offset:0
ds_read_b128 v[76:79], v245 offset:1024
ds_read_b128 v[80:83], v245 offset:2048
ds_read_b128 v[84:87], v245 offset:3072
ds_read_b128 v[88:91], v246 offset:4096
ds_read_b128 v[92:95], v246 offset:5120
ds_read_b128 v[96:99], v246 offset:6144
ds_read_b128 v[100:103], v246 offset:7168
ds_read_b128 v[104:107], v247 offset:8192
ds_read_b128 v[108:111], v247 offset:9216
ds_read_b128 v[112:115], v247 offset:10240
ds_read_b128 v[116:119], v247 offset:11264
s_waitcnt lgkmcnt(11)
v_pk_add_f32 v[56:57], v[56:57], v[72:73]
v_pk_add_f32 v[58:59], v[58:59], v[74:75]
s_waitcnt lgkmcnt(10)
v_pk_add_f32 v[60:61], v[60:61], v[76:77]
v_pk_add_f32 v[62:63], v[62:63], v[78:79]
s_waitcnt lgkmcnt(9)
v_pk_add_f32 v[64:65], v[64:65], v[80:81]
v_pk_add_f32 v[66:67], v[66:67], v[82:83]
s_waitcnt lgkmcnt(8)
v_pk_add_f32 v[68:69], v[68:69], v[84:85]
v_pk_add_f32 v[70:71], v[70:71], v[86:87]
s_waitcnt lgkmcnt(7)
v_pk_add_f32 v[56:57], v[56:57], v[88:89]
v_pk_add_f32 v[58:59], v[58:59], v[90:91]
s_waitcnt lgkmcnt(6)
v_pk_add_f32 v[60:61], v[60:61], v[92:93]
v_pk_add_f32 v[62:63], v[62:63], v[94:95]
s_waitcnt lgkmcnt(5)
v_pk_add_f32 v[64:65], v[64:65], v[96:97]
v_pk_add_f32 v[66:67], v[66:67], v[98:99]
s_waitcnt lgkmcnt(4)
v_pk_add_f32 v[68:69], v[68:69], v[100:101]
v_pk_add_f32 v[70:71], v[70:71], v[102:103]
s_waitcnt lgkmcnt(3)
v_pk_add_f32 v[56:57], v[56:57], v[104:105]
v_pk_add_f32 v[58:59], v[58:59], v[106:107]
s_waitcnt lgkmcnt(2)
v_pk_add_f32 v[60:61], v[60:61], v[108:109]
v_pk_add_f32 v[62:63], v[62:63], v[110:111]
s_waitcnt lgkmcnt(1)
v_pk_add_f32 v[64:65], v[64:65], v[112:113]
v_pk_add_f32 v[66:67], v[66:67], v[114:115]
s_waitcnt lgkmcnt(0)
v_pk_add_f32 v[68:69], v[68:69], v[116:117]
v_pk_add_f32 v[70:71], v[70:71], v[118:119]
s_barrier
s_cmp_lg_u32 s47, 0
s_cbranch_scc1 L_final_21
v_lshlrev_b32 v236, 16, v44
v_and_b32 v237, 0xffff0000, v44
v_lshlrev_b32 v238, 16, v45
v_and_b32 v239, 0xffff0000, v45
v_pk_add_f32 v[236:237], v[236:237], v[56:57]
v_pk_add_f32 v[238:239], v[238:239], v[58:59]
v_cvt_pk_bf16_f32 v44, v236, v237
v_cvt_pk_bf16_f32 v45, v238, v239
v_lshlrev_b32 v236, 16, v46
v_and_b32 v237, 0xffff0000, v46
v_lshlrev_b32 v238, 16, v47
v_and_b32 v239, 0xffff0000, v47
v_pk_add_f32 v[236:237], v[236:237], v[60:61]
v_pk_add_f32 v[238:239], v[238:239], v[62:63]
v_cvt_pk_bf16_f32 v46, v236, v237
v_cvt_pk_bf16_f32 v47, v238, v239
v_lshlrev_b32 v236, 16, v48
v_and_b32 v237, 0xffff0000, v48
v_lshlrev_b32 v238, 16, v49
v_and_b32 v239, 0xffff0000, v49
v_pk_add_f32 v[236:237], v[236:237], v[64:65]
v_pk_add_f32 v[238:239], v[238:239], v[66:67]
v_cvt_pk_bf16_f32 v48, v236, v237
v_cvt_pk_bf16_f32 v49, v238, v239
v_lshlrev_b32 v236, 16, v50
v_and_b32 v237, 0xffff0000, v50
v_lshlrev_b32 v238, 16, v51
v_and_b32 v239, 0xffff0000, v51
v_pk_add_f32 v[236:237], v[236:237], v[68:69]
v_pk_add_f32 v[238:239], v[238:239], v[70:71]
v_cvt_pk_bf16_f32 v50, v236, v237
v_cvt_pk_bf16_f32 v51, v238, v239
s_lshl_b32 s52, s45, 2
s_add_u32 s52, s52, s42
s_lshl_b32 s48, s52, 14
s_lshl_b32 s49, s46, 11
s_add_u32 s48, s48, s49
s_add_u32 s48, s48, 0x10000
buffer_store_dwordx4 v[44:47], v1, s[8:11], s48 offen
buffer_store_dwordx4 v[48:51], v1, s[8:11], s48 offen offset:1024
v_dot2_f32_bf16 v240, v44, s89, 0
v_dot2_f32_bf16 v241, v44, v44, 0
v_dot2_f32_bf16 v240, v45, s89, v240
v_dot2_f32_bf16 v241, v45, v45, v241
v_dot2_f32_bf16 v240, v46, s89, v240
v_dot2_f32_bf16 v241, v46, v46, v241
v_dot2_f32_bf16 v240, v47, s89, v240
v_dot2_f32_bf16 v241, v47, v47, v241
v_dot2_f32_bf16 v240, v48, s89, v240
v_dot2_f32_bf16 v241, v48, v48, v241
v_dot2_f32_bf16 v240, v49, s89, v240
v_dot2_f32_bf16 v241, v49, v49, v241
v_dot2_f32_bf16 v240, v50, s89, v240
v_dot2_f32_bf16 v241, v50, v50, v241
v_dot2_f32_bf16 v240, v51, s89, v240
v_dot2_f32_bf16 v241, v51, v51, v241
s_nop 2
v_permlane32_swap_b32 v240, v241
v_add_f32 v240, v240, v241
v_mov_b32 v242, v240
s_nop 1
v_permlane16_swap_b32 v242, v240
v_add_f32 v240, v240, v242
s_lshl_b32 s49, s52, 10
s_add_u32 s49, s49, 0x50000
buffer_store_dword v240, v4, s[8:11], s49 offen
s_cmp_lg_u32 s42, 3
s_cbranch_scc1 L_nohalo2_22
s_cmp_lg_u32 s45, 1
s_cbranch_scc1 L_nohalo2_22
s_lshl_b32 s48, s46, 11
s_add_u32 s48, s48, 0x78000
buffer_store_dwordx4 v[44:47], v1, s[8:11], s48 offen sc1
buffer_store_dwordx4 v[48:51], v1, s[8:11], s48 offen offset:1024 sc1
s_mov_b32 s49, 0x7c000
buffer_store_dword v240, v4, s[8:11], s49 offen sc1
s_waitcnt vmcnt(0)
L_nohalo2_22:
s_mov_b32 s48, 6
s_waitcnt vmcnt(0)
v_mov_b32 v232, s48
s_mov_b64 exec, 1
buffer_store_dword v232, v2, s[8:11], s85 offen
s_mov_b64 exec, -1
s_cmp_lg_u32 s42, 3
s_cbranch_scc1 L_noremote_23
s_cmp_lg_u32 s45, 3
s_cbranch_scc1 L_noremote_23
s_cmp_eq_u32 s40, 7
s_cbranch_scc1 L_noremote_23
s_lshl_b32 s48, s46, 11
s_add_u32 s48, s48, 0x70000
buffer_store_dwordx4 v[44:47], v1, s[32:35], s48 offen sc1
buffer_store_dwordx4 v[48:51], v1, s[32:35], s48 offen offset:1024 sc1
s_mov_b32 s49, 0x74000
buffer_store_dword v240, v4, s[32:35], s49 offen sc1
s_add_u32 s50, s40, 1
s_lshl_b32 s50, s50, 2
s_add_u32 s50, s50, 32
v_mov_b32 v3, s50
s_mov_b32 s51, 1
s_waitcnt vmcnt(0) lgkmcnt(0)
s_mov_b32 s86, 0
L_poll_24:
buffer_load_dword v232, v3, s[36:39], 0 offen sc1
s_waitcnt vmcnt(0)
v_cmp_gt_u32 vcc, s51, v232
s_nop 0
s_cbranch_vccz L_pollok_25
s_add_u32 s86, s86, 1
s_cmp_lt_u32 s86, 0x40000
s_cbranch_scc1 L_poll_24
v_mov_b32 v232, 0xdead
s_movk_i32 s86, 252
buffer_store_dword v232, v2, s[36:39], s86 offen sc1
s_waitcnt vmcnt(0)
L_pollok_25:
v_mov_b32 v232, 1
s_lshl_b32 s48, s46, 2
s_add_u32 s48, s48, 1024
s_mov_b64 exec, 1
buffer_store_dword v232, v2, s[32:35], s48 offen sc1
s_mov_b64 exec, -1
s_waitcnt vmcnt(0)
L_noremote_23:
s_mov_b32 s47, 0x10000
s_mov_b32 s54, 6
s_waitcnt vmcnt(0) lgkmcnt(0)
s_lshl_b32 s48, s43, 3
s_lshl_b32 s49, s42, 1
s_add_u32 s48, s48, s49
s_lshr_b32 s49, s48, 2
s_lshl_b32 s49, s49, 3
s_and_b32 s48, s48, 3
s_lshl_b32 s49, s49, 2
s_add_u32 s48, s48, s49
v_and_b32 v233, 7, v0
v_lshlrev_b32 v233, 2, v233
v_bfe_u32 v234, v0, 3, 1
v_add_u32 v233, v233, v234
v_add_u32 v233, s48, v233
v_and_b32 v234, 7, v0
v_lshlrev_b32 v234, 2, v234
v_add_u32 v234, 35, v234
v_cmp_gt_u32 vcc, 32, v0
s_cmp_eq_u32 s43, 0
s_nop 2
s_cselect_b64 vcc, -1, vcc
v_cndmask_b32 v233, v234, v233, vcc
v_lshlrev_b32 v3, 2, v233
s_lshl_b32 s52, s43, 3
s_lshl_b32 s53, s42, 1
s_add_u32 s52, s52, s53
s_lshl_b32 s84, s52, 10
s_add_u32 s84, s84, 0x50000
s_mul_i32 s91, s43, 0x8000
s_add_u32 s91, s91, 0x70000
s_lshl_b32 s48, s52, 14
s_add_u32 s48, s48, 0x10000
s_add_u32 s49, s48, 16384
s_lshl_b32 s53, s42, 12
s_add_u32 s50, s91, s53
s_add_u32 s91, s91, 0x4000
s_or_b32 s53, s40, s43
s_cmp_eq_u32 s53, 0
s_cselect_b32 s50, 0x7ff00000, s50
s_cselect_b32 s91, 0x7ff00000, s91
v_add_u32 v248, 49152, v6
v_add_u32 v249, 49152, v7
s_mov_b32 s86, 0
L_poll_26:
buffer_load_dword v232, v3, s[8:11], 0 offen sc1
s_waitcnt vmcnt(0)
v_cmp_gt_u32 vcc, 6, v232
s_nop 0
s_cbranch_vccz L_pollok_27
s_add_u32 s86, s86, 1
s_cmp_lt_u32 s86, 0x40000
s_cbranch_scc1 L_poll_26
v_mov_b32 v232, 0xdead
s_movk_i32 s86, 252
buffer_store_dword v232, v2, s[36:39], s86 offen sc1
s_waitcnt vmcnt(0)
L_pollok_27:
buffer_load_dwordx4 v[152:155], v1, s[8:11], s48 offen offset:0 sc1
buffer_load_dwordx4 v[156:159], v1, s[8:11], s49 offen offset:0 sc1
buffer_load_dwordx4 v[160:163], v1, s[8:11], s48 offen offset:1024 sc1
buffer_load_dwordx4 v[164:167], v1, s[8:11], s49 offen offset:1024 sc1
s_barrier
ds_read_b64_tr_b16 v[120:121], v6 offset:0
ds_read_b64_tr_b16 v[122:123], v6 offset:1024
ds_read_b64_tr_b16 v[124:125], v7 offset:0
ds_read_b64_tr_b16 v[126:127], v7 offset:1024
ds_read_b64_tr_b16 v[128:129], v6 offset:2048
ds_read_b64_tr_b16 v[130:131], v6 offset:3072
ds_read_b64_tr_b16 v[132:133], v7 offset:2048
ds_read_b64_tr_b16 v[134:135], v7 offset:3072
ds_read_b64_tr_b16 v[136:137], v6 offset:4096
ds_read_b64_tr_b16 v[138:139], v6 offset:5120
ds_read_b64_tr_b16 v[140:141], v7 offset:4096
ds_read_b64_tr_b16 v[142:143], v7 offset:5120
s_waitcnt vmcnt(3) lgkmcnt(10)
v_mfma_f32_16x16x32_bf16 v[56:59], v[120:123], v[152:155], 0
s_waitcnt vmcnt(2)
v_mfma_f32_16x16x32_bf16 v[60:63], v[120:123], v[156:159], 0
ds_read_b64_tr_b16 v[120:121], v6 offset:6144
buffer_load_dwordx4 v[168:171], v1, s[8:11], s48 offen offset:2048 sc1
s_waitcnt lgkmcnt(9)
v_mfma_f32_16x16x32_bf16 v[64:67], v[124:127], v[152:155], 0
ds_read_b64_tr_b16 v[122:123], v6 offset:7168
v_mfma_f32_16x16x32_bf16 v[68:71], v[124:127], v[156:159], 0
ds_read_b64_tr_b16 v[124:125], v7 offset:6144
s_waitcnt lgkmcnt(9)
v_mfma_f32_16x16x32_bf16 v[72:75], v[128:131], v[152:155], 0
ds_read_b64_tr_b16 v[126:127], v7 offset:7168
v_mfma_f32_16x16x32_bf16 v[76:79], v[128:131], v[156:159], 0
ds_read_b64_tr_b16 v[128:129], v6 offset:8192
s_waitcnt lgkmcnt(9)
v_mfma_f32_16x16x32_bf16 v[80:83], v[132:135], v[152:155], 0
ds_read_b64_tr_b16 v[130:131], v6 offset:9216
buffer_load_dwordx4 v[172:175], v1, s[8:11], s49 offen offset:2048 sc1
v_mfma_f32_16x16x32_bf16 v[84:87], v[132:135], v[156:159], 0
ds_read_b64_tr_b16 v[132:133], v7 offset:8192
s_waitcnt lgkmcnt(9)
v_mfma_f32_16x16x32_bf16 v[88:91], v[152:155], v[136:139], 0
ds_read_b64_tr_b16 v[134:135], v7 offset:9216
v_mfma_f32_16x16x32_bf16 v[92:95], v[156:159], v[136:139], 0
ds_read_b64_tr_b16 v[136:137], v6 offset:10240
s_waitcnt lgkmcnt(9)
v_mfma_f32_16x16x32_bf16 v[96:99], v[152:155], v[140:143], 0
ds_read_b64_tr_b16 v[138:139], v6 offset:11264
v_mfma_f32_16x16x32_bf16 v[100:103], v[156:159], v[140:143], 0
ds_read_b64_tr_b16 v[140:141], v7 offset:10240
s_waitcnt vmcnt(3) lgkmcnt(9)
v_mfma_f32_16x16x32_bf16 v[56:59], v[120:123], v[160:163], v[56:59]
ds_read_b64_tr_b16 v[142:143], v7 offset:11264
s_waitcnt vmcnt(2)
v_mfma_f32_16x16x32_bf16 v[60:63], v[120:123], v[164:167], v[60:63]
ds_read_b64_tr_b16 v[120:121], v6 offset:12288
buffer_load_dwordx4 v[176:179], v1, s[8:11], s48 offen offset:3072 sc1
s_waitcnt lgkmcnt(9)
v_mfma_f32_16x16x32_bf16 v[64:67], v[124:127], v[160:163], v[64:67]
ds_read_b64_tr_b16 v[122:123], v6 offset:13312
buffer_load_dwordx4 v[180:183], v1, s[8:11], s49 offen offset:3072 sc1
v_mfma_f32_16x16x32_bf16 v[68:71], v[124:127], v[164:167], v[68:71]
ds_read_b64_tr_b16 v[124:125], v7 offset:12288
s_waitcnt lgkmcnt(9)
v_mfma_f32_16x16x32_bf16 v[72:75], v[128:131], v[160:163], v[72:75]
ds_read_b64_tr_b16 v[126:127], v7 offset:13312
s_add_u32 s48, s48, 4096
v_mfma_f32_16x16x32_bf16 v[76:79], v[128:131], v[164:167], v[76:79]
ds_read_b64_tr_b16 v[128:129], v6 offset:14336
s_waitcnt lgkmcnt(9)
v_mfma_f32_16x16x32_bf16 v[80:83], v[132:135], v[160:163], v[80:83]
ds_read_b64_tr_b16 v[130:131], v6 offset:15360
s_add_u32 s49, s49, 4096
v_mfma_f32_16x16x32_bf16 v[84:87], v[132:135], v[164:167], v[84:87]
ds_read_b64_tr_b16 v[132:133], v7 offset:14336
buffer_load_dwordx4 v[184:187], v1, s[8:11], s48 offen offset:0 sc1
s_waitcnt lgkmcnt(9)
v_mfma_f32_16x16x32_bf16 v[88:91], v[160:163], v[136:139], v[88:91]
ds_read_b64_tr_b16 v[134:135], v7 offset:15360
v_mfma_f32_16x16x32_bf16 v[92:95], v[164:167], v[136:139], v[92:95]
ds_read_b64_tr_b16 v[136:137], v6 offset:16384
buffer_load_dwordx4 v[188:191], v1, s[8:11], s49 offen offset:0 sc1
s_waitcnt lgkmcnt(9)
v_mfma_f32_16x16x32_bf16 v[96:99], v[160:163], v[140:143], v[96:99]
ds_read_b64_tr_b16 v[138:139], v6 offset:17408
v_mfma_f32_16x16x32_bf16 v[100:103], v[164:167], v[140:143], v[100:103]
ds_read_b64_tr_b16 v[140:141], v7 offset:16384
s_waitcnt vmcnt(5) lgkmcnt(9)
v_mfma_f32_16x16x32_bf16 v[56:59], v[120:123], v[168:171], v[56:59]
ds_read_b64_tr_b16 v[142:143], v7 offset:17408
s_waitcnt vmcnt(4)
v_mfma_f32_16x16x32_bf16 v[60:63], v[120:123], v[172:175], v[60:63]
ds_read_b64_tr_b16 v[120:121], v6 offset:18432
buffer_load_dwordx4 v[192:195], v1, s[8:11], s48 offen offset:1024 sc1
s_waitcnt lgkmcnt(9)
v_mfma_f32_16x16x32_bf16 v[64:67], v[124:127], v[168:171], v[64:67]
ds_read_b64_tr_b16 v[122:123], v6 offset:19456
v_mfma_f32_16x16x32_bf16 v[68:71], v[124:127], v[172:175], v[68:71]
ds_read_b64_tr_b16 v[124:125], v7 offset:18432
s_waitcnt lgkmcnt(9)
v_mfma_f32_16x16x32_bf16 v[72:75], v[128:131], v[168:171], v[72:75]
ds_read_b64_tr_b16 v[126:127], v7 offset:19456
v_mfma_f32_16x16x32_bf16 v[76:79], v[128:131], v[172:175], v[76:79]
ds_read_b64_tr_b16 v[128:129], v6 offset:20480
s_waitcnt lgkmcnt(9)
v_mfma_f32_16x16x32_bf16 v[80:83], v[132:135], v[168:171], v[80:83]
ds_read_b64_tr_b16 v[130:131], v6 offset:21504
buffer_load_dwordx4 v[196:199], v1, s[8:11], s49 offen offset:1024 sc1
v_mfma_f32_16x16x32_bf16 v[84:87], v[132:135], v[172:175], v[84:87]
ds_read_b64_tr_b16 v[132:133], v7 offset:20480
s_waitcnt lgkmcnt(9)
v_mfma_f32_16x16x32_bf16 v[88:91], v[168:171], v[136:139], v[88:91]
ds_read_b64_tr_b16 v[134:135], v7 offset:21504
v_mfma_f32_16x16x32_bf16 v[92:95], v[172:175], v[136:139], v[92:95]
ds_read_b64_tr_b16 v[136:137], v6 offset:22528
s_waitcnt lgkmcnt(9)
v_mfma_f32_16x16x32_bf16 v[96:99], v[168:171], v[140:143], v[96:99]
ds_read_b64_tr_b16 v[138:139], v6 offset:23552
v_mfma_f32_16x16x32_bf16 v[100:103], v[172:175], v[140:143], v[100:103]
ds_read_b64_tr_b16 v[140:141], v7 offset:22528
s_waitcnt vmcnt(5) lgkmcnt(9)
v_mfma_f32_16x16x32_bf16 v[56:59], v[120:123], v[176:179], v[56:59]
ds_read_b64_tr_b16 v[142:143], v7 offset:23552
s_waitcnt vmcnt(4)
v_mfma_f32_16x16x32_bf16 v[60:63], v[120:123], v[180:183], v[60:63]
ds_read_b64_tr_b16 v[120:121], v6 offset:24576
buffer_load_dwordx4 v[200:203], v1, s[8:11], s48 offen offset:2048 sc1
s_waitcnt lgkmcnt(9)
v_mfma_f32_16x16x32_bf16 v[64:67], v[124:127], v[176:179], v[64:67]
ds_read_b64_tr_b16 v[122:123], v6 offset:25600
v_mfma_f32_16x16x32_bf16 v[68:71], v[124:127], v[180:183], v[68:71]
ds_read_b64_tr_b16 v[124:125], v7 offset:24576
buffer_load_dwordx4 v[204:207], v1, s[8:11], s49 offen offset:2048 sc1
s_waitcnt lgkmcnt(9)
v_mfma_f32_16x16x32_bf16 v[72:75], v[128:131], v[176:179], v[72:75]
ds_read_b64_tr_b16 v[126:127], v7 offset:25600
v_mfma_f32_16x16x32_bf16 v[76:79], v[128:131], v[180:183], v[76:79]
ds_read_b64_tr_b16 v[128:129], v6 offset:26624
s_waitcnt lgkmcnt(9)
v_mfma_f32_16x16x32_bf16 v[80:83], v[132:135], v[176:179], v[80:83]
ds_read_b64_tr_b16 v[130:131], v6 offset:27648
buffer_load_dwordx4 v[208:211], v1, s[8:11], s48 offen offset:3072 sc1
v_mfma_f32_16x16x32_bf16 v[84:87], v[132:135], v[180:183], v[84:87]
ds_read_b64_tr_b16 v[132:133], v7 offset:26624
s_waitcnt lgkmcnt(9)
v_mfma_f32_16x16x32_bf16 v[88:91], v[176:179], v[136:139], v[88:91]
ds_read_b64_tr_b16 v[134:135], v7 offset:27648
buffer_load_dwordx4 v[212:215], v1, s[8:11], s49 offen offset:3072 sc1
v_mfma_f32_16x16x32_bf16 v[92:95], v[180:183], v[136:139], v[92:95]
ds_read_b64_tr_b16 v[136:137], v6 offset:28672
s_waitcnt lgkmcnt(9)
v_mfma_f32_16x16x32_bf16 v[96:99], v[176:179], v[140:143], v[96:99]
ds_read_b64_tr_b16 v[138:139], v6 offset:29696
v_mfma_f32_16x16x32_bf16 v[100:103], v[180:183], v[140:143], v[100:103]
ds_read_b64_tr_b16 v[140:141], v7 offset:28672
s_waitcnt vmcnt(7) lgkmcnt(9)
v_mfma_f32_16x16x32_bf16 v[56:59], v[120:123], v[184:187], v[56:59]
ds_read_b64_tr_b16 v[142:143], v7 offset:29696
s_waitcnt vmcnt(6)
v_mfma_f32_16x16x32_bf16 v[60:63], v[120:123], v[188:191], v[60:63]
ds_read_b64_tr_b16 v[120:121], v6 offset:30720
s_add_u32 s48, s48, 4096
s_waitcnt lgkmcnt(9)
v_mfma_f32_16x16x32_bf16 v[64:67], v[124:127], v[184:187], v[64:67]
ds_read_b64_tr_b16 v[122:123], v6 offset:31744
v_mfma_f32_16x16x32_bf16 v[68:71], v[124:127], v[188:191], v[68:71]
ds_read_b64_tr_b16 v[124:125], v7 offset:30720
s_add_u32 s49, s49, 4096
s_waitcnt lgkmcnt(9)
v_mfma_f32_16x16x32_bf16 v[72:75], v[128:131], v[184:187], v[72:75]
ds_read_b64_tr_b16 v[126:127], v7 offset:31744
v_mfma_f32_16x16x32_bf16 v[76:79], v[128:131], v[188:191], v[76:79]
ds_read_b64_tr_b16 v[128:129], v6 offset:32768
s_waitcnt lgkmcnt(9)
v_mfma_f32_16x16x32_bf16 v[80:83], v[132:135], v[184:187], v[80:83]
ds_read_b64_tr_b16 v[130:131], v6 offset:33792
buffer_load_dwordx4 v[216:219], v1, s[8:11], s48 offen offset:0 sc1
v_mfma_f32_16x16x32_bf16 v[84:87], v[132:135], v[188:191], v[84:87]
ds_read_b64_tr_b16 v[132:133], v7 offset:32768
s_waitcnt lgkmcnt(9)
v_mfma_f32_16x16x32_bf16 v[88:91], v[184:187], v[136:139], v[88:91]
ds_read_b64_tr_b16 v[134:135], v7 offset:33792
buffer_load_dwordx4 v[220:223], v1, s[8:11], s49 offen offset:0 sc1
v_mfma_f32_16x16x32_bf16 v[92:95], v[188:191], v[136:139], v[92:95]
ds_read_b64_tr_b16 v[136:137], v6 offset:34816
s_waitcnt lgkmcnt(9)
v_mfma_f32_16x16x32_bf16 v[96:99], v[184:187], v[140:143], v[96:99]
ds_read_b64_tr_b16 v[138:139], v6 offset:35840
v_mfma_f32_16x16x32_bf16 v[100:103], v[188:191], v[140:143], v[100:103]
ds_read_b64_tr_b16 v[140:141], v7 offset:34816
s_waitcnt vmcnt(7) lgkmcnt(9)
v_mfma_f32_16x16x32_bf16 v[56:59], v[120:123], v[192:195], v[56:59]
ds_read_b64_tr_b16 v[142:143], v7 offset:35840
s_waitcnt vmcnt(6)
v_mfma_f32_16x16x32_bf16 v[60:63], v[120:123], v[196:199], v[60:63]
ds_read_b64_tr_b16 v[120:121], v6 offset:36864
buffer_load_dwordx4 v[224:227], v1, s[8:11], s48 offen offset:1024 sc1
s_waitcnt lgkmcnt(9)
v_mfma_f32_16x16x32_bf16 v[64:67], v[124:127], v[192:195], v[64:67]
ds_read_b64_tr_b16 v[122:123], v6 offset:37888
v_mfma_f32_16x16x32_bf16 v[68:71], v[124:127], v[196:199], v[68:71]
ds_read_b64_tr_b16 v[124:125], v7 offset:36864
buffer_load_dwordx4 v[228:231], v1, s[8:11], s49 offen offset:1024 sc1
s_waitcnt lgkmcnt(9)
v_mfma_f32_16x16x32_bf16 v[72:75], v[128:131], v[192:195], v[72:75]
ds_read_b64_tr_b16 v[126:127], v7 offset:37888
v_mfma_f32_16x16x32_bf16 v[76:79], v[128:131], v[196:199], v[76:79]
ds_read_b64_tr_b16 v[128:129], v6 offset:38912
s_waitcnt lgkmcnt(9)
v_mfma_f32_16x16x32_bf16 v[80:83], v[132:135], v[192:195], v[80:83]
ds_read_b64_tr_b16 v[130:131], v6 offset:39936
buffer_load_dwordx4 v[152:155], v1, s[8:11], s48 offen offset:2048 sc1
v_mfma_f32_16x16x32_bf16 v[84:87], v[132:135], v[196:199], v[84:87]
ds_read_b64_tr_b16 v[132:133], v7 offset:38912
s_waitcnt lgkmcnt(9)
v_mfma_f32_16x16x32_bf16 v[88:91], v[192:195], v[136:139], v[88:91]
ds_read_b64_tr_b16 v[134:135], v7 offset:39936
buffer_load_dwordx4 v[156:159], v1, s[8:11], s49 offen offset:2048 sc1
v_mfma_f32_16x16x32_bf16 v[92:95], v[196:199], v[136:139], v[92:95]
ds_read_b64_tr_b16 v[136:137], v6 offset:40960
s_waitcnt lgkmcnt(9)
v_mfma_f32_16x16x32_bf16 v[96:99], v[192:195], v[140:143], v[96:99]
ds_read_b64_tr_b16 v[138:139], v6 offset:41984
v_mfma_f32_16x16x32_bf16 v[100:103], v[196:199], v[140:143], v[100:103]
ds_read_b64_tr_b16 v[140:141], v7 offset:40960
s_waitcnt vmcnt(9) lgkmcnt(9)
v_mfma_f32_16x16x32_bf16 v[56:59], v[120:123], v[200:203], v[56:59]
ds_read_b64_tr_b16 v[142:143], v7 offset:41984
s_waitcnt vmcnt(8)
v_mfma_f32_16x16x32_bf16 v[60:63], v[120:123], v[204:207], v[60:63]
ds_read_b64_tr_b16 v[120:121], v6 offset:43008
buffer_load_dwordx4 v[160:163], v1, s[8:11], s48 offen offset:3072 sc1
s_waitcnt lgkmcnt(9)
v_mfma_f32_16x16x32_bf16 v[64:67], v[124:127], v[200:203], v[64:67]
ds_read_b64_tr_b16 v[122:123], v6 offset:44032
v_mfma_f32_16x16x32_bf16 v[68:71], v[124:127], v[204:207], v[68:71]
ds_read_b64_tr_b16 v[124:125], v7 offset:43008
s_waitcnt lgkmcnt(9)
v_mfma_f32_16x16x32_bf16 v[72:75], v[128:131], v[200:203], v[72:75]
ds_read_b64_tr_b16 v[126:127], v7 offset:44032
v_mfma_f32_16x16x32_bf16 v[76:79], v[128:131], v[204:207], v[76:79]
ds_read_b64_tr_b16 v[128:129], v6 offset:45056
s_waitcnt lgkmcnt(9)
v_mfma_f32_16x16x32_bf16 v[80:83], v[132:135], v[200:203], v[80:83]
ds_read_b64_tr_b16 v[130:131], v6 offset:46080
buffer_load_dwordx4 v[164:167], v1, s[8:11], s49 offen offset:3072 sc1
v_mfma_f32_16x16x32_bf16 v[84:87], v[132:135], v[204:207], v[84:87]
ds_read_b64_tr_b16 v[132:133], v7 offset:45056
s_waitcnt lgkmcnt(9)
v_mfma_f32_16x16x32_bf16 v[88:91], v[200:203], v[136:139], v[88:91]
ds_read_b64_tr_b16 v[134:135], v7 offset:46080
v_mfma_f32_16x16x32_bf16 v[92:95], v[204:207], v[136:139], v[92:95]
ds_read_b64_tr_b16 v[136:137], v6 offset:47104
s_waitcnt lgkmcnt(9)
v_mfma_f32_16x16x32_bf16 v[96:99], v[200:203], v[140:143], v[96:99]
ds_read_b64_tr_b16 v[138:139], v6 offset:48128
v_mfma_f32_16x16x32_bf16 v[100:103], v[204:207], v[140:143], v[100:103]
ds_read_b64_tr_b16 v[140:141], v7 offset:47104
s_waitcnt vmcnt(9) lgkmcnt(9)
v_mfma_f32_16x16x32_bf16 v[56:59], v[120:123], v[208:211], v[56:59]
ds_read_b64_tr_b16 v[142:143], v7 offset:48128
s_waitcnt vmcnt(8)
v_mfma_f32_16x16x32_bf16 v[60:63], v[120:123], v[212:215], v[60:63]
ds_read_b64_tr_b16 v[120:121], v248 offset:0
s_add_u32 s48, s48, 4096
s_waitcnt lgkmcnt(9)
v_mfma_f32_16x16x32_bf16 v[64:67], v[124:127], v[208:211], v[64:67]
ds_read_b64_tr_b16 v[122:123], v248 offset:1024
s_add_u32 s49, s49, 4096
v_mfma_f32_16x16x32_bf16 v[68:71], v[124:127], v[212:215], v[68:71]
ds_read_b64_tr_b16 v[124:125], v249 offset:0
s_waitcnt lgkmcnt(9)
v_mfma_f32_16x16x32_bf16 v[72:75], v[128:131], v[208:211], v[72:75]
ds_read_b64_tr_b16 v[126:127], v249 offset:1024
buffer_load_dwordx4 v[168:171], v1, s[8:11], s48 offen offset:0 sc1
v_mfma_f32_16x16x32_bf16 v[76:79], v[128:131], v[212:215], v[76:79]
ds_read_b64_tr_b16 v[128:129], v248 offset:2048
s_waitcnt lgkmcnt(9)
v_mfma_f32_16x16x32_bf16 v[80:83], v[132:135], v[208:211], v[80:83]
ds_read_b64_tr_b16 v[130:131], v248 offset:3072
buffer_load_dwordx4 v[172:175], v1, s[8:11], s49 offen offset:0 sc1
v_mfma_f32_16x16x32_bf16 v[84:87], v[132:135], v[212:215], v[84:87]
ds_read_b64_tr_b16 v[132:133], v249 offset:2048
buffer_load_dwordx4 v[176:179], v1, s[8:11], s48 offen offset:1024 sc1
s_waitcnt lgkmcnt(9)
v_mfma_f32_16x16x32_bf16 v[88:91], v[208:211], v[136:139], v[88:91]
ds_read_b64_tr_b16 v[134:135], v249 offset:3072
v_mfma_f32_16x16x32_bf16 v[92:95], v[212:215], v[136:139], v[92:95]
ds_read_b64_tr_b16 v[136:137], v248 offset:4096
buffer_load_dwordx4 v[180:183], v1, s[8:11], s49 offen offset:1024 sc1
s_waitcnt lgkmcnt(9)
v_mfma_f32_16x16x32_bf16 v[96:99], v[208:211], v[140:143], v[96:99]
ds_read_b64_tr_b16 v[138:139], v248 offset:5120
v_mfma_f32_16x16x32_bf16 v[100:103], v[212:215], v[140:143], v[100:103]
ds_read_b64_tr_b16 v[140:141], v249 offset:4096
s_waitcnt vmcnt(11) lgkmcnt(9)
v_mfma_f32_16x16x32_bf16 v[56:59], v[120:123], v[216:219], v[56:59]
ds_read_b64_tr_b16 v[142:143], v249 offset:5120
s_waitcnt vmcnt(10)
v_mfma_f32_16x16x32_bf16 v[60:63], v[120:123], v[220:223], v[60:63]
ds_read_b64_tr_b16 v[120:121], v248 offset:6144
buffer_load_dwordx4 v[184:187], v1, s[8:11], s48 offen offset:2048 sc1
s_waitcnt lgkmcnt(9)
v_mfma_f32_16x16x32_bf16 v[64:67], v[124:127], v[216:219], v[64:67]
ds_read_b64_tr_b16 v[122:123], v248 offset:7168
v_mfma_f32_16x16x32_bf16 v[68:71], v[124:127], v[220:223], v[68:71]
ds_read_b64_tr_b16 v[124:125], v249 offset:6144
s_waitcnt lgkmcnt(9)
v_mfma_f32_16x16x32_bf16 v[72:75], v[128:131], v[216:219], v[72:75]
ds_read_b64_tr_b16 v[126:127], v249 offset:7168
v_mfma_f32_16x16x32_bf16 v[76:79], v[128:131], v[220:223], v[76:79]
ds_read_b64_tr_b16 v[128:129], v248 offset:8192
s_waitcnt lgkmcnt(9)
v_mfma_f32_16x16x32_bf16 v[80:83], v[132:135], v[216:219], v[80:83]
ds_read_b64_tr_b16 v[130:131], v248 offset:9216
buffer_load_dwordx4 v[188:191], v1, s[8:11], s49 offen offset:2048 sc1
v_mfma_f32_16x16x32_bf16 v[84:87], v[132:135], v[220:223], v[84:87]
ds_read_b64_tr_b16 v[132:133], v249 offset:8192
s_waitcnt lgkmcnt(9)
v_mfma_f32_16x16x32_bf16 v[88:91], v[216:219], v[136:139], v[88:91]
ds_read_b64_tr_b16 v[134:135], v249 offset:9216
v_mfma_f32_16x16x32_bf16 v[92:95], v[220:223], v[136:139], v[92:95]
ds_read_b64_tr_b16 v[136:137], v248 offset:10240
s_waitcnt lgkmcnt(9)
v_mfma_f32_16x16x32_bf16 v[96:99], v[216:219], v[140:143], v[96:99]
ds_read_b64_tr_b16 v[138:139], v248 offset:11264
v_mfma_f32_16x16x32_bf16 v[100:103], v[220:223], v[140:143], v[100:103]
ds_read_b64_tr_b16 v[140:141], v249 offset:10240
v_and_b32 v3, 7, v0
v_lshlrev_b32 v3, 2, v3
v_add_u32 v3, 1024, v3
buffer_load_dword v233, v3, s[8:11], 0 offen sc1
s_waitcnt vmcnt(12) lgkmcnt(9)
v_mfma_f32_16x16x32_bf16 v[56:59], v[120:123], v[224:227], v[56:59]
ds_read_b64_tr_b16 v[142:143], v249 offset:11264
s_waitcnt vmcnt(11)
v_mfma_f32_16x16x32_bf16 v[60:63], v[120:123], v[228:231], v[60:63]
ds_read_b64_tr_b16 v[120:121], v248 offset:12288
buffer_load_dwordx4 v[192:195], v1, s[8:11], s48 offen offset:3072 sc1
s_waitcnt lgkmcnt(9)
v_mfma_f32_16x16x32_bf16 v[64:67], v[124:127], v[224:227], v[64:67]
ds_read_b64_tr_b16 v[122:123], v248 offset:13312
v_mfma_f32_16x16x32_bf16 v[68:71], v[124:127], v[228:231], v[68:71]
ds_read_b64_tr_b16 v[124:125], v249 offset:12288
s_waitcnt lgkmcnt(9)
v_mfma_f32_16x16x32_bf16 v[72:75], v[128:131], v[224:227], v[72:75]
ds_read_b64_tr_b16 v[126:127], v249 offset:13312
v_mfma_f32_16x16x32_bf16 v[76:79], v[128:131], v[228:231], v[76:79]
ds_read_b64_tr_b16 v[128:129], v248 offset:14336
s_waitcnt lgkmcnt(9)
v_mfma_f32_16x16x32_bf16 v[80:83], v[132:135], v[224:227], v[80:83]
ds_read_b64_tr_b16 v[130:131], v248 offset:15360
buffer_load_dwordx4 v[196:199], v1, s[8:11], s49 offen offset:3072 sc1
v_mfma_f32_16x16x32_bf16 v[84:87], v[132:135], v[228:231], v[84:87]
ds_read_b64_tr_b16 v[132:133], v249 offset:14336
s_waitcnt lgkmcnt(9)
v_mfma_f32_16x16x32_bf16 v[88:91], v[224:227], v[136:139], v[88:91]
ds_read_b64_tr_b16 v[134:135], v249 offset:15360
v_mfma_f32_16x16x32_bf16 v[92:95], v[228:231], v[136:139], v[92:95]
ds_read_b64_tr_b16 v[136:137], v248 offset:16384
s_waitcnt lgkmcnt(9)
v_mfma_f32_16x16x32_bf16 v[96:99], v[224:227], v[140:143], v[96:99]
ds_read_b64_tr_b16 v[138:139], v248 offset:17408
v_mfma_f32_16x16x32_bf16 v[100:103], v[228:231], v[140:143], v[100:103]
ds_read_b64_tr_b16 v[140:141], v249 offset:16384
s_waitcnt vmcnt(12) lgkmcnt(9)
v_mfma_f32_16x16x32_bf16 v[56:59], v[120:123], v[152:155], v[56:59]
ds_read_b64_tr_b16 v[142:143], v249 offset:17408
s_waitcnt vmcnt(11)
v_mfma_f32_16x16x32_bf16 v[60:63], v[120:123], v[156:159], v[60:63]
ds_read_b64_tr_b16 v[120:121], v248 offset:18432
buffer_load_dwordx4 v[236:239], v1, s[8:11], s84 offen sc1
s_waitcnt lgkmcnt(9)
v_mfma_f32_16x16x32_bf16 v[64:67], v[124:127], v[152:155], v[64:67]
ds_read_b64_tr_b16 v[122:123], v248 offset:19456
v_mfma_f32_16x16x32_bf16 v[68:71], v[124:127], v[156:159], v[68:71]
ds_read_b64_tr_b16 v[124:125], v249 offset:18432
s_waitcnt lgkmcnt(9)
v_mfma_f32_16x16x32_bf16 v[72:75], v[128:131], v[152:155], v[72:75]
ds_read_b64_tr_b16 v[126:127], v249 offset:19456
buffer_load_dwordx4 v[240:243], v1, s[8:11], s84 offen offset:1024 sc1
v_mfma_f32_16x16x32_bf16 v[76:79], v[128:131], v[156:159], v[76:79]
ds_read_b64_tr_b16 v[128:129], v248 offset:20480
s_waitcnt lgkmcnt(9)
v_mfma_f32_16x16x32_bf16 v[80:83], v[132:135], v[152:155], v[80:83]
ds_read_b64_tr_b16 v[130:131], v248 offset:21504
v_mfma_f32_16x16x32_bf16 v[84:87], v[132:135], v[156:159], v[84:87]
ds_read_b64_tr_b16 v[132:133], v249 offset:20480
s_waitcnt lgkmcnt(9)
v_mfma_f32_16x16x32_bf16 v[88:91], v[152:155], v[136:139], v[88:91]
ds_read_b64_tr_b16 v[134:135], v249 offset:21504
v_mfma_f32_16x16x32_bf16 v[92:95], v[156:159], v[136:139], v[92:95]
ds_read_b64_tr_b16 v[136:137], v248 offset:22528
s_waitcnt lgkmcnt(9)
v_mfma_f32_16x16x32_bf16 v[96:99], v[152:155], v[140:143], v[96:99]
ds_read_b64_tr_b16 v[138:139], v248 offset:23552
v_mfma_f32_16x16x32_bf16 v[100:103], v[156:159], v[140:143], v[100:103]
ds_read_b64_tr_b16 v[140:141], v249 offset:22528
s_cmp_lg_u32 s43, 0
s_cbranch_scc1 L_norem_28
s_cmp_eq_u32 s40, 0
s_cbranch_scc1 L_norem_28
s_waitcnt vmcnt(4)
v_cmp_gt_u32 vcc, 1, v233
s_nop 0
s_cbranch_vccz L_norem_28
s_waitcnt vmcnt(0)
s_mov_b32 s86, 0
L_poll_29:
buffer_load_dword v232, v3, s[8:11], 0 offen sc1
s_waitcnt vmcnt(0)
v_cmp_gt_u32 vcc, 1, v232
s_nop 0
s_cbranch_vccz L_pollok_30
s_add_u32 s86, s86, 1
s_cmp_lt_u32 s86, 0x40000
s_cbranch_scc1 L_poll_29
v_mov_b32 v232, 0xdead
s_movk_i32 s86, 252
buffer_store_dword v232, v2, s[36:39], s86 offen sc1
s_waitcnt vmcnt(0)
L_pollok_30:
L_norem_28:
buffer_load_dwordx4 v[16:19], v1, s[8:11], s50 offen offset:0 sc1
buffer_load_dwordx4 v[20:23], v1, s[8:11], s50 offen offset:1024 sc1
buffer_load_dwordx4 v[24:27], v1, s[8:11], s50 offen offset:2048 sc1
buffer_load_dwordx4 v[28:31], v1, s[8:11], s50 offen offset:3072 sc1
buffer_load_dwordx4 v[244:247], v1, s[8:11], s91 offen sc1
s_barrier
s_waitcnt vmcnt(17) lgkmcnt(9)
v_mfma_f32_16x16x32_bf16 v[56:59], v[120:123], v[160:163], v[56:59]
ds_read_b64_tr_b16 v[142:143], v249 offset:23552
s_waitcnt vmcnt(16)
v_mfma_f32_16x16x32_bf16 v[60:63], v[120:123], v[164:167], v[60:63]
ds_read_b64_tr_b16 v[120:121], v248 offset:24576
s_waitcnt lgkmcnt(9)
v_mfma_f32_16x16x32_bf16 v[64:67], v[124:127], v[160:163], v[64:67]
ds_read_b64_tr_b16 v[122:123], v248 offset:25600
v_mfma_f32_16x16x32_bf16 v[68:71], v[124:127], v[164:167], v[68:71]
ds_read_b64_tr_b16 v[124:125], v249 offset:24576
s_waitcnt lgkmcnt(9)
v_mfma_f32_16x16x32_bf16 v[72:75], v[128:131], v[160:163], v[72:75]
ds_read_b64_tr_b16 v[126:127], v249 offset:25600
v_mfma_f32_16x16x32_bf16 v[76:79], v[128:131], v[164:167], v[76:79]
ds_read_b64_tr_b16 v[128:129], v248 offset:26624
s_waitcnt lgkmcnt(9)
v_mfma_f32_16x16x32_bf16 v[80:83], v[132:135], v[160:163], v[80:83]
ds_read_b64_tr_b16 v[130:131], v248 offset:27648
v_mfma_f32_16x16x32_bf16 v[84:87], v[132:135], v[164:167], v[84:87]
ds_read_b64_tr_b16 v[132:133], v249 offset:26624
s_waitcnt lgkmcnt(9)
v_mfma_f32_16x16x32_bf16 v[88:91], v[160:163], v[136:139], v[88:91]
ds_read_b64_tr_b16 v[134:135], v249 offset:27648
v_mfma_f32_16x16x32_bf16 v[92:95], v[164:167], v[136:139], v[92:95]
ds_read_b64_tr_b16 v[136:137], v248 offset:28672
s_waitcnt lgkmcnt(9)
v_mfma_f32_16x16x32_bf16 v[96:99], v[160:163], v[140:143], v[96:99]
ds_read_b64_tr_b16 v[138:139], v248 offset:29696
v_mfma_f32_16x16x32_bf16 v[100:103], v[164:167], v[140:143], v[100:103]
ds_read_b64_tr_b16 v[140:141], v249 offset:28672
s_waitcnt vmcnt(15) lgkmcnt(9)
v_mfma_f32_16x16x32_bf16 v[56:59], v[120:123], v[168:171], v[56:59]
ds_read_b64_tr_b16 v[142:143], v249 offset:29696
s_waitcnt vmcnt(6)
v_add_f32 v236, v236, v238
v_add_f32 v237, v237, v239
v_mfma_f32_16x16x32_bf16 v[60:63], v[120:123], v[172:175], v[60:63]
ds_read_b64_tr_b16 v[120:121], v248 offset:30720
v_permlane32_swap_b32 v236, v237
s_waitcnt lgkmcnt(9)
v_mfma_f32_16x16x32_bf16 v[64:67], v[124:127], v[168:171], v[64:67]
ds_read_b64_tr_b16 v[122:123], v248 offset:31744
v_add_f32 v236, v236, v237
v_mfma_f32_16x16x32_bf16 v[68:71], v[124:127], v[172:175], v[68:71]
ds_read_b64_tr_b16 v[124:125], v249 offset:30720
v_mov_b32 v238, v236
s_waitcnt lgkmcnt(9)
v_mfma_f32_16x16x32_bf16 v[72:75], v[128:131], v[168:171], v[72:75]
ds_read_b64_tr_b16 v[126:127], v249 offset:31744
v_permlane16_swap_b32 v238, v236
v_mfma_f32_16x16x32_bf16 v[76:79], v[128:131], v[172:175], v[76:79]
ds_read_b64_tr_b16 v[128:129], v248 offset:32768
v_add_f32 v236, v236, v238
s_waitcnt lgkmcnt(9)
v_mfma_f32_16x16x32_bf16 v[80:83], v[132:135], v[168:171], v[80:83]
ds_read_b64_tr_b16 v[130:131], v248 offset:33792
v_mov_b32 v237, v236
v_mfma_f32_16x16x32_bf16 v[84:87], v[132:135], v[172:175], v[84:87]
ds_read_b64_tr_b16 v[132:133], v249 offset:32768
v_permlane32_swap_b32 v236, v237
s_waitcnt lgkmcnt(9)
v_mfma_f32_16x16x32_bf16 v[88:91], v[168:171], v[136:139], v[88:91]
ds_read_b64_tr_b16 v[134:135], v249 offset:33792
v_mul_f32 v236, 0x3b000000, v236
v_mfma_f32_16x16x32_bf16 v[92:95], v[172:175], v[136:139], v[92:95]
ds_read_b64_tr_b16 v[136:137], v248 offset:34816
v_mul_f32 v237, 0x3b000000, v237
s_waitcnt lgkmcnt(9)
v_mfma_f32_16x16x32_bf16 v[96:99], v[168:171], v[140:143], v[96:99]
ds_read_b64_tr_b16 v[138:139], v248 offset:35840
v_fma_f32 v237, -v236, v236, v237
v_mfma_f32_16x16x32_bf16 v[100:103], v[172:175], v[140:143], v[100:103]
ds_read_b64_tr_b16 v[140:141], v249 offset:34816
v_max_f32 v237, 0, v237
s_waitcnt lgkmcnt(9)
v_mfma_f32_16x16x32_bf16 v[56:59], v[120:123], v[176:179], v[56:59]
ds_read_b64_tr_b16 v[142:143], v249 offset:35840
v_add_f32 v237, s94, v237
v_mfma_f32_16x16x32_bf16 v[60:63], v[120:123], v[180:183], v[60:63]
ds_read_b64_tr_b16 v[120:121], v248 offset:36864
v_rsq_f32 v252, v237
s_waitcnt lgkmcnt(9)
v_mfma_f32_16x16x32_bf16 v[64:67], v[124:127], v[176:179], v[64:67]
ds_read_b64_tr_b16 v[122:123], v248 offset:37888
v_mul_f32 v253, v236, v252
v_mfma_f32_16x16x32_bf16 v[68:71], v[124:127], v[180:183], v[68:71]
ds_read_b64_tr_b16 v[124:125], v249 offset:36864
s_waitcnt vmcnt(5)
v_add_f32 v240, v240, v242
s_waitcnt lgkmcnt(9)
v_mfma_f32_16x16x32_bf16 v[72:75], v[128:131], v[176:179], v[72:75]
ds_read_b64_tr_b16 v[126:127], v249 offset:37888
v_add_f32 v241, v241, v243
v_mfma_f32_16x16x32_bf16 v[76:79], v[128:131], v[180:183], v[76:79]
ds_read_b64_tr_b16 v[128:129], v248 offset:38912
v_permlane32_swap_b32 v240, v241
s_waitcnt lgkmcnt(9)
v_mfma_f32_16x16x32_bf16 v[80:83], v[132:135], v[176:179], v[80:83]
ds_read_b64_tr_b16 v[130:131], v248 offset:39936
v_add_f32 v240, v240, v241
v_mfma_f32_16x16x32_bf16 v[84:87], v[132:135], v[180:183], v[84:87]
ds_read_b64_tr_b16 v[132:133], v249 offset:38912
v_mov_b32 v242, v240
s_waitcnt lgkmcnt(9)
v_mfma_f32_16x16x32_bf16 v[88:91], v[176:179], v[136:139], v[88:91]
ds_read_b64_tr_b16 v[134:135], v249 offset:39936
v_permlane16_swap_b32 v242, v240
v_mfma_f32_16x16x32_bf16 v[92:95], v[180:183], v[136:139], v[92:95]
ds_read_b64_tr_b16 v[136:137], v248 offset:40960
v_add_f32 v240, v240, v242
s_waitcnt lgkmcnt(9)
v_mfma_f32_16x16x32_bf16 v[96:99], v[176:179], v[140:143], v[96:99]
ds_read_b64_tr_b16 v[138:139], v248 offset:41984
v_mov_b32 v241, v240
v_mfma_f32_16x16x32_bf16 v[100:103], v[180:183], v[140:143], v[100:103]
ds_read_b64_tr_b16 v[140:141], v249 offset:40960
v_permlane32_swap_b32 v240, v241
v_mul_f32 v240, 0x3b000000, v240
s_waitcnt lgkmcnt(9)
v_mfma_f32_16x16x32_bf16 v[56:59], v[120:123], v[184:187], v[56:59]
ds_read_b64_tr_b16 v[142:143], v249 offset:41984
v_mul_f32 v241, 0x3b000000, v241
v_mfma_f32_16x16x32_bf16 v[60:63], v[120:123], v[188:191], v[60:63]
ds_read_b64_tr_b16 v[120:121], v248 offset:43008
v_fma_f32 v241, -v240, v240, v241
s_waitcnt lgkmcnt(9)
v_mfma_f32_16x16x32_bf16 v[64:67], v[124:127], v[184:187], v[64:67]
ds_read_b64_tr_b16 v[122:123], v248 offset:44032
v_max_f32 v241, 0, v241
v_mfma_f32_16x16x32_bf16 v[68:71], v[124:127], v[188:191], v[68:71]
ds_read_b64_tr_b16 v[124:125], v249 offset:43008
v_add_f32 v241, s94, v241
s_waitcnt lgkmcnt(9)
v_mfma_f32_16x16x32_bf16 v[72:75], v[128:131], v[184:187], v[72:75]
ds_read_b64_tr_b16 v[126:127], v249 offset:44032
v_rsq_f32 v254, v241
v_mfma_f32_16x16x32_bf16 v[76:79], v[128:131], v[188:191], v[76:79]
ds_read_b64_tr_b16 v[128:129], v248 offset:45056
v_mul_f32 v255, v240, v254
s_waitcnt lgkmcnt(9)
v_mfma_f32_16x16x32_bf16 v[80:83], v[132:135], v[184:187], v[80:83]
ds_read_b64_tr_b16 v[130:131], v248 offset:46080
s_waitcnt vmcnt(0)
v_add_f32 v244, v244, v246
v_mfma_f32_16x16x32_bf16 v[84:87], v[132:135], v[188:191], v[84:87]
ds_read_b64_tr_b16 v[132:133], v249 offset:45056
v_add_f32 v245, v245, v247
s_waitcnt lgkmcnt(9)
v_mfma_f32_16x16x32_bf16 v[88:91], v[184:187], v[136:139], v[88:91]
ds_read_b64_tr_b16 v[134:135], v249 offset:46080
v_permlane32_swap_b32 v244, v245
v_mfma_f32_16x16x32_bf16 v[92:95], v[188:191], v[136:139], v[92:95]
ds_read_b64_tr_b16 v[136:137], v248 offset:47104
v_add_f32 v244, v244, v245
s_waitcnt lgkmcnt(9)
v_mfma_f32_16x16x32_bf16 v[96:99], v[184:187], v[140:143], v[96:99]
ds_read_b64_tr_b16 v[138:139], v248 offset:48128
v_mov_b32 v246, v244
v_mfma_f32_16x16x32_bf16 v[100:103], v[188:191], v[140:143], v[100:103]
ds_read_b64_tr_b16 v[140:141], v249 offset:47104
v_permlane16_swap_b32 v246, v244
s_waitcnt lgkmcnt(9)
v_mfma_f32_16x16x32_bf16 v[56:59], v[120:123], v[192:195], v[56:59]
ds_read_b64_tr_b16 v[142:143], v249 offset:48128
v_add_f32 v244, v244, v246
v_mfma_f32_16x16x32_bf16 v[60:63], v[120:123], v[196:199], v[60:63]
v_mov_b32 v245, v244
s_waitcnt lgkmcnt(8)
v_mfma_f32_16x16x32_bf16 v[64:67], v[124:127], v[192:195], v[64:67]
v_permlane32_swap_b32 v244, v245
v_mfma_f32_16x16x32_bf16 v[68:71], v[124:127], v[196:199], v[68:71]
v_mul_f32 v244, 0x3b000000, v244
s_waitcnt lgkmcnt(6)
v_mfma_f32_16x16x32_bf16 v[72:75], v[128:131], v[192:195], v[72:75]
v_mul_f32 v245, 0x3b000000, v245
v_mfma_f32_16x16x32_bf16 v[76:79], v[128:131], v[196:199], v[76:79]
v_fma_f32 v245, -v244, v244, v245
s_waitcnt lgkmcnt(4)
v_mfma_f32_16x16x32_bf16 v[80:83], v[132:135], v[192:195], v[80:83]
v_max_f32 v245, 0, v245
v_mfma_f32_16x16x32_bf16 v[84:87], v[132:135], v[196:199], v[84:87]
v_add_f32 v245, s94, v245
s_waitcnt lgkmcnt(2)
v_mfma_f32_16x16x32_bf16 v[88:91], v[192:195], v[136:139], v[88:91]
v_rsq_f32 v234, v245
v_mfma_f32_16x16x32_bf16 v[92:95], v[196:199], v[136:139], v[92:95]
v_mul_f32 v235, v244, v234
s_waitcnt lgkmcnt(0)
v_mfma_f32_16x16x32_bf16 v[96:99], v[192:195], v[140:143], v[96:99]
v_mfma_f32_16x16x32_bf16 v[100:103], v[196:199], v[140:143], v[100:103]
s_mul_i32 s52, s42, 24576
v_add_u32 v250, s52, v6
v_add_u32 v251, s52, v7
ds_read_b64_tr_b16 v[120:121], v250 offset:2048
ds_read_b64_tr_b16 v[122:123], v250 offset:3072
ds_read_b64_tr_b16 v[124:125], v251 offset:2048
ds_read_b64_tr_b16 v[126:127], v251 offset:3072
ds_read_b64_tr_b16 v[128:129], v250 offset:4096
ds_read_b64_tr_b16 v[130:131], v250 offset:5120
ds_read_b64_tr_b16 v[132:133], v251 offset:4096
ds_read_b64_tr_b16 v[134:135], v251 offset:5120
ds_read_b64_tr_b16 v[136:137], v250 offset:8192
ds_read_b64_tr_b16 v[138:139], v250 offset:9216
ds_read_b64_tr_b16 v[140:141], v251 offset:8192
ds_read_b64_tr_b16 v[142:143], v251 offset:9216
ds_read_b64_tr_b16 v[144:145], v250 offset:10240
ds_read_b64_tr_b16 v[146:147], v250 offset:11264
ds_read_b64_tr_b16 v[148:149], v251 offset:10240
ds_read_b64_tr_b16 v[150:151], v251 offset:11264
s_waitcnt lgkmcnt(14)
v_mfma_f32_16x16x32_bf16 v[104:107], v[120:123], v[16:19], 0
ds_read_b64_tr_b16 v[120:121], v250 offset:14336
ds_read_b64_tr_b16 v[122:123], v250 offset:15360
s_waitcnt lgkmcnt(14)
v_mfma_f32_16x16x32_bf16 v[108:111], v[124:127], v[16:19], 0
ds_read_b64_tr_b16 v[124:125], v251 offset:14336
ds_read_b64_tr_b16 v[126:127], v251 offset:15360
s_waitcnt lgkmcnt(14)
v_mfma_f32_16x16x32_bf16 v[112:115], v[16:19], v[128:131], 0
ds_read_b64_tr_b16 v[128:129], v250 offset:16384
ds_read_b64_tr_b16 v[130:131], v250 offset:17408
s_waitcnt lgkmcnt(14)
v_mfma_f32_16x16x32_bf16 v[116:119], v[16:19], v[132:135], 0
ds_read_b64_tr_b16 v[132:133], v251 offset:16384
ds_read_b64_tr_b16 v[134:135], v251 offset:17408
s_waitcnt lgkmcnt(14)
v_mfma_f32_16x16x32_bf16 v[104:107], v[136:139], v[20:23], v[104:107]
ds_read_b64_tr_b16 v[136:137], v250 offset:20480
ds_read_b64_tr_b16 v[138:139], v250 offset:21504
s_waitcnt lgkmcnt(14)
v_mfma_f32_16x16x32_bf16 v[108:111], v[140:143], v[20:23], v[108:111]
ds_read_b64_tr_b16 v[140:141], v251 offset:20480
ds_read_b64_tr_b16 v[142:143], v251 offset:21504
s_waitcnt lgkmcnt(14)
v_mfma_f32_16x16x32_bf16 v[112:115], v[20:23], v[144:147], v[112:115]
ds_read_b64_tr_b16 v[144:145], v250 offset:22528
ds_read_b64_tr_b16 v[146:147], v250 offset:23552
s_waitcnt lgkmcnt(14)
v_mfma_f32_16x16x32_bf16 v[116:119], v[20:23], v[148:151], v[116:119]
ds_read_b64_tr_b16 v[148:149], v251 offset:22528
ds_read_b64_tr_b16 v[150:151], v251 offset:23552
s_waitcnt lgkmcnt(14)
v_mfma_f32_16x16x32_bf16 v[104:107], v[120:123], v[24:27], v[104:107]
s_waitcnt lgkmcnt(12)
v_mfma_f32_16x16x32_bf16 v[108:111], v[124:127], v[24:27], v[108:111]
s_waitcnt lgkmcnt(10)
v_mfma_f32_16x16x32_bf16 v[112:115], v[24:27], v[128:131], v[112:115]
s_waitcnt lgkmcnt(8)
v_mfma_f32_16x16x32_bf16 v[116:119], v[24:27], v[132:135], v[116:119]
s_waitcnt lgkmcnt(6)
v_mfma_f32_16x16x32_bf16 v[104:107], v[136:139], v[28:31], v[104:107]
s_waitcnt lgkmcnt(4)
v_mfma_f32_16x16x32_bf16 v[108:111], v[140:143], v[28:31], v[108:111]
s_waitcnt lgkmcnt(2)
v_mfma_f32_16x16x32_bf16 v[112:115], v[28:31], v[144:147], v[112:115]
s_waitcnt lgkmcnt(0)
v_mfma_f32_16x16x32_bf16 v[116:119], v[28:31], v[148:151], v[116:119]
s_nop 7
s_branch L_p1epi
L_final_21:
v_lshlrev_b32 v236, 16, v44
v_and_b32 v237, 0xffff0000, v44
v_lshlrev_b32 v238, 16, v45
v_and_b32 v239, 0xffff0000, v45
v_pk_add_f32 v[236:237], v[236:237], v[56:57]
v_pk_add_f32 v[238:239], v[238:239], v[58:59]
v_cvt_pk_bf16_f32 v44, v236, v237
v_cvt_pk_bf16_f32 v45, v238, v239
v_lshlrev_b32 v236, 16, v46
v_and_b32 v237, 0xffff0000, v46
v_lshlrev_b32 v238, 16, v47
v_and_b32 v239, 0xffff0000, v47
v_pk_add_f32 v[236:237], v[236:237], v[60:61]
v_pk_add_f32 v[238:239], v[238:239], v[62:63]
v_cvt_pk_bf16_f32 v46, v236, v237
v_cvt_pk_bf16_f32 v47, v238, v239
v_lshlrev_b32 v236, 16, v48
v_and_b32 v237, 0xffff0000, v48
v_lshlrev_b32 v238, 16, v49
v_and_b32 v239, 0xffff0000, v49
v_pk_add_f32 v[236:237], v[236:237], v[64:65]
v_pk_add_f32 v[238:239], v[238:239], v[66:67]
v_cvt_pk_bf16_f32 v48, v236, v237
v_cvt_pk_bf16_f32 v49, v238, v239
v_lshlrev_b32 v236, 16, v50
v_and_b32 v237, 0xffff0000, v50
v_lshlrev_b32 v238, 16, v51
v_and_b32 v239, 0xffff0000, v51
v_pk_add_f32 v[236:237], v[236:237], v[68:69]
v_pk_add_f32 v[238:239], v[238:239], v[70:71]
v_cvt_pk_bf16_f32 v50, v236, v237
v_cvt_pk_bf16_f32 v51, v238, v239
s_lshl_b32 s52, s45, 2
s_add_u32 s52, s52, s42
s_lshl_b32 s48, s40, 4
s_add_u32 s48, s48, s52
s_lshl_b32 s48, s48, 14
v_permlane16_swap_b32 v44, v46
v_permlane16_swap_b32 v45, v47
v_permlane16_swap_b32 v48, v50
v_permlane16_swap_b32 v49, v51
buffer_store_dwordx4 v[44:47], v5, s[28:31], s48 offen offset:0
buffer_store_dwordx4 v[48:51], v5, s[28:31], s48 offen offset:64
s_waitcnt vmcnt(0) lgkmcnt(0)
s_endpgm
L_helper:
s_and_b32 s48, s100, 15
s_lshl_b32 s49, s48, 2
s_mov_b32 s4, 0x56421010
s_mov_b32 s5, 0x99997799
s_lshr_b64 s[4:5], s[4:5], s49
s_and_b32 s49, s4, 15
s_lshl_b32 s49, s49, 3
s_load_dwordx2 s[4:5], s[0:1], s49
s_mul_i32 s50, s40, 0x400000
s_add_u32 s50, s50, 0x8000
s_bitcmp1_b32 s48, 0
s_cselect_b32 s51, 0x200000, 0
s_add_u32 s50, s50, s51
s_cmp_eq_u32 s49, 72
s_cselect_b32 s50, s50, 0
s_waitcnt lgkmcnt(0)
s_add_u32 s4, s4, s50
s_addc_u32 s5, s5, 0
s_load_dword s6, s[4:5], 128
v_lshrrev_b32 v20, 2, v0
v_mul_u32_u24 v20, 3072, v20
v_bfe_u32 v21, v0, 4, 1
v_lshlrev_b32 v21, 1, v21
v_and_b32 v22, 3, v0
v_xor_b32 v21, v21, v22
v_lshlrev_b32 v21, 4, v21
v_add_u32 v6, v20, v21
v_lshrrev_b32 v20, 3, v0
v_lshlrev_b32 v20, 10, v20
v_and_b32 v21, 7, v0
v_lshrrev_b32 v22, 4, v0
v_lshlrev_b32 v22, 1, v22
v_xor_b32 v21, v21, v22
v_lshlrev_b32 v21, 4, v21
v_add_u32 v7, v20, v21
s_mov_b32 s48, 4682
v_add_u32 v20, 0, v0
v_mul_u32_u24 v21, s48, v20
v_lshrrev_b32 v21, 16, v21
v_mul_u32_u24 v22, 14, v21
v_sub_u32 v20, v20, v22
v_mul_u32_u24 v21, 3584, v21
v_lshlrev_b32 v20, 4, v20
v_add_u32 v8, v20, v21
v_add_u32 v20, 64, v0
v_mul_u32_u24 v21, s48, v20
v_lshrrev_b32 v21, 16, v21
v_mul_u32_u24 v22, 14, v21
v_sub_u32 v20, v20, v22
v_mul_u32_u24 v21, 3584, v21
v_lshlrev_b32 v20, 4, v20
v_add_u32 v9, v20, v21
v_add_u32 v20, 128, v0
v_mul_u32_u24 v21, s48, v20
v_lshrrev_b32 v21, 16, v21
v_mul_u32_u24 v22, 14, v21
v_sub_u32 v20, v20, v22
v_mul_u32_u24 v21, 3584, v21
v_lshlrev_b32 v20, 4, v20
v_add_u32 v10, v20, v21
v_add_u32 v20, 192, v0
v_mul_u32_u24 v21, s48, v20
v_lshrrev_b32 v21, 16, v21
v_mul_u32_u24 v22, 14, v21
v_sub_u32 v20, v20, v22
v_mul_u32_u24 v21, 3584, v21
v_lshlrev_b32 v20, 4, v20
v_add_u32 v11, v20, v21
v_add_u32 v20, 256, v0
v_mul_u32_u24 v21, s48, v20
v_lshrrev_b32 v21, 16, v21
v_mul_u32_u24 v22, 14, v21
v_sub_u32 v20, v20, v22
v_mul_u32_u24 v21, 3584, v21
v_lshlrev_b32 v20, 4, v20
v_add_u32 v12, v20, v21
v_add_u32 v20, 320, v0
v_mul_u32_u24 v21, s48, v20
v_lshrrev_b32 v21, 16, v21
v_mul_u32_u24 v22, 14, v21
v_sub_u32 v20, v20, v22
v_mul_u32_u24 v21, 3584, v21
v_lshlrev_b32 v20, 4, v20
v_add_u32 v13, v20, v21
v_add_u32 v20, 384, v0
v_mul_u32_u24 v21, s48, v20
v_lshrrev_b32 v21, 16, v21
v_mul_u32_u24 v22, 14, v21
v_sub_u32 v20, v20, v22
v_mul_u32_u24 v21, 3584, v21
v_lshlrev_b32 v20, 4, v20
v_add_u32 v14, v20, v21
v_lshrrev_b32 v20, 4, v0
v_lshlrev_b32 v20, 2, v20
v_bfe_u32 v21, v0, 2, 2
v_add_u32 v20, v20, v21
v_and_b32 v21, 3, v0
v_lshlrev_b32 v21, 3, v21
v_mul_u32_u24 v22, 224, v20
v_add_u32 v16, v22, v21
v_lshlrev_b32 v22, 6, v20
v_add_u32 v22, v22, v21
v_bfe_u32 v21, v0, 4, 1
v_lshlrev_b32 v21, 5, v21
v_add_u32 v15, v22, v21
s_mov_b32 s89, 0x3f803f80
s_waitcnt lgkmcnt(0)
v_mov_b32 v19, 161792
s_mov_b32 s86, 0
L_role_31:
ds_read_b32 v18, v19
s_waitcnt lgkmcnt(0)
v_readfirstlane_b32 s41, v18
s_nop 3
s_cmp_lg_u32 s41, 0
s_cbranch_scc1 L_roleok_32
s_add_u32 s86, s86, 1
s_cmp_lt_u32 s86, 0x100000
s_cbranch_scc1 L_role_31
L_roleok_32:
s_sub_u32 s41, s41, 1
s_and_b32 s41, s41, 31
s_lshr_b32 s43, s41, 4
s_and_b32 s44, s41, 15
s_lshr_b32 s48, s44, 3
s_lshl_b32 s45, s43, 1
s_add_u32 s45, s45, s48
s_and_b32 s46, s44, 7
s_mov_b32 s47, 0
s_mov_b32 s54, 0
s_lshl_b32 s85, s41, 4
s_lshl_b32 s48, s42, 2
s_add_u32 s85, s85, s48
s_lshl_b32 s100, s41, 2
s_add_u32 s100, s100, s42
s_mul_i32 s55, s42, 98304
s_lshl_b32 s48, s44, 6
s_add_u32 s55, s55, s48
s_mul_i32 s56, s42, 6144
s_lshl_b32 s57, s42, 13
s_lshl_b32 s48, s46, 7
s_add_u32 s57, s57, s48
s_lshl_b32 s58, s42, 10
s_mul_i32 s59, s42, 229376
s_mul_i32 s48, s44, 224
s_add_u32 s59, s59, s48
s_mul_i32 s60, s42, 14336
s_mul_i32 s61, s42, 458752
s_lshl_b32 s48, s46, 7
s_add_u32 s61, s61, s48
s_mul_i32 s63, s42, 28672
s_mul_i32 s62, s42, 8192
s_add_u32 s62, s62, 114688
s_waitcnt vmcnt(0)
v_add_u32 v3, s56, v1
v_add_u32 v4, s60, v1
v_add_u32 v5, 57344, v4
v_add_u32 v18, 49152, v3
s_add_u32 m0, s56, 0
s_add_u32 s87, s55, 0
buffer_load_dwordx4 v6, s[12:15], s87 offen sc1 lds
s_add_u32 m0, s56, 1024
s_add_u32 s87, s55, 49152
buffer_load_dwordx4 v6, s[12:15], s87 offen sc1 lds
s_add_u32 m0, s56, 2048
s_add_u32 s87, s55, 1024
buffer_load_dwordx4 v6, s[12:15], s87 offen sc1 lds
s_add_u32 m0, s56, 3072
s_add_u32 s87, s55, 50176
buffer_load_dwordx4 v6, s[12:15], s87 offen sc1 lds
s_add_u32 m0, s56, 4096
s_add_u32 s87, s55, 2048
buffer_load_dwordx4 v6, s[12:15], s87 offen sc1 lds
s_add_u32 m0, s56, 5120
s_add_u32 s87, s55, 51200
buffer_load_dwordx4 v6, s[12:15], s87 offen sc1 lds
s_lshl_b32 s48, s40, 8
s_lshl_b32 s49, s41, 3
s_add_u32 s48, s48, s49
s_lshl_b32 s49, s42, 1
s_add_u32 s48, s48, s49
s_lshl_b32 s48, s48, 10
buffer_load_dwordx4 v[240:243], v1, s[28:31], s48 offen
buffer_load_dwordx4 v[244:247], v1, s[28:31], s48 offen offset:1024
s_lshl_b32 s49, s40, 8
s_lshl_b32 s50, s41, 2
s_add_u32 s49, s49, s50
s_add_u32 s49, s49, s42
s_sub_u32 s49, s49, 16
s_lshl_b32 s49, s49, 10
s_cmp_eq_u32 s40, 0
s_cselect_b32 s49, 0x7ff00000, s49
buffer_load_dwordx4 v[248:251], v1, s[28:31], s49 offen
s_lshl_b32 s50, s40, 2
s_add_u32 s50, s50, 32
v_mov_b32 v30, s50
buffer_load_dword v31, v30, s[36:39], 0 offen sc1
s_add_u32 m0, s56, 24576
s_add_u32 s87, s55, 393216
buffer_load_dwordx4 v6, s[12:15], s87 offen sc1 lds
s_add_u32 m0, s56, 25600
s_add_u32 s87, s55, 442368
buffer_load_dwordx4 v6, s[12:15], s87 offen sc1 lds
s_add_u32 m0, s56, 26624
s_add_u32 s87, s55, 394240
buffer_load_dwordx4 v6, s[12:15], s87 offen sc1 lds
s_add_u32 m0, s56, 27648
s_add_u32 s87, s55, 443392
buffer_load_dwordx4 v6, s[12:15], s87 offen sc1 lds
s_add_u32 m0, s56, 28672
s_add_u32 s87, s55, 395264
buffer_load_dwordx4 v6, s[12:15], s87 offen sc1 lds
s_add_u32 m0, s56, 29696
s_add_u32 s87, s55, 444416
buffer_load_dwordx4 v6, s[12:15], s87 offen sc1 lds
s_add_u32 m0, s56, 49152
s_add_u32 s87, s55, 786432
buffer_load_dwordx4 v6, s[12:15], s87 offen sc1 lds
s_add_u32 m0, s56, 50176
s_add_u32 s87, s55, 835584
buffer_load_dwordx4 v6, s[12:15], s87 offen sc1 lds
s_add_u32 m0, s56, 51200
s_add_u32 s87, s55, 787456
buffer_load_dwordx4 v6, s[12:15], s87 offen sc1 lds
s_add_u32 m0, s56, 52224
s_add_u32 s87, s55, 836608
buffer_load_dwordx4 v6, s[12:15], s87 offen sc1 lds
s_add_u32 m0, s56, 53248
s_add_u32 s87, s55, 788480
buffer_load_dwordx4 v6, s[12:15], s87 offen sc1 lds
s_add_u32 m0, s56, 54272
s_add_u32 s87, s55, 837632
buffer_load_dwordx4 v6, s[12:15], s87 offen sc1 lds
s_waitcnt vmcnt(16)
s_barrier
s_waitcnt vmcnt(15)
v_dot2_f32_bf16 v20, v240, s89, 0
v_dot2_f32_bf16 v21, v240, v240, 0
v_dot2_f32_bf16 v20, v241, s89, v20
v_dot2_f32_bf16 v21, v241, v241, v21
v_dot2_f32_bf16 v20, v242, s89, v20
v_dot2_f32_bf16 v21, v242, v242, v21
v_dot2_f32_bf16 v20, v243, s89, v20
v_dot2_f32_bf16 v21, v243, v243, v21
s_waitcnt vmcnt(14)
v_dot2_f32_bf16 v22, v244, s89, 0
v_dot2_f32_bf16 v23, v244, v244, 0
v_dot2_f32_bf16 v22, v245, s89, v22
v_dot2_f32_bf16 v23, v245, v245, v23
v_dot2_f32_bf16 v22, v246, s89, v22
v_dot2_f32_bf16 v23, v246, v246, v23
v_dot2_f32_bf16 v22, v247, s89, v22
v_dot2_f32_bf16 v23, v247, v247, v23
s_waitcnt vmcnt(13)
v_dot2_f32_bf16 v24, v248, s89, 0
v_dot2_f32_bf16 v25, v248, v248, 0
v_dot2_f32_bf16 v24, v249, s89, v24
v_dot2_f32_bf16 v25, v249, v249, v25
v_dot2_f32_bf16 v24, v250, s89, v24
v_dot2_f32_bf16 v25, v250, v250, v25
v_dot2_f32_bf16 v24, v251, s89, v24
v_dot2_f32_bf16 v25, v251, v251, v25
v_permlane32_swap_b32 v20, v21
v_permlane32_swap_b32 v22, v23
s_nop 0
v_permlane32_swap_b32 v24, v25
v_add_f32 v20, v20, v21
v_add_f32 v22, v22, v23
v_add_f32 v24, v24, v25
v_mov_b32 v26, v20
v_mov_b32 v27, v22
v_mov_b32 v28, v24
v_permlane16_swap_b32 v26, v20
v_permlane16_swap_b32 v27, v22
v_permlane16_swap_b32 v28, v24
v_add_f32 v20, v20, v26
v_add_f32 v22, v22, v27
v_add_f32 v24, v24, v28
v_add_f32_dpp v20, v20, v20 row_ror:8 row_mask:0xf bank_mask:0xf
v_add_f32_dpp v22, v22, v22 row_ror:8 row_mask:0xf bank_mask:0xf
v_add_f32_dpp v24, v24, v24 row_ror:8 row_mask:0xf bank_mask:0xf
v_add_f32_dpp v20, v20, v20 row_ror:4 row_mask:0xf bank_mask:0xf
v_add_f32_dpp v22, v22, v22 row_ror:4 row_mask:0xf bank_mask:0xf
v_add_f32_dpp v24, v24, v24 row_ror:4 row_mask:0xf bank_mask:0xf
v_add_f32_dpp v20, v20, v20 row_ror:2 row_mask:0xf bank_mask:0xf
v_add_f32_dpp v22, v22, v22 row_ror:2 row_mask:0xf bank_mask:0xf
v_add_f32_dpp v24, v24, v24 row_ror:2 row_mask:0xf bank_mask:0xf
v_add_f32_dpp v20, v20, v20 row_ror:1 row_mask:0xf bank_mask:0xf
v_add_f32_dpp v22, v22, v22 row_ror:1 row_mask:0xf bank_mask:0xf
v_add_f32_dpp v24, v24, v24 row_ror:1 row_mask:0xf bank_mask:0xf
v_lshrrev_b32 v29, 2, v0
v_lshlrev_b32 v29, 10, v29
v_and_b32 v19, 1, v0
v_lshlrev_b32 v19, 9, v19
v_add_u32 v29, v29, v19
v_and_b32 v19, 2, v0
v_lshlrev_b32 v19, 2, v19
v_add_u32 v29, v29, v19
v_lshlrev_b32 v19, 8, v0
s_add_u32 m0, s56, 73728
s_add_u32 s87, s55, 1179648
buffer_load_dwordx4 v6, s[12:15], s87 offen sc1 lds
s_add_u32 m0, s56, 74752
s_add_u32 s87, s55, 1228800
buffer_load_dwordx4 v6, s[12:15], s87 offen sc1 lds
s_add_u32 m0, s56, 75776
s_add_u32 s87, s55, 1180672
buffer_load_dwordx4 v6, s[12:15], s87 offen sc1 lds
s_add_u32 m0, s56, 76800
s_add_u32 s87, s55, 1229824
buffer_load_dwordx4 v6, s[12:15], s87 offen sc1 lds
s_add_u32 m0, s56, 77824
s_add_u32 s87, s55, 1181696
buffer_load_dwordx4 v6, s[12:15], s87 offen sc1 lds
s_add_u32 m0, s56, 78848
s_add_u32 s87, s55, 1230848
buffer_load_dwordx4 v6, s[12:15], s87 offen sc1 lds
s_waitcnt vmcnt(12)
s_barrier
s_lshr_b32 s48, s41, 1
s_and_b32 s49, s41, 1
s_lshl_b32 s49, s49, 3
s_lshl_b32 s50, s42, 1
s_add_u32 s49, s49, s50
s_lshl_b32 s49, s49, 4
s_lshl_b32 s50, s48, 14
s_add_u32 s50, s50, s49
s_add_u32 s50, s50, 0x10000
s_lshl_b32 s51, s48, 10
s_add_u32 s51, s51, s49
s_add_u32 s51, s51, 0x50000
v_readlane_b32 s52, v20, 0
v_readlane_b32 s53, v20, 32
v_mov_b32 v252, 0
v_mov_b32 v253, 0
v_mov_b32 v254, 0
v_mov_b32 v255, 0
v_writelane_b32 v252, s52, 0
v_writelane_b32 v253, s53, 0
s_mov_b64 exec, 0xf
buffer_store_dwordx4 v[252:255], v19, s[8:11], s51 offen offset:0 sc1
s_mov_b64 exec, -1
v_readlane_b32 s52, v22, 0
v_readlane_b32 s53, v22, 32
v_mov_b32 v252, 0
v_mov_b32 v253, 0
v_mov_b32 v254, 0
v_mov_b32 v255, 0
v_writelane_b32 v252, s52, 0
v_writelane_b32 v253, s53, 0
s_mov_b64 exec, 0xf
buffer_store_dwordx4 v[252:255], v19, s[8:11], s51 offen offset:16 sc1
s_mov_b64 exec, -1
s_lshl_b32 s48, s41, 2
s_add_u32 s48, s48, s42
s_lshl_b32 s48, s48, 4
s_add_u32 s51, s48, 0x64000
s_cmp_lt_u32 s41, 4
s_cselect_b32 s51, s51, 0x7ff00000
v_readlane_b32 s52, v24, 0
v_readlane_b32 s53, v24, 32
v_mov_b32 v252, 0
v_mov_b32 v253, 0
v_mov_b32 v254, 0
v_mov_b32 v255, 0
v_writelane_b32 v252, s52, 0
v_writelane_b32 v253, s53, 0
s_mov_b64 exec, 0xf
buffer_store_dwordx4 v[252:255], v19, s[8:11], s51 offen offset:0 sc1
s_mov_b64 exec, -1
s_add_u32 s51, s49, 0x6c000
s_lshr_b32 s48, s41, 1
s_cmp_eq_u32 s48, 7
s_cselect_b32 s51, s51, 0x7ff00000
v_readlane_b32 s52, v20, 0
v_readlane_b32 s53, v20, 32
v_mov_b32 v252, 0
v_mov_b32 v253, 0
v_mov_b32 v254, 0
v_mov_b32 v255, 0
v_writelane_b32 v252, s52, 0
v_writelane_b32 v253, s53, 0
s_mov_b64 exec, 0xf
buffer_store_dwordx4 v[252:255], v19, s[8:11], s51 offen offset:0 sc1
s_mov_b64 exec, -1
v_readlane_b32 s52, v22, 0
v_readlane_b32 s53, v22, 32
v_mov_b32 v252, 0
v_mov_b32 v253, 0
v_mov_b32 v254, 0
v_mov_b32 v255, 0
v_writelane_b32 v252, s52, 0
v_writelane_b32 v253, s53, 0
s_mov_b64 exec, 0xf
buffer_store_dwordx4 v[252:255], v19, s[8:11], s51 offen offset:16 sc1
s_mov_b64 exec, -1
s_waitcnt vmcnt(11)
s_barrier
s_waitcnt vmcnt(0)
s_mov_b32 s86, 0
L_hrdy_33:
v_cmp_eq_u32 vcc, 0, v31
s_nop 0
s_cbranch_vccz L_hrdyok_34
buffer_load_dword v31, v30, s[36:39], 0 offen sc1
s_waitcnt vmcnt(0)
s_add_u32 s86, s86, 1
s_cmp_lt_u32 s86, 0x40000
s_cbranch_scc1 L_hrdy_33
L_hrdyok_34:
v_mov_b32 v31, 1
s_mov_b64 exec, 1
buffer_store_dword v31, v2, s[8:11], s85 offen offset:512
s_mov_b64 exec, -1
ds_read_b128 v[32:35], v3 offset:0
ds_read_b128 v[36:39], v3 offset:1024
ds_read_b128 v[40:43], v3 offset:2048
ds_read_b128 v[44:47], v3 offset:3072
ds_read_b128 v[48:51], v3 offset:4096
ds_read_b128 v[52:55], v3 offset:5120
ds_read_b128 v[56:59], v3 offset:24576
ds_read_b128 v[60:63], v3 offset:25600
ds_read_b128 v[64:67], v3 offset:26624
ds_read_b128 v[68:71], v3 offset:27648
ds_read_b128 v[72:75], v3 offset:28672
ds_read_b128 v[76:79], v3 offset:29696
ds_read_b128 v[80:83], v18 offset:0
ds_read_b128 v[84:87], v18 offset:1024
ds_read_b128 v[88:91], v18 offset:2048
ds_read_b128 v[92:95], v18 offset:3072
ds_read_b128 v[96:99], v18 offset:4096
ds_read_b128 v[100:103], v18 offset:5120
s_waitcnt lgkmcnt(0)
v_mov_b32 v20, s89
v_mov_b32 v21, s89
v_mov_b32 v22, s89
v_mov_b32 v23, s89
s_and_b32 s48, s42, 1
s_lshl_b32 s48, s48, 5
v_xor_b32 v159, s48, v15
s_lshr_b32 s48, s42, 1
s_lshl_b32 s48, s48, 11
v_add_u32 v158, s48, v159
v_add_u32 v159, 4096, v159
v_mov_b32 v24, 0
v_mov_b32 v25, 0
v_mov_b32 v26, 0
v_mov_b32 v27, 0
v_mov_b32 v28, 0
v_mov_b32 v29, 0
v_mov_b32 v30, 0
v_mov_b32 v31, 0
ds_read_b64_tr_b16 v[240:241], v158 offset:0
ds_read_b64_tr_b16 v[244:245], v159 offset:0
ds_read_b64_tr_b16 v[242:243], v158 offset:1024
ds_read_b64_tr_b16 v[246:247], v159 offset:1024
ds_read_b64_tr_b16 v[248:249], v158 offset:6144
ds_read_b64_tr_b16 v[252:253], v159 offset:6144
ds_read_b64_tr_b16 v[250:251], v158 offset:7168
ds_read_b64_tr_b16 v[254:255], v159 offset:7168
s_waitcnt lgkmcnt(5)
v_mfma_f32_16x16x32_bf16 v[24:27], v[240:243], v[20:23], v[24:27]
s_waitcnt lgkmcnt(4)
v_mfma_f32_16x16x32_bf16 v[28:31], v[20:23], v[244:247], v[28:31]
ds_read_b64_tr_b16 v[240:241], v158 offset:12288
ds_read_b64_tr_b16 v[244:245], v159 offset:12288
ds_read_b64_tr_b16 v[242:243], v158 offset:13312
ds_read_b64_tr_b16 v[246:247], v159 offset:13312
s_waitcnt lgkmcnt(5)
v_mfma_f32_16x16x32_bf16 v[24:27], v[248:251], v[20:23], v[24:27]
s_waitcnt lgkmcnt(4)
v_mfma_f32_16x16x32_bf16 v[28:31], v[20:23], v[252:255], v[28:31]
ds_read_b64_tr_b16 v[248:249], v158 offset:18432
ds_read_b64_tr_b16 v[252:253], v159 offset:18432
ds_read_b64_tr_b16 v[250:251], v158 offset:19456
ds_read_b64_tr_b16 v[254:255], v159 offset:19456
s_waitcnt lgkmcnt(5)
v_mfma_f32_16x16x32_bf16 v[24:27], v[240:243], v[20:23], v[24:27]
s_waitcnt lgkmcnt(4)
v_mfma_f32_16x16x32_bf16 v[28:31], v[20:23], v[244:247], v[28:31]
ds_read_b64_tr_b16 v[240:241], v158 offset:24576
ds_read_b64_tr_b16 v[244:245], v159 offset:24576
ds_read_b64_tr_b16 v[242:243], v158 offset:25600
ds_read_b64_tr_b16 v[246:247], v159 offset:25600
s_waitcnt lgkmcnt(5)
v_mfma_f32_16x16x32_bf16 v[24:27], v[248:251], v[20:23], v[24:27]
s_waitcnt lgkmcnt(4)
v_mfma_f32_16x16x32_bf16 v[28:31], v[20:23], v[252:255], v[28:31]
ds_read_b64_tr_b16 v[248:249], v158 offset:30720
ds_read_b64_tr_b16 v[252:253], v159 offset:30720
ds_read_b64_tr_b16 v[250:251], v158 offset:31744
ds_read_b64_tr_b16 v[254:255], v159 offset:31744
s_waitcnt lgkmcnt(5)
v_mfma_f32_16x16x32_bf16 v[24:27], v[240:243], v[20:23], v[24:27]
s_waitcnt lgkmcnt(4)
v_mfma_f32_16x16x32_bf16 v[28:31], v[20:23], v[244:247], v[28:31]
ds_read_b64_tr_b16 v[240:241], v158 offset:36864
ds_read_b64_tr_b16 v[244:245], v159 offset:36864
ds_read_b64_tr_b16 v[242:243], v158 offset:37888
ds_read_b64_tr_b16 v[246:247], v159 offset:37888
s_waitcnt lgkmcnt(5)
v_mfma_f32_16x16x32_bf16 v[24:27], v[248:251], v[20:23], v[24:27]
s_waitcnt lgkmcnt(4)
v_mfma_f32_16x16x32_bf16 v[28:31], v[20:23], v[252:255], v[28:31]
ds_read_b64_tr_b16 v[248:249], v158 offset:43008
ds_read_b64_tr_b16 v[252:253], v159 offset:43008
ds_read_b64_tr_b16 v[250:251], v158 offset:44032
ds_read_b64_tr_b16 v[254:255], v159 offset:44032
s_waitcnt lgkmcnt(5)
v_mfma_f32_16x16x32_bf16 v[24:27], v[240:243], v[20:23], v[24:27]
s_waitcnt lgkmcnt(4)
v_mfma_f32_16x16x32_bf16 v[28:31], v[20:23], v[244:247], v[28:31]
v_add_u32 v158, 49152, v158
v_add_u32 v159, 49152, v159
ds_read_b64_tr_b16 v[240:241], v158 offset:0
ds_read_b64_tr_b16 v[244:245], v159 offset:0
ds_read_b64_tr_b16 v[242:243], v158 offset:1024
ds_read_b64_tr_b16 v[246:247], v159 offset:1024
s_waitcnt lgkmcnt(5)
v_mfma_f32_16x16x32_bf16 v[24:27], v[248:251], v[20:23], v[24:27]
s_waitcnt lgkmcnt(4)
v_mfma_f32_16x16x32_bf16 v[28:31], v[20:23], v[252:255], v[28:31]
ds_read_b64_tr_b16 v[248:249], v158 offset:6144
ds_read_b64_tr_b16 v[252:253], v159 offset:6144
ds_read_b64_tr_b16 v[250:251], v158 offset:7168
ds_read_b64_tr_b16 v[254:255], v159 offset:7168
s_waitcnt lgkmcnt(5)
v_mfma_f32_16x16x32_bf16 v[24:27], v[240:243], v[20:23], v[24:27]
s_waitcnt lgkmcnt(4)
v_mfma_f32_16x16x32_bf16 v[28:31], v[20:23], v[244:247], v[28:31]
ds_read_b64_tr_b16 v[240:241], v158 offset:12288
ds_read_b64_tr_b16 v[244:245], v159 offset:12288
ds_read_b64_tr_b16 v[242:243], v158 offset:13312
ds_read_b64_tr_b16 v[246:247], v159 offset:13312
s_waitcnt lgkmcnt(5)
v_mfma_f32_16x16x32_bf16 v[24:27], v[248:251], v[20:23], v[24:27]
s_waitcnt lgkmcnt(4)
v_mfma_f32_16x16x32_bf16 v[28:31], v[20:23], v[252:255], v[28:31]
ds_read_b64_tr_b16 v[248:249], v158 offset:18432
ds_read_b64_tr_b16 v[252:253], v159 offset:18432
ds_read_b64_tr_b16 v[250:251], v158 offset:19456
ds_read_b64_tr_b16 v[254:255], v159 offset:19456
s_waitcnt lgkmcnt(5)
v_mfma_f32_16x16x32_bf16 v[24:27], v[240:243], v[20:23], v[24:27]
s_waitcnt lgkmcnt(4)
v_mfma_f32_16x16x32_bf16 v[28:31], v[20:23], v[244:247], v[28:31]
s_waitcnt lgkmcnt(1)
v_mfma_f32_16x16x32_bf16 v[24:27], v[248:251], v[20:23], v[24:27]
s_waitcnt lgkmcnt(0)
v_mfma_f32_16x16x32_bf16 v[28:31], v[20:23], v[252:255], v[28:31]
s_barrier
ds_read_b128 v[104:107], v18 offset:24576
ds_read_b128 v[108:111], v18 offset:25600
ds_read_b128 v[112:115], v18 offset:26624
ds_read_b128 v[116:119], v18 offset:27648
ds_read_b128 v[120:123], v18 offset:28672
ds_read_b128 v[124:127], v18 offset:29696
s_waitcnt lgkmcnt(0)
ds_read_b64_tr_b16 v[240:241], v158 offset:24576
ds_read_b64_tr_b16 v[244:245], v159 offset:24576
ds_read_b64_tr_b16 v[242:243], v158 offset:25600
ds_read_b64_tr_b16 v[246:247], v159 offset:25600
ds_read_b64_tr_b16 v[248:249], v158 offset:30720
ds_read_b64_tr_b16 v[252:253], v159 offset:30720
ds_read_b64_tr_b16 v[250:251], v158 offset:31744
ds_read_b64_tr_b16 v[254:255], v159 offset:31744
s_waitcnt lgkmcnt(5)
v_mfma_f32_16x16x32_bf16 v[24:27], v[240:243], v[20:23], v[24:27]
s_waitcnt lgkmcnt(4)
v_mfma_f32_16x16x32_bf16 v[28:31], v[20:23], v[244:247], v[28:31]
ds_read_b64_tr_b16 v[240:241], v158 offset:36864
ds_read_b64_tr_b16 v[244:245], v159 offset:36864
ds_read_b64_tr_b16 v[242:243], v158 offset:37888
ds_read_b64_tr_b16 v[246:247], v159 offset:37888
s_waitcnt lgkmcnt(5)
v_mfma_f32_16x16x32_bf16 v[24:27], v[248:251], v[20:23], v[24:27]
s_waitcnt lgkmcnt(4)
v_mfma_f32_16x16x32_bf16 v[28:31], v[20:23], v[252:255], v[28:31]
ds_read_b64_tr_b16 v[248:249], v158 offset:43008
ds_read_b64_tr_b16 v[252:253], v159 offset:43008
ds_read_b64_tr_b16 v[250:251], v158 offset:44032
ds_read_b64_tr_b16 v[254:255], v159 offset:44032
s_waitcnt lgkmcnt(5)
v_mfma_f32_16x16x32_bf16 v[24:27], v[240:243], v[20:23], v[24:27]
s_waitcnt lgkmcnt(4)
v_mfma_f32_16x16x32_bf16 v[28:31], v[20:23], v[244:247], v[28:31]
s_waitcnt lgkmcnt(1)
v_mfma_f32_16x16x32_bf16 v[24:27], v[248:251], v[20:23], v[24:27]
s_waitcnt lgkmcnt(0)
v_mfma_f32_16x16x32_bf16 v[28:31], v[20:23], v[252:255], v[28:31]
v_lshrrev_b32 v158, 4, v0
v_lshlrev_b32 v158, 4, v158
s_lshl_b32 s48, s42, 6
s_add_u32 s48, s48, 160768
v_add_u32 v158, s48, v158
s_mov_b32 exec_lo, 0x00010001
s_mov_b32 exec_hi, 0x00010001
ds_write_b128 v158, v[24:27]
s_mov_b64 exec, 0xffff
s_and_b32 s48, s42, 1
s_lshl_b32 s48, s48, 6
s_add_u32 s48, s48, 161024
v_lshlrev_b32 v159, 2, v0
v_add_u32 v159, s48, v159
ds_write_b32 v159, v28
s_mov_b64 exec, -1
s_waitcnt lgkmcnt(0)
s_barrier
s_lshr_b32 s48, s100, 3
s_mul_i32 s48, s48, 57344
s_and_b32 s49, s100, 7
s_mul_i32 s49, s49, 2048
s_add_u32 s88, s48, s49
s_add_u32 s88, s88, 0x100000
v_min_u32 v19, 15, v0
v_lshlrev_b32 v19, 7, v19
buffer_load_dword v17, v19, s[8:11], s88 offen
s_lshl_b32 s88, s100, 11
s_add_u32 s88, s88, 0x10000
v_min_u32 v19, 15, v0
v_lshlrev_b32 v19, 7, v19
buffer_load_dword v17, v19, s[8:11], s88 offen
s_mul_i32 s88, s100, 7168
v_min_u32 v19, 55, v0
v_lshlrev_b32 v19, 7, v19
buffer_load_dword v17, v19, s[20:23], s88 offen
s_barrier
s_barrier
s_lshl_b32 s48, s42, 10
s_add_u32 s48, s48, 65536
v_add_u32 v19, s48, v1
ds_read_b128 v[240:243], v19 offset:0
ds_read_b128 v[244:247], v19 offset:4096
ds_read_b128 v[248:251], v19 offset:8192
ds_read_b128 v[252:255], v19 offset:12288
s_cmp_ge_u32 s42, 2
s_cbranch_scc1 L_hv_35
v_and_b32 v18, 15, v0
v_lshlrev_b32 v18, 2, v18
v_add_u32 v18, 163072, v18
ds_read_b32 v20, v18
ds_read_b32 v24, v18 offset:64
v_lshrrev_b32 v18, 4, v0
v_lshlrev_b32 v18, 4, v18
s_lshl_b32 s48, s42, 6
s_add_u32 s48, s48, 160896
v_add_u32 v18, s48, v18
ds_read_b128 v[28:31], v18
s_waitcnt lgkmcnt(2)
v_mov_b32 v21, v20
s_waitcnt lgkmcnt(1)
v_mov_b32 v25, v24
v_mov_b32 v22, v20
v_mov_b32 v26, v24
v_mov_b32 v23, v20
v_mov_b32 v27, v24
s_waitcnt lgkmcnt(0)
s_branch L_hvj_36
L_hv_35:
v_lshrrev_b32 v18, 4, v0
v_lshlrev_b32 v18, 4, v18
v_add_u32 v18, 163072, v18
ds_read_b128 v[20:23], v18
ds_read_b128 v[24:27], v18 offset:64
v_and_b32 v18, 15, v0
v_lshlrev_b32 v18, 2, v18
s_and_b32 s48, s42, 1
s_lshl_b32 s48, s48, 6
s_add_u32 s48, s48, 161024
v_add_u32 v18, s48, v18
ds_read_b32 v28, v18
s_waitcnt lgkmcnt(0)
v_mov_b32 v29, v28
v_mov_b32 v30, v28
v_mov_b32 v31, v28
s_waitcnt lgkmcnt(0)
L_hvj_36:
s_nop 1
v_pk_add_f32 v[240:241], v[240:241], v[244:245]
v_pk_add_f32 v[248:249], v[248:249], v[252:253]
v_pk_add_f32 v[242:243], v[242:243], v[246:247]
v_pk_add_f32 v[250:251], v[250:251], v[254:255]
v_pk_add_f32 v[240:241], v[240:241], v[248:249]
v_pk_add_f32 v[242:243], v[242:243], v[250:251]
v_pk_mul_f32 v[24:25], v[24:25], v[28:29]
v_pk_mul_f32 v[26:27], v[26:27], v[30:31]
v_pk_fma_f32 v[240:241], v[240:241], v[20:21], v[24:25] neg_lo:[0,0,1] neg_hi:[0,0,1]
v_pk_fma_f32 v[242:243], v[242:243], v[22:23], v[26:27] neg_lo:[0,0,1] neg_hi:[0,0,1]
v_cvt_pk_bf16_f32 v244, v240, v241
v_cvt_pk_bf16_f32 v245, v242, v243
v_lshlrev_b32 v18, 3, v0
s_lshl_b32 s48, s42, 9
s_add_u32 s48, s48, 57344
v_add_u32 v18, s48, v18
ds_write_b64 v18, v[244:245]
s_waitcnt lgkmcnt(0)
s_barrier
s_lshr_b32 s48, s100, 3
s_mul_i32 s48, s48, 57344
s_and_b32 s49, s100, 7
s_mul_i32 s49, s49, 5120
s_add_u32 s88, s48, s49
s_add_u32 s88, s88, 0x104000
s_mul_i32 s48, s40, 0x400000
s_add_u32 s88, s88, s48
s_add_u32 s4, s82, s88
s_addc_u32 s5, s83, 0
s_load_dword s6, s[4:5], 0
s_load_dword s7, s[4:5], 64
s_load_dword s6, s[4:5], 128
s_load_dword s7, s[4:5], 192
s_load_dword s6, s[4:5], 256
s_load_dword s7, s[4:5], 320
s_load_dword s6, s[4:5], 384
s_load_dword s7, s[4:5], 448
s_load_dword s6, s[4:5], 512
s_load_dword s7, s[4:5], 576
s_load_dword s6, s[4:5], 640
s_load_dword s7, s[4:5], 704
s_load_dword s6, s[4:5], 768
s_load_dword s7, s[4:5], 832
s_load_dword s6, s[4:5], 896
s_waitcnt lgkmcnt(14)
s_load_dword s7, s[4:5], 960
s_waitcnt lgkmcnt(14)
s_load_dword s6, s[4:5], 1024
s_waitcnt lgkmcnt(14)
s_load_dword s7, s[4:5], 1088
s_waitcnt lgkmcnt(14)
s_load_dword s6, s[4:5], 1152
s_waitcnt lgkmcnt(14)
s_load_dword s7, s[4:5], 1216
s_waitcnt lgkmcnt(14)
s_load_dword s6, s[4:5], 1280
s_waitcnt lgkmcnt(14)
s_load_dword s7, s[4:5], 1344
s_waitcnt lgkmcnt(14)
s_load_dword s6, s[4:5], 1408
s_waitcnt lgkmcnt(14)
s_load_dword s7, s[4:5], 1472
s_waitcnt lgkmcnt(14)
s_load_dword s6, s[4:5], 1536
s_waitcnt lgkmcnt(14)
s_load_dword s7, s[4:5], 1600
s_waitcnt lgkmcnt(14)
s_load_dword s6, s[4:5], 1664
s_waitcnt lgkmcnt(14)
s_load_dword s7, s[4:5], 1728
s_waitcnt lgkmcnt(14)
s_load_dword s6, s[4:5], 1792
s_waitcnt lgkmcnt(14)
s_load_dword s7, s[4:5], 1856
s_waitcnt lgkmcnt(14)
s_load_dword s6, s[4:5], 1920
s_waitcnt lgkmcnt(14)
s_load_dword s7, s[4:5], 1984
s_waitcnt lgkmcnt(14)
s_load_dword s6, s[4:5], 2048
s_waitcnt lgkmcnt(14)
s_load_dword s7, s[4:5], 2112
s_waitcnt lgkmcnt(14)
s_load_dword s6, s[4:5], 2176
s_waitcnt lgkmcnt(14)
s_load_dword s7, s[4:5], 2240
s_waitcnt lgkmcnt(14)
s_load_dword s6, s[4:5], 2304
s_waitcnt lgkmcnt(14)
s_load_dword s7, s[4:5], 2368
s_waitcnt lgkmcnt(14)
s_load_dword s6, s[4:5], 2432
s_waitcnt lgkmcnt(14)
s_load_dword s7, s[4:5], 2496
s_waitcnt vmcnt(0)
s_mov_b32 s28, s74
s_and_b32 s29, s75, 0xffff
s_mov_b32 s30, 3584
s_mov_b32 s31, 0x20000
s_mul_i32 s48, s44, 224
v_min_u32 v17, 27, v0
v_lshrrev_b32 v21, 2, v17
v_and_b32 v17, 3, v17
v_lshlrev_b32 v19, 5, v21
v_lshlrev_b32 v20, 3, v17
v_add_u32 v19, v19, v20
buffer_load_dwordx2 v[24:25], v19, s[28:31], s48 offen
s_add_u32 m0, s58, 98304
s_add_u32 s87, s57, 0
buffer_load_dwordx4 v7, s[16:19], s87 offen lds
s_add_u32 m0, s58, 102400
s_add_u32 s87, s57, 32768
buffer_load_dwordx4 v7, s[16:19], s87 offen lds
s_add_u32 m0, s58, 106496
s_add_u32 s87, s57, 65536
buffer_load_dwordx4 v7, s[16:19], s87 offen lds
s_add_u32 m0, s58, 110592
s_add_u32 s87, s57, 98304
buffer_load_dwordx4 v7, s[16:19], s87 offen lds
s_add_u32 m0, s58, 114688
s_add_u32 s87, s57, 131072
buffer_load_dwordx4 v7, s[16:19], s87 offen lds
s_add_u32 m0, s58, 118784
s_add_u32 s87, s57, 163840
buffer_load_dwordx4 v7, s[16:19], s87 offen lds
s_add_u32 m0, s58, 122880
s_add_u32 s87, s57, 196608
buffer_load_dwordx4 v7, s[16:19], s87 offen lds
s_add_u32 m0, s58, 126976
s_add_u32 s87, s57, 229376
buffer_load_dwordx4 v7, s[16:19], s87 offen lds
s_add_u32 m0, s58, 131072
s_add_u32 s87, s57, 262144
buffer_load_dwordx4 v7, s[16:19], s87 offen lds
s_add_u32 m0, s58, 135168
s_add_u32 s87, s57, 294912
buffer_load_dwordx4 v7, s[16:19], s87 offen lds
s_add_u32 m0, s58, 139264
s_add_u32 s87, s57, 327680
buffer_load_dwordx4 v7, s[16:19], s87 offen lds
s_add_u32 m0, s58, 143360
s_add_u32 s87, s57, 360448
buffer_load_dwordx4 v7, s[16:19], s87 offen lds
s_add_u32 m0, s58, 147456
s_add_u32 s87, s57, 393216
buffer_load_dwordx4 v7, s[16:19], s87 offen lds
s_add_u32 m0, s58, 151552
s_add_u32 s87, s57, 425984
buffer_load_dwordx4 v7, s[16:19], s87 offen lds
s_add_u32 m0, s58, 155648
s_add_u32 s87, s57, 458752
buffer_load_dwordx4 v7, s[16:19], s87 offen lds
s_add_u32 m0, s58, 90112
s_add_u32 s87, s57, 491520
buffer_load_dwordx4 v7, s[16:19], s87 offen lds
v_min_u32 v17, 27, v0
v_lshrrev_b32 v21, 2, v17
v_and_b32 v17, 3, v17
v_lshlrev_b32 v19, 6, v21
v_lshlrev_b32 v20, 4, v17
v_add_u32 v19, v19, v20
v_add_u32 v19, 160256, v19
s_mov_b32 s49, 0x3fb8aa3b
s_waitcnt vmcnt(16)
v_lshlrev_b32 v28, 16, v24
v_and_b32 v29, 0xffff0000, v24
v_lshlrev_b32 v30, 16, v25
v_and_b32 v31, 0xffff0000, v25
v_mul_f32 v28, s49, v28
v_mul_f32 v29, s49, v29
v_mul_f32 v30, s49, v30
v_mul_f32 v31, s49, v31
ds_write_b128 v19, v[28:31]
s_waitcnt lgkmcnt(14)
s_load_dword s6, s[4:5], 2560
s_waitcnt lgkmcnt(14)
s_load_dword s7, s[4:5], 2624
s_waitcnt lgkmcnt(14)
s_load_dword s6, s[4:5], 2688
s_waitcnt lgkmcnt(14)
s_load_dword s7, s[4:5], 2752
s_waitcnt lgkmcnt(14)
s_load_dword s6, s[4:5], 2816
s_waitcnt lgkmcnt(14)
s_load_dword s7, s[4:5], 2880
s_waitcnt lgkmcnt(14)
s_load_dword s6, s[4:5], 2944
s_waitcnt lgkmcnt(14)
s_load_dword s7, s[4:5], 3008
s_waitcnt lgkmcnt(14)
s_load_dword s6, s[4:5], 3072
s_waitcnt lgkmcnt(14)
s_load_dword s7, s[4:5], 3136
s_waitcnt vmcnt(0)
s_barrier
s_barrier
s_add_u32 s87, s59, 0
buffer_load_dwordx4 v[128:131], v8, s[20:23], s87 offen sc1
buffer_load_dwordx4 v[132:135], v9, s[20:23], s87 offen sc1
buffer_load_dwordx4 v[136:139], v10, s[20:23], s87 offen sc1
buffer_load_dwordx4 v[140:143], v11, s[20:23], s87 offen sc1
buffer_load_dwordx4 v[144:147], v12, s[20:23], s87 offen sc1
buffer_load_dwordx4 v[148:151], v13, s[20:23], s87 offen sc1
buffer_load_dwordx4 v[152:155], v14, s[20:23], s87 offen sc1
s_add_u32 s87, s59, 114688
buffer_load_dwordx4 v[156:159], v8, s[20:23], s87 offen sc1
buffer_load_dwordx4 v[160:163], v9, s[20:23], s87 offen sc1
buffer_load_dwordx4 v[164:167], v10, s[20:23], s87 offen sc1
buffer_load_dwordx4 v[168:171], v11, s[20:23], s87 offen sc1
buffer_load_dwordx4 v[172:175], v12, s[20:23], s87 offen sc1
buffer_load_dwordx4 v[176:179], v13, s[20:23], s87 offen sc1
buffer_load_dwordx4 v[180:183], v14, s[20:23], s87 offen sc1
s_mul_i32 s88, s100, 7168
s_add_u32 s88, s88, 917504
v_min_u32 v19, 55, v0
v_lshlrev_b32 v19, 7, v19
buffer_load_dword v17, v19, s[20:23], s88 offen
s_waitcnt lgkmcnt(14)
s_load_dword s6, s[4:5], 3200
s_waitcnt lgkmcnt(14)
s_load_dword s7, s[4:5], 3264
s_waitcnt lgkmcnt(14)
s_load_dword s6, s[4:5], 3328
s_waitcnt lgkmcnt(14)
s_load_dword s7, s[4:5], 3392
s_waitcnt lgkmcnt(14)
s_load_dword s6, s[4:5], 3456
s_waitcnt lgkmcnt(14)
s_load_dword s7, s[4:5], 3520
s_waitcnt lgkmcnt(14)
s_load_dword s6, s[4:5], 3584
s_waitcnt lgkmcnt(14)
s_load_dword s7, s[4:5], 3648
s_waitcnt lgkmcnt(14)
s_load_dword s6, s[4:5], 3712
s_waitcnt lgkmcnt(14)
s_load_dword s7, s[4:5], 3776
s_barrier
s_waitcnt lgkmcnt(14)
s_load_dword s6, s[4:5], 3840
s_waitcnt lgkmcnt(14)
s_load_dword s7, s[4:5], 3904
s_waitcnt lgkmcnt(14)
s_load_dword s6, s[4:5], 3968
s_waitcnt lgkmcnt(14)
s_load_dword s7, s[4:5], 4032
s_waitcnt lgkmcnt(14)
s_load_dword s6, s[4:5], 4096
s_waitcnt lgkmcnt(14)
s_load_dword s7, s[4:5], 4160
s_waitcnt lgkmcnt(14)
s_load_dword s6, s[4:5], 4224
s_waitcnt lgkmcnt(14)
s_load_dword s7, s[4:5], 4288
s_waitcnt lgkmcnt(14)
s_load_dword s6, s[4:5], 4352
s_waitcnt lgkmcnt(14)
s_load_dword s7, s[4:5], 4416
s_waitcnt lgkmcnt(14)
s_load_dword s6, s[4:5], 4480
s_waitcnt lgkmcnt(14)
s_load_dword s7, s[4:5], 4544
s_waitcnt lgkmcnt(14)
s_load_dword s6, s[4:5], 4608
s_waitcnt lgkmcnt(14)
s_load_dword s7, s[4:5], 4672
s_waitcnt lgkmcnt(14)
s_load_dword s6, s[4:5], 4736
s_waitcnt lgkmcnt(14)
s_load_dword s7, s[4:5], 4800
s_waitcnt lgkmcnt(14)
s_load_dword s6, s[4:5], 4864
s_waitcnt lgkmcnt(14)
s_load_dword s7, s[4:5], 4928
s_waitcnt lgkmcnt(14)
s_load_dword s6, s[4:5], 4992
s_waitcnt lgkmcnt(14)
s_load_dword s7, s[4:5], 5056
s_waitcnt vmcnt(1)
ds_write_b128 v4, v[128:131] offset:0
ds_write_b128 v4, v[132:135] offset:1024
ds_write_b128 v4, v[136:139] offset:2048
ds_write_b128 v4, v[140:143] offset:3072
ds_write_b128 v4, v[144:147] offset:4096
ds_write_b128 v4, v[148:151] offset:5120
ds_write_b128 v4, v[152:155] offset:6144
ds_write_b128 v4, v[156:159] offset:7168
ds_write_b128 v4, v[160:163] offset:8192
ds_write_b128 v4, v[164:167] offset:9216
ds_write_b128 v4, v[168:171] offset:10240
ds_write_b128 v4, v[172:175] offset:11264
ds_write_b128 v4, v[176:179] offset:12288
ds_write_b128 v4, v[180:183] offset:13312
s_waitcnt vmcnt(0)
s_add_u32 s87, s59, 917504
buffer_load_dwordx4 v[184:187], v8, s[20:23], s87 offen sc1
buffer_load_dwordx4 v[188:191], v9, s[20:23], s87 offen sc1
buffer_load_dwordx4 v[192:195], v10, s[20:23], s87 offen sc1
buffer_load_dwordx4 v[196:199], v11, s[20:23], s87 offen sc1
buffer_load_dwordx4 v[200:203], v12, s[20:23], s87 offen sc1
buffer_load_dwordx4 v[204:207], v13, s[20:23], s87 offen sc1
buffer_load_dwordx4 v[208:211], v14, s[20:23], s87 offen sc1
s_add_u32 s87, s59, 1032192
buffer_load_dwordx4 v[212:215], v8, s[20:23], s87 offen sc1
buffer_load_dwordx4 v[216:219], v9, s[20:23], s87 offen sc1
buffer_load_dwordx4 v[220:223], v10, s[20:23], s87 offen sc1
buffer_load_dwordx4 v[224:227], v11, s[20:23], s87 offen sc1
buffer_load_dwordx4 v[228:231], v12, s[20:23], s87 offen sc1
buffer_load_dwordx4 v[232:235], v13, s[20:23], s87 offen sc1
buffer_load_dwordx4 v[236:239], v14, s[20:23], s87 offen sc1
s_waitcnt vmcnt(0)
ds_write_b128 v5, v[184:187] offset:0
ds_write_b128 v5, v[188:191] offset:1024
ds_write_b128 v5, v[192:195] offset:2048
ds_write_b128 v5, v[196:199] offset:3072
ds_write_b128 v5, v[200:203] offset:4096
ds_write_b128 v5, v[204:207] offset:5120
ds_write_b128 v5, v[208:211] offset:6144
ds_write_b128 v5, v[212:215] offset:7168
ds_write_b128 v5, v[216:219] offset:8192
ds_write_b128 v5, v[220:223] offset:9216
ds_write_b128 v5, v[224:227] offset:10240
ds_write_b128 v5, v[228:231] offset:11264
ds_write_b128 v5, v[232:235] offset:12288
ds_write_b128 v5, v[236:239] offset:13312
s_waitcnt lgkmcnt(0)
s_barrier
v_mov_b32 v20, s89
v_mov_b32 v21, s89
v_mov_b32 v22, s89
v_mov_b32 v23, s89
s_lshl_b32 s48, s42, 5
v_add_u32 v19, s48, v16
v_add_u32 v18, 64512, v19
v_mov_b32 v24, 0
v_mov_b32 v25, 0
v_mov_b32 v26, 0
v_mov_b32 v27, 0
v_mov_b32 v28, 0
v_mov_b32 v29, 0
v_mov_b32 v30, 0
v_mov_b32 v31, 0
ds_read_b64_tr_b16 v[240:241], v19 offset:0
ds_read_b64_tr_b16 v[242:243], v19 offset:3584
ds_read_b64_tr_b16 v[244:245], v19 offset:128
ds_read_b64_tr_b16 v[246:247], v19 offset:3712
ds_read_b64_tr_b16 v[248:249], v19 offset:7168
ds_read_b64_tr_b16 v[250:251], v19 offset:10752
ds_read_b64_tr_b16 v[252:253], v19 offset:7296
ds_read_b64_tr_b16 v[254:255], v19 offset:10880
s_waitcnt lgkmcnt(6)
v_mfma_f32_16x16x32_bf16 v[24:27], v[240:243], v[20:23], v[24:27]
s_waitcnt lgkmcnt(4)
v_mfma_f32_16x16x32_bf16 v[28:31], v[244:247], v[20:23], v[28:31]
ds_read_b64_tr_b16 v[240:241], v19 offset:14336
ds_read_b64_tr_b16 v[242:243], v19 offset:17920
ds_read_b64_tr_b16 v[244:245], v19 offset:14464
ds_read_b64_tr_b16 v[246:247], v19 offset:18048
s_waitcnt lgkmcnt(6)
v_mfma_f32_16x16x32_bf16 v[24:27], v[248:251], v[20:23], v[24:27]
s_waitcnt lgkmcnt(4)
v_mfma_f32_16x16x32_bf16 v[28:31], v[252:255], v[20:23], v[28:31]
ds_read_b64_tr_b16 v[248:249], v19 offset:21504
ds_read_b64_tr_b16 v[250:251], v19 offset:25088
ds_read_b64_tr_b16 v[252:253], v19 offset:21632
ds_read_b64_tr_b16 v[254:255], v19 offset:25216
s_waitcnt lgkmcnt(6)
v_mfma_f32_16x16x32_bf16 v[24:27], v[240:243], v[20:23], v[24:27]
s_waitcnt lgkmcnt(4)
v_mfma_f32_16x16x32_bf16 v[28:31], v[244:247], v[20:23], v[28:31]
ds_read_b64_tr_b16 v[240:241], v19 offset:28672
ds_read_b64_tr_b16 v[242:243], v19 offset:32256
ds_read_b64_tr_b16 v[244:245], v19 offset:28800
ds_read_b64_tr_b16 v[246:247], v19 offset:32384
s_waitcnt lgkmcnt(6)
v_mfma_f32_16x16x32_bf16 v[24:27], v[248:251], v[20:23], v[24:27]
s_waitcnt lgkmcnt(4)
v_mfma_f32_16x16x32_bf16 v[28:31], v[252:255], v[20:23], v[28:31]
ds_read_b64_tr_b16 v[248:249], v19 offset:35840
ds_read_b64_tr_b16 v[250:251], v19 offset:39424
ds_read_b64_tr_b16 v[252:253], v19 offset:35968
ds_read_b64_tr_b16 v[254:255], v19 offset:39552
s_waitcnt lgkmcnt(6)
v_mfma_f32_16x16x32_bf16 v[24:27], v[240:243], v[20:23], v[24:27]
s_waitcnt lgkmcnt(4)
v_mfma_f32_16x16x32_bf16 v[28:31], v[244:247], v[20:23], v[28:31]
ds_read_b64_tr_b16 v[240:241], v19 offset:43008
ds_read_b64_tr_b16 v[242:243], v19 offset:46592
ds_read_b64_tr_b16 v[244:245], v19 offset:43136
ds_read_b64_tr_b16 v[246:247], v19 offset:46720
s_waitcnt lgkmcnt(6)
v_mfma_f32_16x16x32_bf16 v[24:27], v[248:251], v[20:23], v[24:27]
s_waitcnt lgkmcnt(4)
v_mfma_f32_16x16x32_bf16 v[28:31], v[252:255], v[20:23], v[28:31]
ds_read_b64_tr_b16 v[248:249], v19 offset:50176
ds_read_b64_tr_b16 v[250:251], v19 offset:53760
ds_read_b64_tr_b16 v[252:253], v19 offset:50304
ds_read_b64_tr_b16 v[254:255], v19 offset:53888
s_waitcnt lgkmcnt(6)
v_mfma_f32_16x16x32_bf16 v[24:27], v[240:243], v[20:23], v[24:27]
s_waitcnt lgkmcnt(4)
v_mfma_f32_16x16x32_bf16 v[28:31], v[244:247], v[20:23], v[28:31]
ds_read_b64_tr_b16 v[240:241], v19 offset:57344
ds_read_b64_tr_b16 v[242:243], v19 offset:60928
ds_read_b64_tr_b16 v[244:245], v19 offset:57472
ds_read_b64_tr_b16 v[246:247], v19 offset:61056
s_waitcnt lgkmcnt(6)
v_mfma_f32_16x16x32_bf16 v[24:27], v[248:251], v[20:23], v[24:27]
s_waitcnt lgkmcnt(4)
v_mfma_f32_16x16x32_bf16 v[28:31], v[252:255], v[20:23], v[28:31]
ds_read_b64_tr_b16 v[248:249], v18 offset:0
ds_read_b64_tr_b16 v[250:251], v18 offset:3584
ds_read_b64_tr_b16 v[252:253], v18 offset:128
ds_read_b64_tr_b16 v[254:255], v18 offset:3712
s_waitcnt lgkmcnt(6)
v_mfma_f32_16x16x32_bf16 v[24:27], v[240:243], v[20:23], v[24:27]
s_waitcnt lgkmcnt(4)
v_mfma_f32_16x16x32_bf16 v[28:31], v[244:247], v[20:23], v[28:31]
ds_read_b64_tr_b16 v[240:241], v18 offset:7168
ds_read_b64_tr_b16 v[242:243], v18 offset:10752
ds_read_b64_tr_b16 v[244:245], v18 offset:7296
ds_read_b64_tr_b16 v[246:247], v18 offset:10880
s_waitcnt lgkmcnt(6)
v_mfma_f32_16x16x32_bf16 v[24:27], v[248:251], v[20:23], v[24:27]
s_waitcnt lgkmcnt(4)
v_mfma_f32_16x16x32_bf16 v[28:31], v[252:255], v[20:23], v[28:31]
ds_read_b64_tr_b16 v[248:249], v18 offset:14336
ds_read_b64_tr_b16 v[250:251], v18 offset:17920
ds_read_b64_tr_b16 v[252:253], v18 offset:14464
ds_read_b64_tr_b16 v[254:255], v18 offset:18048
s_waitcnt lgkmcnt(6)
v_mfma_f32_16x16x32_bf16 v[24:27], v[240:243], v[20:23], v[24:27]
s_waitcnt lgkmcnt(4)
v_mfma_f32_16x16x32_bf16 v[28:31], v[244:247], v[20:23], v[28:31]
ds_read_b64_tr_b16 v[240:241], v18 offset:21504
ds_read_b64_tr_b16 v[242:243], v18 offset:25088
ds_read_b64_tr_b16 v[244:245], v18 offset:21632
ds_read_b64_tr_b16 v[246:247], v18 offset:25216
s_waitcnt lgkmcnt(6)
v_mfma_f32_16x16x32_bf16 v[24:27], v[248:251], v[20:23], v[24:27]
s_waitcnt lgkmcnt(4)
v_mfma_f32_16x16x32_bf16 v[28:31], v[252:255], v[20:23], v[28:31]
ds_read_b64_tr_b16 v[248:249], v18 offset:28672
ds_read_b64_tr_b16 v[250:251], v18 offset:32256
ds_read_b64_tr_b16 v[252:253], v18 offset:28800
ds_read_b64_tr_b16 v[254:255], v18 offset:32384
s_waitcnt lgkmcnt(6)
v_mfma_f32_16x16x32_bf16 v[24:27], v[240:243], v[20:23], v[24:27]
s_waitcnt lgkmcnt(4)
v_mfma_f32_16x16x32_bf16 v[28:31], v[244:247], v[20:23], v[28:31]
ds_read_b64_tr_b16 v[240:241], v18 offset:35840
ds_read_b64_tr_b16 v[242:243], v18 offset:39424
ds_read_b64_tr_b16 v[244:245], v18 offset:35968
ds_read_b64_tr_b16 v[246:247], v18 offset:39552
s_waitcnt lgkmcnt(6)
v_mfma_f32_16x16x32_bf16 v[24:27], v[248:251], v[20:23], v[24:27]
s_waitcnt lgkmcnt(4)
v_mfma_f32_16x16x32_bf16 v[28:31], v[252:255], v[20:23], v[28:31]
ds_read_b64_tr_b16 v[248:249], v18 offset:43008
ds_read_b64_tr_b16 v[250:251], v18 offset:46592
ds_read_b64_tr_b16 v[252:253], v18 offset:43136
ds_read_b64_tr_b16 v[254:255], v18 offset:46720
s_waitcnt lgkmcnt(6)
v_mfma_f32_16x16x32_bf16 v[24:27], v[240:243], v[20:23], v[24:27]
s_waitcnt lgkmcnt(4)
v_mfma_f32_16x16x32_bf16 v[28:31], v[244:247], v[20:23], v[28:31]
s_waitcnt lgkmcnt(2)
v_mfma_f32_16x16x32_bf16 v[24:27], v[248:251], v[20:23], v[24:27]
s_waitcnt lgkmcnt(0)
v_mfma_f32_16x16x32_bf16 v[28:31], v[252:255], v[20:23], v[28:31]
v_lshrrev_b32 v19, 4, v0
v_lshlrev_b32 v19, 4, v19
s_lshl_b32 s48, s42, 6
s_add_u32 s48, s48, 159744
v_add_u32 v19, s48, v19
s_mov_b32 exec_lo, 0x00010001
s_mov_b32 exec_hi, 0x00010001
ds_write_b128 v19, v[24:27]
ds_write_b128 v19, v[28:31] offset:256
s_mov_b64 exec, -1
s_waitcnt lgkmcnt(0)
s_barrier
s_lshr_b32 s48, s100, 5
s_mul_i32 s48, s48, 458752
s_and_b32 s49, s100, 31
s_mul_i32 s49, s49, 7168
s_add_u32 s88, s48, s49
v_min_u32 v19, 55, v0
v_lshlrev_b32 v19, 7, v19
buffer_load_dword v17, v19, s[24:27], s88 offen
s_lshr_b32 s48, s100, 5
s_mul_i32 s48, s48, 458752
s_and_b32 s49, s100, 31
s_mul_i32 s49, s49, 7168
s_add_u32 s88, s48, s49
s_add_u32 s88, s88, 229376
v_min_u32 v19, 55, v0
v_lshlrev_b32 v19, 7, v19
buffer_load_dword v17, v19, s[24:27], s88 offen
s_barrier
s_waitcnt vmcnt(0)
s_add_u32 m0, s62, 0
s_add_u32 s87, s61, 0
buffer_load_dwordx4 v7, s[24:27], s87 offen lds
s_add_u32 m0, s62, 1024
s_add_u32 s87, s61, 8192
buffer_load_dwordx4 v7, s[24:27], s87 offen lds
s_add_u32 m0, s62, 2048
s_add_u32 s87, s61, 16384
buffer_load_dwordx4 v7, s[24:27], s87 offen lds
s_add_u32 m0, s62, 3072
s_add_u32 s87, s61, 24576
buffer_load_dwordx4 v7, s[24:27], s87 offen lds
s_add_u32 m0, s62, 4096
s_add_u32 s87, s61, 32768
buffer_load_dwordx4 v7, s[24:27], s87 offen lds
s_add_u32 m0, s62, 5120
s_add_u32 s87, s61, 40960
buffer_load_dwordx4 v7, s[24:27], s87 offen lds
s_add_u32 m0, s62, 6144
s_add_u32 s87, s61, 49152
buffer_load_dwordx4 v7, s[24:27], s87 offen lds
s_add_u32 m0, s62, 7168
s_add_u32 s87, s61, 57344
buffer_load_dwordx4 v7, s[24:27], s87 offen lds
s_add_u32 m0, s63, 0
s_add_u32 s87, s61, 114688
buffer_load_dwordx4 v7, s[24:27], s87 offen lds
s_add_u32 m0, s63, 1024
s_add_u32 s87, s61, 122880
buffer_load_dwordx4 v7, s[24:27], s87 offen lds
s_add_u32 m0, s63, 2048
s_add_u32 s87, s61, 131072
buffer_load_dwordx4 v7, s[24:27], s87 offen lds
s_add_u32 m0, s63, 3072
s_add_u32 s87, s61, 139264
buffer_load_dwordx4 v7, s[24:27], s87 offen lds
s_add_u32 m0, s63, 4096
s_add_u32 s87, s61, 147456
buffer_load_dwordx4 v7, s[24:27], s87 offen lds
s_add_u32 m0, s63, 5120
s_add_u32 s87, s61, 155648
buffer_load_dwordx4 v7, s[24:27], s87 offen lds
s_add_u32 m0, s63, 6144
s_add_u32 s87, s61, 163840
buffer_load_dwordx4 v7, s[24:27], s87 offen lds
s_add_u32 m0, s63, 7168
s_add_u32 s87, s61, 172032
buffer_load_dwordx4 v7, s[24:27], s87 offen lds
s_add_u32 m0, s63, 8192
s_add_u32 s87, s61, 229376
buffer_load_dwordx4 v7, s[24:27], s87 offen lds
s_add_u32 m0, s63, 9216
s_add_u32 s87, s61, 237568
buffer_load_dwordx4 v7, s[24:27], s87 offen lds
s_add_u32 m0, s63, 10240
s_add_u32 s87, s61, 245760
buffer_load_dwordx4 v7, s[24:27], s87 offen lds
s_add_u32 m0, s63, 11264
s_add_u32 s87, s61, 253952
buffer_load_dwordx4 v7, s[24:27], s87 offen lds
s_add_u32 m0, s63, 12288
s_add_u32 s87, s61, 262144
buffer_load_dwordx4 v7, s[24:27], s87 offen lds
s_add_u32 m0, s63, 13312
s_add_u32 s87, s61, 270336
buffer_load_dwordx4 v7, s[24:27], s87 offen lds
s_add_u32 m0, s63, 14336
s_add_u32 s87, s61, 278528
buffer_load_dwordx4 v7, s[24:27], s87 offen lds
s_add_u32 m0, s63, 15360
s_add_u32 s87, s61, 286720
buffer_load_dwordx4 v7, s[24:27], s87 offen lds
s_add_u32 m0, s63, 16384
s_add_u32 s87, s61, 344064
buffer_load_dwordx4 v7, s[24:27], s87 offen lds
s_add_u32 m0, s63, 17408
s_add_u32 s87, s61, 352256
buffer_load_dwordx4 v7, s[24:27], s87 offen lds
s_add_u32 m0, s63, 18432
s_add_u32 s87, s61, 360448
buffer_load_dwordx4 v7, s[24:27], s87 offen lds
s_add_u32 m0, s63, 19456
s_add_u32 s87, s61, 368640
buffer_load_dwordx4 v7, s[24:27], s87 offen lds
s_add_u32 m0, s63, 20480
s_add_u32 s87, s61, 376832
buffer_load_dwordx4 v7, s[24:27], s87 offen lds
s_add_u32 m0, s63, 21504
s_add_u32 s87, s61, 385024
buffer_load_dwordx4 v7, s[24:27], s87 offen lds
s_add_u32 m0, s63, 22528
s_add_u32 s87, s61, 393216
buffer_load_dwordx4 v7, s[24:27], s87 offen lds
s_add_u32 m0, s63, 23552
s_add_u32 s87, s61, 401408
buffer_load_dwordx4 v7, s[24:27], s87 offen lds
s_add_u32 m0, s63, 24576
s_add_u32 s87, s61, 65536
buffer_load_dwordx4 v7, s[24:27], s87 offen lds
s_add_u32 m0, s63, 25600
s_add_u32 s87, s61, 73728
buffer_load_dwordx4 v7, s[24:27], s87 offen lds
s_add_u32 m0, s63, 26624
s_add_u32 s87, s61, 81920
buffer_load_dwordx4 v7, s[24:27], s87 offen lds
s_add_u32 m0, s63, 27648
s_add_u32 s87, s61, 90112
buffer_load_dwordx4 v7, s[24:27], s87 offen lds
s_waitcnt vmcnt(0)
s_barrier
s_barrier
s_add_u32 m0, s62, 0
s_add_u32 s87, s61, 180224
buffer_load_dwordx4 v7, s[24:27], s87 offen lds
s_add_u32 m0, s62, 1024
s_add_u32 s87, s61, 188416
buffer_load_dwordx4 v7, s[24:27], s87 offen lds
s_add_u32 m0, s62, 2048
s_add_u32 s87, s61, 196608
buffer_load_dwordx4 v7, s[24:27], s87 offen lds
s_add_u32 m0, s62, 3072
s_add_u32 s87, s61, 204800
buffer_load_dwordx4 v7, s[24:27], s87 offen lds
s_add_u32 m0, s62, 4096
s_add_u32 s87, s61, 98304
buffer_load_dwordx4 v7, s[24:27], s87 offen lds
s_add_u32 m0, s62, 5120
s_add_u32 s87, s61, 106496
buffer_load_dwordx4 v7, s[24:27], s87 offen lds
s_add_u32 m0, s62, 6144
s_add_u32 s87, s61, 212992
buffer_load_dwordx4 v7, s[24:27], s87 offen lds
s_add_u32 m0, s62, 7168
s_add_u32 s87, s61, 221184
buffer_load_dwordx4 v7, s[24:27], s87 offen lds
s_barrier
s_add_u32 m0, s63, 0
s_add_u32 s87, s61, 294912
buffer_load_dwordx4 v7, s[24:27], s87 offen lds
s_add_u32 m0, s63, 1024
s_add_u32 s87, s61, 303104
buffer_load_dwordx4 v7, s[24:27], s87 offen lds
s_add_u32 m0, s63, 2048
s_add_u32 s87, s61, 311296
buffer_load_dwordx4 v7, s[24:27], s87 offen lds
s_add_u32 m0, s63, 3072
s_add_u32 s87, s61, 319488
buffer_load_dwordx4 v7, s[24:27], s87 offen lds
s_add_u32 m0, s63, 4096
s_add_u32 s87, s61, 409600
buffer_load_dwordx4 v7, s[24:27], s87 offen lds
s_add_u32 m0, s63, 5120
s_add_u32 s87, s61, 417792
buffer_load_dwordx4 v7, s[24:27], s87 offen lds
s_add_u32 m0, s63, 6144
s_add_u32 s87, s61, 425984
buffer_load_dwordx4 v7, s[24:27], s87 offen lds
s_add_u32 m0, s63, 7168
s_add_u32 s87, s61, 434176
buffer_load_dwordx4 v7, s[24:27], s87 offen lds
s_add_u32 m0, s63, 8192
s_add_u32 s87, s61, 327680
buffer_load_dwordx4 v7, s[24:27], s87 offen lds
s_add_u32 m0, s63, 9216
s_add_u32 s87, s61, 335872
buffer_load_dwordx4 v7, s[24:27], s87 offen lds
s_add_u32 m0, s63, 10240
s_add_u32 s87, s61, 442368
buffer_load_dwordx4 v7, s[24:27], s87 offen lds
s_add_u32 m0, s63, 11264
s_add_u32 s87, s61, 450560
buffer_load_dwordx4 v7, s[24:27], s87 offen lds
s_waitcnt vmcnt(12)
s_barrier
s_waitcnt vmcnt(0)
s_barrier
s_lshl_b32 s88, s100, 12
v_min_u32 v19, 31, v0
v_lshlrev_b32 v19, 7, v19
buffer_load_dword v17, v19, s[16:19], s88 offen
s_barrier
s_barrier
v_add_u32 v18, 49152, v3
ds_write_b128 v3, v[32:35] offset:0
ds_write_b128 v3, v[36:39] offset:1024
ds_write_b128 v3, v[40:43] offset:2048
ds_write_b128 v3, v[44:47] offset:3072
ds_write_b128 v3, v[48:51] offset:4096
ds_write_b128 v3, v[52:55] offset:5120
ds_write_b128 v3, v[56:59] offset:24576
ds_write_b128 v3, v[60:63] offset:25600
ds_write_b128 v3, v[64:67] offset:26624
ds_write_b128 v3, v[68:71] offset:27648
ds_write_b128 v3, v[72:75] offset:28672
ds_write_b128 v3, v[76:79] offset:29696
ds_write_b128 v18, v[80:83] offset:0
ds_write_b128 v18, v[84:87] offset:1024
ds_write_b128 v18, v[88:91] offset:2048
ds_write_b128 v18, v[92:95] offset:3072
ds_write_b128 v18, v[96:99] offset:4096
ds_write_b128 v18, v[100:103] offset:5120
ds_write_b128 v18, v[104:107] offset:24576
ds_write_b128 v18, v[108:111] offset:25600
ds_write_b128 v18, v[112:115] offset:26624
ds_write_b128 v18, v[116:119] offset:27648
ds_write_b128 v18, v[120:123] offset:28672
ds_write_b128 v18, v[124:127] offset:29696
s_waitcnt lgkmcnt(0)
s_barrier
s_mov_b32 s47, 0x10000
s_barrier
s_add_u32 m0, s58, 98304
s_add_u32 s87, s57, 0
buffer_load_dwordx4 v7, s[16:19], s87 offen lds
s_add_u32 m0, s58, 102400
s_add_u32 s87, s57, 32768
buffer_load_dwordx4 v7, s[16:19], s87 offen lds
s_add_u32 m0, s58, 106496
s_add_u32 s87, s57, 65536
buffer_load_dwordx4 v7, s[16:19], s87 offen lds
s_add_u32 m0, s58, 110592
s_add_u32 s87, s57, 98304
buffer_load_dwordx4 v7, s[16:19], s87 offen lds
s_add_u32 m0, s58, 114688
s_add_u32 s87, s57, 131072
buffer_load_dwordx4 v7, s[16:19], s87 offen lds
s_add_u32 m0, s58, 118784
s_add_u32 s87, s57, 163840
buffer_load_dwordx4 v7, s[16:19], s87 offen lds
s_add_u32 m0, s58, 122880
s_add_u32 s87, s57, 196608
buffer_load_dwordx4 v7, s[16:19], s87 offen lds
s_add_u32 m0, s58, 126976
s_add_u32 s87, s57, 229376
buffer_load_dwordx4 v7, s[16:19], s87 offen lds
s_add_u32 m0, s58, 131072
s_add_u32 s87, s57, 262144
buffer_load_dwordx4 v7, s[16:19], s87 offen lds
s_add_u32 m0, s58, 135168
s_add_u32 s87, s57, 294912
buffer_load_dwordx4 v7, s[16:19], s87 offen lds
s_add_u32 m0, s58, 139264
s_add_u32 s87, s57, 327680
buffer_load_dwordx4 v7, s[16:19], s87 offen lds
s_add_u32 m0, s58, 143360
s_add_u32 s87, s57, 360448
buffer_load_dwordx4 v7, s[16:19], s87 offen lds
s_add_u32 m0, s58, 147456
s_add_u32 s87, s57, 393216
buffer_load_dwordx4 v7, s[16:19], s87 offen lds
s_add_u32 m0, s58, 151552
s_add_u32 s87, s57, 425984
buffer_load_dwordx4 v7, s[16:19], s87 offen lds
s_add_u32 m0, s58, 155648
s_add_u32 s87, s57, 458752
buffer_load_dwordx4 v7, s[16:19], s87 offen lds
s_add_u32 s87, s61, 114688
buffer_load_dwordx4 v[32:35], v7, s[24:27], s87 offen
s_add_u32 s87, s61, 122880
buffer_load_dwordx4 v[36:39], v7, s[24:27], s87 offen
s_add_u32 s87, s61, 131072
buffer_load_dwordx4 v[40:43], v7, s[24:27], s87 offen
s_add_u32 s87, s61, 139264
buffer_load_dwordx4 v[44:47], v7, s[24:27], s87 offen
s_barrier
s_barrier
s_lshl_b32 s48, s42, 10
s_add_u32 s48, s48, 65536
v_add_u32 v19, s48, v1
ds_read_b128 v[240:243], v19 offset:0
ds_read_b128 v[244:247], v19 offset:4096
ds_read_b128 v[248:251], v19 offset:8192
ds_read_b128 v[252:255], v19 offset:12288
s_cmp_ge_u32 s42, 2
s_cbranch_scc1 L_hv_37
v_and_b32 v18, 15, v0
v_lshlrev_b32 v18, 2, v18
v_add_u32 v18, 163072, v18
ds_read_b32 v20, v18
ds_read_b32 v24, v18 offset:64
v_lshrrev_b32 v18, 4, v0
v_lshlrev_b32 v18, 4, v18
s_lshl_b32 s48, s42, 6
s_add_u32 s48, s48, 160896
v_add_u32 v18, s48, v18
ds_read_b128 v[28:31], v18
s_waitcnt lgkmcnt(2)
v_mov_b32 v21, v20
s_waitcnt lgkmcnt(1)
v_mov_b32 v25, v24
v_mov_b32 v22, v20
v_mov_b32 v26, v24
v_mov_b32 v23, v20
v_mov_b32 v27, v24
s_waitcnt lgkmcnt(0)
s_branch L_hvj_38
L_hv_37:
v_lshrrev_b32 v18, 4, v0
v_lshlrev_b32 v18, 4, v18
v_add_u32 v18, 163072, v18
ds_read_b128 v[20:23], v18
ds_read_b128 v[24:27], v18 offset:64
v_and_b32 v18, 15, v0
v_lshlrev_b32 v18, 2, v18
s_and_b32 s48, s42, 1
s_lshl_b32 s48, s48, 6
s_add_u32 s48, s48, 161024
v_add_u32 v18, s48, v18
ds_read_b32 v28, v18
s_waitcnt lgkmcnt(0)
v_mov_b32 v29, v28
v_mov_b32 v30, v28
v_mov_b32 v31, v28
s_waitcnt lgkmcnt(0)
L_hvj_38:
s_nop 1
v_pk_add_f32 v[240:241], v[240:241], v[244:245]
v_pk_add_f32 v[248:249], v[248:249], v[252:253]
v_pk_add_f32 v[242:243], v[242:243], v[246:247]
v_pk_add_f32 v[250:251], v[250:251], v[254:255]
v_pk_add_f32 v[240:241], v[240:241], v[248:249]
v_pk_add_f32 v[242:243], v[242:243], v[250:251]
v_pk_mul_f32 v[24:25], v[24:25], v[28:29]
v_pk_mul_f32 v[26:27], v[26:27], v[30:31]
v_pk_fma_f32 v[240:241], v[240:241], v[20:21], v[24:25] neg_lo:[0,0,1] neg_hi:[0,0,1]
v_pk_fma_f32 v[242:243], v[242:243], v[22:23], v[26:27] neg_lo:[0,0,1] neg_hi:[0,0,1]
v_cvt_pk_bf16_f32 v244, v240, v241
v_cvt_pk_bf16_f32 v245, v242, v243
v_lshlrev_b32 v18, 3, v0
s_lshl_b32 s48, s42, 9
s_add_u32 s48, s48, 57344
v_add_u32 v18, s48, v18
ds_write_b64 v18, v[244:245]
s_waitcnt lgkmcnt(0)
s_barrier
s_add_u32 m0, s58, 90112
s_add_u32 s87, s57, 491520
buffer_load_dwordx4 v7, s[16:19], s87 offen lds
ds_write_b128 v4, v[128:131] offset:0
ds_write_b128 v4, v[132:135] offset:1024
ds_write_b128 v4, v[136:139] offset:2048
ds_write_b128 v4, v[140:143] offset:3072
ds_write_b128 v4, v[144:147] offset:4096
ds_write_b128 v4, v[148:151] offset:5120
ds_write_b128 v4, v[152:155] offset:6144
ds_write_b128 v4, v[156:159] offset:7168
ds_write_b128 v4, v[160:163] offset:8192
ds_write_b128 v4, v[164:167] offset:9216
ds_write_b128 v4, v[168:171] offset:10240
ds_write_b128 v4, v[172:175] offset:11264
ds_write_b128 v4, v[176:179] offset:12288
ds_write_b128 v4, v[180:183] offset:13312
s_waitcnt lgkmcnt(0)
s_add_u32 s87, s61, 147456
buffer_load_dwordx4 v[48:51], v7, s[24:27], s87 offen
s_add_u32 s87, s61, 155648
buffer_load_dwordx4 v[52:55], v7, s[24:27], s87 offen
s_add_u32 s87, s61, 163840
buffer_load_dwordx4 v[56:59], v7, s[24:27], s87 offen
s_add_u32 s87, s61, 172032
buffer_load_dwordx4 v[60:63], v7, s[24:27], s87 offen
s_add_u32 s87, s61, 229376
buffer_load_dwordx4 v[64:67], v7, s[24:27], s87 offen
s_add_u32 s87, s61, 237568
buffer_load_dwordx4 v[68:71], v7, s[24:27], s87 offen
s_add_u32 s87, s61, 245760
buffer_load_dwordx4 v[72:75], v7, s[24:27], s87 offen
s_add_u32 s87, s61, 253952
buffer_load_dwordx4 v[76:79], v7, s[24:27], s87 offen
s_waitcnt vmcnt(8)
s_barrier
s_barrier
s_add_u32 s87, s61, 262144
buffer_load_dwordx4 v[80:83], v7, s[24:27], s87 offen
s_add_u32 s87, s61, 270336
buffer_load_dwordx4 v[84:87], v7, s[24:27], s87 offen
s_add_u32 s87, s61, 278528
buffer_load_dwordx4 v[88:91], v7, s[24:27], s87 offen
s_add_u32 s87, s61, 286720
buffer_load_dwordx4 v[92:95], v7, s[24:27], s87 offen
s_add_u32 s87, s61, 180224
buffer_load_dwordx4 v[96:99], v7, s[24:27], s87 offen
s_add_u32 s87, s61, 188416
buffer_load_dwordx4 v[100:103], v7, s[24:27], s87 offen
s_add_u32 s87, s61, 196608
buffer_load_dwordx4 v[104:107], v7, s[24:27], s87 offen
s_add_u32 s87, s61, 204800
buffer_load_dwordx4 v[108:111], v7, s[24:27], s87 offen
s_add_u32 s87, s61, 98304
buffer_load_dwordx4 v[112:115], v7, s[24:27], s87 offen
s_add_u32 s87, s61, 106496
buffer_load_dwordx4 v[116:119], v7, s[24:27], s87 offen
s_add_u32 s87, s61, 212992
buffer_load_dwordx4 v[120:123], v7, s[24:27], s87 offen
s_add_u32 s87, s61, 221184
buffer_load_dwordx4 v[124:127], v7, s[24:27], s87 offen
s_barrier
ds_write_b128 v5, v[184:187] offset:0
ds_write_b128 v5, v[188:191] offset:1024
ds_write_b128 v5, v[192:195] offset:2048
ds_write_b128 v5, v[196:199] offset:3072
ds_write_b128 v5, v[200:203] offset:4096
ds_write_b128 v5, v[204:207] offset:5120
ds_write_b128 v5, v[208:211] offset:6144
ds_write_b128 v5, v[212:215] offset:7168
ds_write_b128 v5, v[216:219] offset:8192
ds_write_b128 v5, v[220:223] offset:9216
ds_write_b128 v5, v[224:227] offset:10240
ds_write_b128 v5, v[228:231] offset:11264
ds_write_b128 v5, v[232:235] offset:12288
ds_write_b128 v5, v[236:239] offset:13312
s_waitcnt lgkmcnt(0)
s_barrier
s_barrier
s_add_u32 m0, s62, 0
s_add_u32 s87, s61, 0
buffer_load_dwordx4 v7, s[24:27], s87 offen lds
s_add_u32 m0, s62, 1024
s_add_u32 s87, s61, 8192
buffer_load_dwordx4 v7, s[24:27], s87 offen lds
s_add_u32 m0, s62, 2048
s_add_u32 s87, s61, 16384
buffer_load_dwordx4 v7, s[24:27], s87 offen lds
s_add_u32 m0, s62, 3072
s_add_u32 s87, s61, 24576
buffer_load_dwordx4 v7, s[24:27], s87 offen lds
s_add_u32 m0, s62, 4096
s_add_u32 s87, s61, 32768
buffer_load_dwordx4 v7, s[24:27], s87 offen lds
s_add_u32 m0, s62, 5120
s_add_u32 s87, s61, 40960
buffer_load_dwordx4 v7, s[24:27], s87 offen lds
s_add_u32 m0, s62, 6144
s_add_u32 s87, s61, 49152
buffer_load_dwordx4 v7, s[24:27], s87 offen lds
s_add_u32 m0, s62, 7168
s_add_u32 s87, s61, 57344
buffer_load_dwordx4 v7, s[24:27], s87 offen lds
s_add_u32 s87, s61, 294912
buffer_load_dwordx4 v[184:187], v7, s[24:27], s87 offen
s_add_u32 s87, s61, 303104
buffer_load_dwordx4 v[188:191], v7, s[24:27], s87 offen
s_add_u32 s87, s61, 311296
buffer_load_dwordx4 v[192:195], v7, s[24:27], s87 offen
s_add_u32 s87, s61, 319488
buffer_load_dwordx4 v[196:199], v7, s[24:27], s87 offen
s_add_u32 s87, s61, 409600
buffer_load_dwordx4 v[200:203], v7, s[24:27], s87 offen
s_add_u32 s87, s61, 417792
buffer_load_dwordx4 v[204:207], v7, s[24:27], s87 offen
s_add_u32 s87, s61, 425984
buffer_load_dwordx4 v[208:211], v7, s[24:27], s87 offen
s_add_u32 s87, s61, 434176
buffer_load_dwordx4 v[212:215], v7, s[24:27], s87 offen
s_add_u32 s87, s61, 327680
buffer_load_dwordx4 v[216:219], v7, s[24:27], s87 offen
s_add_u32 s87, s61, 335872
buffer_load_dwordx4 v[220:223], v7, s[24:27], s87 offen
s_add_u32 s87, s61, 442368
buffer_load_dwordx4 v[224:227], v7, s[24:27], s87 offen
s_add_u32 s87, s61, 450560
buffer_load_dwordx4 v[228:231], v7, s[24:27], s87 offen
s_barrier
s_add_u32 m0, s63, 16384
s_add_u32 s87, s61, 344064
buffer_load_dwordx4 v7, s[24:27], s87 offen lds
s_add_u32 m0, s63, 17408
s_add_u32 s87, s61, 352256
buffer_load_dwordx4 v7, s[24:27], s87 offen lds
s_add_u32 m0, s63, 18432
s_add_u32 s87, s61, 360448
buffer_load_dwordx4 v7, s[24:27], s87 offen lds
s_add_u32 m0, s63, 19456
s_add_u32 s87, s61, 368640
buffer_load_dwordx4 v7, s[24:27], s87 offen lds
s_add_u32 m0, s63, 20480
s_add_u32 s87, s61, 376832
buffer_load_dwordx4 v7, s[24:27], s87 offen lds
s_add_u32 m0, s63, 21504
s_add_u32 s87, s61, 385024
buffer_load_dwordx4 v7, s[24:27], s87 offen lds
s_add_u32 m0, s63, 22528
s_add_u32 s87, s61, 393216
buffer_load_dwordx4 v7, s[24:27], s87 offen lds
s_add_u32 m0, s63, 23552
s_add_u32 s87, s61, 401408
buffer_load_dwordx4 v7, s[24:27], s87 offen lds
s_add_u32 m0, s63, 24576
s_add_u32 s87, s61, 65536
buffer_load_dwordx4 v7, s[24:27], s87 offen lds
s_add_u32 m0, s63, 25600
s_add_u32 s87, s61, 73728
buffer_load_dwordx4 v7, s[24:27], s87 offen lds
s_add_u32 m0, s63, 26624
s_add_u32 s87, s61, 81920
buffer_load_dwordx4 v7, s[24:27], s87 offen lds
s_add_u32 m0, s63, 27648
s_add_u32 s87, s61, 90112
buffer_load_dwordx4 v7, s[24:27], s87 offen lds
v_add_u32 v17, s63, v1
ds_write_b128 v17, v[32:35] offset:0
ds_write_b128 v17, v[36:39] offset:1024
ds_write_b128 v17, v[40:43] offset:2048
ds_write_b128 v17, v[44:47] offset:3072
s_nop 1
v_add_u32 v17, s63, v1
s_waitcnt vmcnt(51)
ds_write_b128 v17, v[48:51] offset:4096
s_waitcnt vmcnt(50)
ds_write_b128 v17, v[52:55] offset:5120
s_waitcnt vmcnt(49)
ds_write_b128 v17, v[56:59] offset:6144
s_waitcnt vmcnt(48)
ds_write_b128 v17, v[60:63] offset:7168
s_nop 1
v_add_u32 v17, s63, v1
s_waitcnt vmcnt(47)
ds_write_b128 v17, v[64:67] offset:8192
s_waitcnt vmcnt(46)
ds_write_b128 v17, v[68:71] offset:9216
s_waitcnt vmcnt(45)
ds_write_b128 v17, v[72:75] offset:10240
s_waitcnt vmcnt(44)
ds_write_b128 v17, v[76:79] offset:11264
s_nop 1
v_add_u32 v17, s63, v1
s_waitcnt vmcnt(43)
ds_write_b128 v17, v[80:83] offset:12288
s_waitcnt vmcnt(42)
ds_write_b128 v17, v[84:87] offset:13312
s_waitcnt vmcnt(41)
ds_write_b128 v17, v[88:91] offset:14336
s_waitcnt vmcnt(40)
ds_write_b128 v17, v[92:95] offset:15360
s_waitcnt lgkmcnt(0)
s_waitcnt vmcnt(0)
s_barrier
s_barrier
v_add_u32 v17, s62, v1
ds_write_b128 v17, v[96:99] offset:0
ds_write_b128 v17, v[100:103] offset:1024
ds_write_b128 v17, v[104:107] offset:2048
ds_write_b128 v17, v[108:111] offset:3072
s_nop 1
v_add_u32 v17, s62, v1
ds_write_b128 v17, v[112:115] offset:4096
ds_write_b128 v17, v[116:119] offset:5120
ds_write_b128 v17, v[120:123] offset:6144
ds_write_b128 v17, v[124:127] offset:7168
s_barrier
s_nop 0
v_add_u32 v17, s63, v1
ds_write_b128 v17, v[184:187] offset:0
ds_write_b128 v17, v[188:191] offset:1024
ds_write_b128 v17, v[192:195] offset:2048
ds_write_b128 v17, v[196:199] offset:3072
s_nop 1
v_add_u32 v17, s63, v1
ds_write_b128 v17, v[200:203] offset:4096
ds_write_b128 v17, v[204:207] offset:5120
ds_write_b128 v17, v[208:211] offset:6144
ds_write_b128 v17, v[212:215] offset:7168
s_nop 1
v_add_u32 v17, s63, v1
ds_write_b128 v17, v[216:219] offset:8192
ds_write_b128 v17, v[220:223] offset:9216
ds_write_b128 v17, v[224:227] offset:10240
ds_write_b128 v17, v[228:231] offset:11264
s_waitcnt lgkmcnt(0)
s_barrier
s_barrier
s_barrier
s_barrier
s_waitcnt vmcnt(0) lgkmcnt(0)
s_endpgm
L_end:
s_endpgm
.section .rodata,"a"
.p2align 6
.amdhsa_kernel interleave_layers__sliding_local_dilated__dense_activation_mish__prompt_kernel
  .amdhsa_next_free_vgpr 256
  .amdhsa_next_free_sgpr 102
  .amdhsa_accum_offset 256
  .amdhsa_group_segment_fixed_size 0
  .amdhsa_kernarg_size 80
  .amdhsa_user_sgpr_count 2
  .amdhsa_user_sgpr_kernarg_segment_ptr 1
  .amdhsa_system_sgpr_workgroup_id_x 1
.end_amdhsa_kernel
```
